```python
import torch

def _softmax(x, axis=-1):
    return torch.softmax(x, dim=axis)
def _gelu(x):
    return torch.nn.functional.gelu(x, approximate="tanh")
def _silu(x):
    return torch.nn.functional.silu(x)
def _sigmoid(x):
    return torch.sigmoid(x)
def _layernorm(x, axis=-1, eps=1e-5):
    m = x.mean(dim=axis, keepdim=True)
    v = x.var(dim=axis, keepdim=True, unbiased=False)
    return (x - m) / torch.sqrt(v + eps)
def _scatter_add(tgt, idx, src, axis=0):
    return tgt.clone().index_add_(axis, idx, src)
def _segment_sum(src, seg, n):
    out = torch.zeros((n,) + src.shape[1:], dtype=src.dtype)
    return out.index_add_(0, seg, src)
def _pad(x, pw):
    flat = tuple(v for pair in reversed(pw) for v in pair)
    return torch.nn.functional.pad(x, flat)

kernel_name = 'parallel_sum__mha_block__geglu_ffn__prompt'

def setup_inputs():

    _w = (lambda a: (lambda t: t.to(torch.bfloat16) if t.is_floating_point() else t)(torch.as_tensor(a)))
    def _A_setup():
        B, S, D, H = 1, 2048, 512, 32
        return {
            "x": _w((lambda *s: torch.randn(*s, dtype=torch.bfloat16) * 0.05)(B, S, D)),
            "wqkv": _w((lambda *s: torch.randn(*s, dtype=torch.bfloat16) * 0.2)(D, 3 * D)),
            "wo": _w((lambda *s: torch.randn(*s, dtype=torch.bfloat16) * 0.1)(D, D)),
        }
    _A_in = _A_setup()

    def _B_setup():
        B, S, D, F = 1, 2048, 512, 1376
        return {
            "x": _w((lambda *s: torch.randn(*s, dtype=torch.bfloat16) * 0.05)(B, S, D)),
            "w_gate": _w((lambda *s: torch.randn(*s, dtype=torch.bfloat16) * 0.1)(D, F)),
            "w_up": _w((lambda *s: torch.randn(*s, dtype=torch.bfloat16) * 0.1)(D, F)),
            "w_down": _w((lambda *s: torch.randn(*s, dtype=torch.bfloat16) * 0.1)(F, D)),
        }
    _B_in = _B_setup()

    return {
        "A_x": _A_in["x"],
        "A_wqkv": _A_in["wqkv"],
        "A_wo": _A_in["wo"],
        "B_x": _B_in["x"],
        "B_w_gate": _B_in["w_gate"],
        "B_w_up": _B_in["w_up"],
        "B_w_down": _B_in["w_down"],
    }

def reference(A_x, A_wqkv, A_wo, B_x, B_w_gate, B_w_up, B_w_down):
    def _A_ref(x, wqkv, wo):
        B, S, D = x.shape
        H = 32
        Dh = D // H
        qkv = (lambda x, *d: x.permute(*d))((x @ wqkv).reshape(B, S, 3, H, Dh), 2, 0, 3, 1, 4)
        q, k, v = qkv[0], qkv[1], qkv[2]
        scores = torch.einsum("bhqd,bhkd->bhqk", q, k) * (Dh ** -0.5)
        p = _softmax(scores, axis=-1)
        o = torch.einsum("bhqk,bhkd->bhqd", p, v)
        return (lambda x, *d: x.permute(*d))(o, 0, 2, 1, 3).reshape(B, S, D) @ wo

    def _B_ref(x, w_gate, w_up, w_down):
        return (_gelu(x @ w_gate) * (x @ w_up)) @ w_down

    x = A_x
    xn = _layernorm(x, axis=-1)
    return x + _A_ref(xn, A_wqkv, A_wo) + _B_ref(xn, B_w_gate, B_w_up, B_w_down)
```

```asm
; @launch grid=(256,1,1) block=(512,1,1) lds=163840
.amdgcn_target "amdgcn-amd-amdhsa--gfx950"
.text
.globl parallel_sum__mha_block__geglu_ffn__prompt_kernel
.p2align 12
.p2align 8
.type parallel_sum__mha_block__geglu_ffn__prompt_kernel,@function
parallel_sum__mha_block__geglu_ffn__prompt_kernel:
    s_cmp_ge_u32 s2, 256
    s_cbranch_scc1 L_end
    s_load_dwordx16 s[68:83], s[0:1], 0
    s_load_dwordx4 s[84:87], s[0:1], 64
    s_getpc_b64 s[4:5]
L_pc:
    s_lshl_b32 s3, s2, 11
    s_and_b32 s3, s3, 114688
    v_lshl_add_u32 v254, v0, 5, s3
    v_min_u32 v254, L_code_end-L_pc-4, v254
    v_mov_b32 v255, s5
    v_add_co_u32 v254, vcc, s4, v254
    s_nop 1
    v_addc_co_u32 v255, vcc, 0, v255, vcc
    global_load_dword v255, v[254:255], off
    v_lshrrev_b32 v2, 6, v0
    v_and_b32 v1, 63, v0
    s_and_b32 s41, s2, 7
    v_readfirstlane_b32 s40, v2
    s_lshr_b32 s42, s2, 3
    s_lshl_b32 s47, s41, 2
    s_lshr_b32 s41, 0x75643120, s47
    s_and_b32 s41, s41, 7
    s_and_b32 s47, s41, 1
    s_lshl_b32 s47, s47, 3
    s_and_b32 s48, s42, 7
    s_add_u32 s43, s47, s48
    s_lshr_b32 s48, s42, 3
    s_bfe_u32 s46, s41, 0x10001
    s_xor_b32 s46, s46, 1
    s_and_b32 s44, s41, 4
    s_add_u32 s44, s44, s48
    s_mul_i32 s48, s48, 0
    s_add_u32 s51, s48, s43
    s_and_b32 s51, s51, 7
    s_and_b32 s45, s40, 3
    s_mov_b32 s10, 2097152
    s_mov_b32 s11, 0x00020000
    s_mov_b32 s34, 16515072
    s_mov_b32 s35, 0x00020000
    v_lshlrev_b32 v2, 4, v1
    s_xor_b32 s60, s41, 4
    s_and_b32 s60, s60, 6
    s_lshl_b32 s60, s60, 2
    s_and_b32 s48, s42, 7
    s_add_u32 s60, s60, s48
    s_lshr_b32 s61, s42, 3
    s_lshr_b32 s47, s47, 1
    s_add_u32 s61, s61, s47
    s_cmp_lt_u32 s40, 4
    s_cbranch_scc1 L_T
    s_lshl_b32 s52, s43, 17
    s_lshl_b32 s54, s45, 12
    s_mov_b32 s14, 1572864
    s_mov_b32 s15, 0x00020000
    v_lshrrev_b32 v100, 3, v1
    s_lshl_b32 s47, s45, 5
    v_add_u32 v100, s47, v100
    v_lshlrev_b32 v100, 10, v100
    v_lshrrev_b32 v101, 4, v1
    v_xor_b32 v101, v101, v1
    v_and_b32 v101, 7, v101
    v_lshl_add_u32 v117, v101, 4, v100
    v_xor_b32 v118, 64, v117
    v_add_u32 v118, 8192, v118
    v_mov_b32 v106, 14221312
    s_and_b32 s47, s43, 8
    s_add_u32 s47, s47, s44
    s_lshl_b32 s47, s47, 1
    s_add_u32 s47, s47, s46
    s_lshl_b32 s47, s47, 2
    s_add_u32 s47, s47, s45
    s_lshl_b32 s47, s47, 3
    s_xor_b32 s67, s47, 512
    s_add_u32 s63, s51, s47
    s_and_b32 s51, s51, 7
    s_setprio 1
    s_cmp_eq_u32 s46, 1
    s_cbranch_scc1 L_G_v
    s_and_b32 s47, s44, 4
    s_add_u32 s53, s44, s47
    s_lshl2_add_u32 s53, s46, s53
    s_lshl_b32 s53, s53, 6
    s_lshl_b32 s47, s44, 7
    s_sub_u32 s47, s47, s53
    s_add_u32 s47, s47, 960
    v_mov_b32 v103, s47
    s_mul_i32 s55, s45, 3072
    s_lshl4_add_u32 s53, s55, s53
    s_add_u32 s55, s55, 16384
    v_add_u32 v100, 0, v1
    v_mul_u32_u24 v101, 43691, v100
    v_lshrrev_b32 v101, 19, v101
    v_mul_u32_u24 v102, 12, v101
    v_sub_u32 v102, v100, v102
    v_cmp_le_u32 vcc, 4, v102
    v_mul_u32_u24 v101, 3072, v101
    v_lshl_add_u32 v101, v102, 4, v101
    v_cndmask_b32 v100, 0, v103, vcc
    v_add_u32 v60, v100, v101
    v_add_u32 v100, 64, v1
    v_mul_u32_u24 v101, 43691, v100
    v_lshrrev_b32 v101, 19, v101
    v_mul_u32_u24 v102, 12, v101
    v_sub_u32 v102, v100, v102
    v_cmp_le_u32 vcc, 4, v102
    v_mul_u32_u24 v101, 3072, v101
    v_lshl_add_u32 v101, v102, 4, v101
    v_cndmask_b32 v100, 0, v103, vcc
    v_add_u32 v61, v100, v101
    v_add_u32 v100, 128, v1
    v_mul_u32_u24 v101, 43691, v100
    v_lshrrev_b32 v101, 19, v101
    v_mul_u32_u24 v102, 12, v101
    v_sub_u32 v102, v100, v102
    v_cmp_le_u32 vcc, 4, v102
    v_mul_u32_u24 v101, 3072, v101
    v_lshl_add_u32 v101, v102, 4, v101
    v_cndmask_b32 v100, 0, v103, vcc
    v_add_u32 v62, v100, v101
    s_waitcnt lgkmcnt(0)
    s_mov_b64 s[8:9], s[68:69]
    s_mov_b64 s[12:13], s[70:71]
    s_mov_b64 s[32:33], s[86:87]
    s_lshl_b32 s47, s51, 7
    s_add_u32 m0, s54, 33024
    s_add_u32 s47, s47, s52
    buffer_load_dwordx4 v117, s[8:11], s47 offen lds
    s_add_u32 m0, s54, 34048
    s_mul_i32 s48, s51, 196608
    buffer_load_dwordx4 v118, s[8:11], s47 offen lds
    s_add_u32 m0, s54, 35072
    s_add_u32 s47, s47, 16384
    buffer_load_dwordx4 v117, s[8:11], s47 offen lds
    s_add_u32 m0, s54, 36096
    s_add_u32 s48, s48, s53
    buffer_load_dwordx4 v118, s[8:11], s47 offen lds
    s_add_u32 m0, s55, 33024
    s_add_u32 s51, s51, 1
    buffer_load_dwordx4 v60, s[12:15], s48 offen lds
    s_add_u32 m0, s55, 34048
    s_nop 0
    buffer_load_dwordx4 v61, s[12:15], s48 offen lds
    s_add_u32 m0, s55, 35072
    s_nop 0
    buffer_load_dwordx4 v62, s[12:15], s48 offen lds
    s_and_b32 s51, s51, 7
    buffer_load_dword v106, v106, s[32:35], 0 offen sc1
    v_and_b32 v100, 31, v1
    s_lshl_b32 s47, s45, 5
    v_add_u32 v100, s47, v100
    v_lshrrev_b32 v101, 1, v100
    v_lshrrev_b32 v102, 5, v1
    v_xor_b32 v101, v101, v102
    v_and_b32 v101, 7, v101
    v_lshlrev_b32 v101, 4, v101
    v_lshl_add_u32 v112, v100, 7, v101
    v_xor_b32 v113, 32, v112
    v_xor_b32 v114, 64, v112
    v_xor_b32 v115, 96, v112
    v_lshrrev_b32 v100, 5, v1
    v_lshlrev_b32 v100, 3, v100
    v_bfe_u32 v101, v1, 2, 2
    v_add_u32 v100, v100, v101
    v_bfe_u32 v102, v1, 4, 1
    v_and_b32 v103, 3, v1
    v_lshlrev_b32 v103, 3, v103
    v_mul_u32_u24 v116, 192, v100
    v_lshl_add_u32 v116, v102, 5, v116
    v_add_u32 v116, v116, v103
    s_min_u32 s47, s45, 2
    s_lshl_b32 s47, s47, 6
    s_add_u32 s47, s47, 16384
    v_add_u32 v116, s47, v116
    v_mul_u32_u24 v3, 192, v100
    v_mul_u32_u24 v102, 12320, v102
    v_add3_u32 v3, v3, v102, v103
    v_add_u32 v3, 132096, v3
    v_lshrrev_b32 v100, 4, v1
    v_cmp_eq_u32 vcc, v100, v101
    v_mov_b32 v101, 0x3f803f80
    v_mov_b32 v7, 156736
    v_cndmask_b32 v124, 0, v101, vcc
    v_mov_b32 v125, v124
    v_mov_b32 v126, v124
    v_mov_b32 v127, v124
    s_mov_b64 s[16:17], s[76:77]
    s_mov_b32 s18, 1409024
    s_mov_b32 s19, 0x00020000
    s_mov_b64 s[20:21], s[78:79]
    s_mov_b32 s22, 1409024
    s_mov_b32 s23, 0x00020000
    s_mov_b64 s[24:25], s[80:81]
    s_mov_b32 s26, 1409024
    s_mov_b32 s27, 0x00020000
    s_mov_b64 s[28:29], s[72:73]
    s_mov_b32 s30, 524288
    s_mov_b32 s31, 0x00020000
    s_mov_b64 s[36:37], s[82:83]
    s_mov_b32 s38, 2097152
    s_mov_b32 s39, 0x00020000
    s_lshl_b32 s47, s51, 7
    s_add_u32 m0, s54, 66048
    s_add_u32 s47, s47, s52
    buffer_load_dwordx4 v117, s[8:11], s47 offen lds
    s_add_u32 m0, s54, 67072
    s_mul_i32 s48, s51, 196608
    buffer_load_dwordx4 v118, s[8:11], s47 offen lds
    s_add_u32 m0, s54, 68096
    s_add_u32 s47, s47, 16384
    buffer_load_dwordx4 v117, s[8:11], s47 offen lds
    s_add_u32 m0, s54, 69120
    s_add_u32 s48, s48, s53
    buffer_load_dwordx4 v118, s[8:11], s47 offen lds
    s_add_u32 m0, s55, 66048
    s_add_u32 s51, s51, 1
    buffer_load_dwordx4 v60, s[12:15], s48 offen lds
    s_add_u32 m0, s55, 67072
    s_nop 0
    buffer_load_dwordx4 v61, s[12:15], s48 offen lds
    s_add_u32 m0, s55, 68096
    s_nop 0
    buffer_load_dwordx4 v62, s[12:15], s48 offen lds
    s_and_b32 s51, s51, 7
    v_and_b32 v107, 28, v1
    v_and_b32 v108, 31, v1
    v_add_u32 v107, v107, v108
    s_lshl_b32 s50, s43, 2
    s_add_u32 s50, s50, s45
    s_lshl_b32 s50, s50, 10
    s_add_u32 s50, s50, 14155776
    v_lshl_add_u32 v107, v107, 4, s50
    v_add_u32 v100, 0, v1
    v_mul_u32_u24 v101, 43691, v100
    v_lshrrev_b32 v101, 19, v101
    v_mul_u32_u24 v102, 12, v101
    v_sub_u32 v102, v100, v102
    v_mul_u32_u24 v101, 2752, v101
    v_lshl_add_u32 v4, v102, 4, v101
    v_cmp_le_u32 vcc, 10, v102
    v_mov_b32 v100, 1073741824
    s_nop 0
    v_cndmask_b32 v4, v4, v100, vcc
    v_add_u32 v100, 64, v1
    v_mul_u32_u24 v101, 43691, v100
    v_lshrrev_b32 v101, 19, v101
    v_mul_u32_u24 v102, 12, v101
    v_sub_u32 v102, v100, v102
    v_mul_u32_u24 v101, 2752, v101
    v_lshl_add_u32 v5, v102, 4, v101
    v_cmp_le_u32 vcc, 10, v102
    v_mov_b32 v100, 1073741824
    s_nop 0
    v_cndmask_b32 v5, v5, v100, vcc
    v_add_u32 v100, 128, v1
    v_mul_u32_u24 v101, 43691, v100
    v_lshrrev_b32 v101, 19, v101
    v_mul_u32_u24 v102, 12, v101
    v_sub_u32 v102, v100, v102
    v_mul_u32_u24 v101, 2752, v101
    v_lshl_add_u32 v6, v102, 4, v101
    v_cmp_le_u32 vcc, 10, v102
    v_mov_b32 v100, 1073741824
    s_nop 0
    v_cndmask_b32 v6, v6, v100, vcc
    s_mul_i32 s56, s44, 160
    s_mul_i32 s50, s45, 44032
    s_add_u32 s56, s56, s50
    s_add_u32 s56, s56, 1536
    s_mul_i32 s57, s45, 3072
    v_and_b32 v100, 15, v1
    v_bfe_u32 v101, v1, 4, 1
    v_lshl_add_u32 v100, v100, 1, v101
    v_lshrrev_b32 v101, 5, v1
    v_lshlrev_b32 v101, 30, v101
    v_lshl_add_u32 v99, v100, 3, v101
    s_waitcnt vmcnt(7)
    s_waitcnt lgkmcnt(0)
    s_barrier
    ds_read_b128 v[128:131], v112 offset:33024
    ds_read_b128 v[132:135], v113 offset:33024
    ds_read_b128 v[136:139], v114 offset:33024
    ds_read_b128 v[140:143], v115 offset:33024
    ds_read_b64_tr_b16 v[64:65], v116 offset:33024
    ds_read_b64_tr_b16 v[66:67], v116 offset:33792
    ds_read_b64_tr_b16 v[68:69], v116 offset:36096
    ds_read_b64_tr_b16 v[70:71], v116 offset:36864
    ds_read_b64_tr_b16 v[72:73], v116 offset:39168
    ds_read_b64_tr_b16 v[74:75], v116 offset:39936
    ds_read_b64_tr_b16 v[76:77], v116 offset:42240
    ds_read_b64_tr_b16 v[78:79], v116 offset:43008
    s_lshl_b32 s47, s51, 7
    s_add_u32 m0, s54, 99072
    s_add_u32 s47, s47, s52
    buffer_load_dwordx4 v117, s[8:11], s47 offen lds
    v_readfirstlane_b32 s58, v106
    s_add_u32 m0, s54, 100096
    s_mul_i32 s48, s51, 196608
    buffer_load_dwordx4 v118, s[8:11], s47 offen lds
    s_mul_i32 s58, s58, 0x9e3779b1
    s_add_u32 s58, s58, 0x7f4a7c15
    s_add_u32 m0, s54, 101120
    s_add_u32 s47, s47, 16384
    buffer_load_dwordx4 v117, s[8:11], s47 offen lds
    s_waitcnt lgkmcnt(0)
    v_mfma_f32_16x16x32_bf16 v[120:123], v[124:127], v[64:67], 0
    v_mfma_f32_16x16x32_bf16 v[120:123], v[124:127], v[68:71], v[120:123]
    v_mfma_f32_16x16x32_bf16 v[120:123], v[124:127], v[72:75], v[120:123]
    v_mfma_f32_16x16x32_bf16 v[120:123], v[124:127], v[76:79], v[120:123]
    s_add_u32 m0, s54, 102144
    s_add_u32 s48, s48, s53
    buffer_load_dwordx4 v118, s[8:11], s47 offen lds
    s_nop 4
    v_mov_b32 v122, v120
    v_mov_b32 v121, s58
    s_add_u32 m0, s55, 99072
    s_add_u32 s51, s51, 1
    buffer_load_dwordx4 v60, s[12:15], s48 offen lds
    v_permlane32_swap_b32 v120, v122
    s_lshl_b32 s50, s63, 8
    s_add_u32 s50, s50, 15728640
    v_add_f32 v120, v120, v122
    buffer_store_dwordx2 v[120:121], v99, s[32:35], s50 offen sc1
    s_add_u32 m0, s55, 100096
    s_nop 0
    buffer_load_dwordx4 v61, s[12:15], s48 offen lds
    s_add_u32 m0, s55, 101120
    s_nop 0
    buffer_load_dwordx4 v62, s[12:15], s48 offen lds
    s_and_b32 s51, s51, 7
    s_lshl_b32 s47, s51, 7
    s_add_u32 m0, s54, 0
    s_add_u32 s47, s47, s52
    buffer_load_dwordx4 v117, s[8:11], s47 offen lds
    s_add_u32 m0, s54, 1024
    s_mul_i32 s48, s51, 196608
    buffer_load_dwordx4 v118, s[8:11], s47 offen lds
    s_add_u32 m0, s54, 2048
    s_add_u32 s47, s47, 16384
    buffer_load_dwordx4 v117, s[8:11], s47 offen lds
    s_add_u32 m0, s54, 3072
    s_add_u32 s48, s48, s53
    buffer_load_dwordx4 v118, s[8:11], s47 offen lds
    s_waitcnt vmcnt(12)
    s_waitcnt lgkmcnt(0)
    s_barrier
    v_add_u32 v112, 66048, v112
    v_add_u32 v113, 66048, v113
    v_add_u32 v114, 66048, v114
    v_add_u32 v115, 66048, v115
    ds_read_b128 v[144:147], v112 offset:0
    ds_read_b128 v[148:151], v113 offset:0
    ds_read_b128 v[152:155], v114 offset:0
    ds_read_b128 v[156:159], v115 offset:0
    s_add_u32 m0, s55, 0
    s_add_u32 s51, s51, 1
    buffer_load_dwordx4 v60, s[12:15], s48 offen lds
    s_and_b32 s50, s60, 7
    v_xor_b32 v100, s50, v1
    s_and_b32 s50, s60, 28
    s_add_u32 s50, s50, s45
    s_lshl_b32 s50, s50, 6
    v_add_u32 v100, s50, v100
    s_lshl2_add_u32 s50, s44, s45
    s_lshl_b32 s50, s50, 6
    s_add_u32 s50, s50, s43
    v_mov_b32 v101, s50
    s_lshl_b32 s49, s61, 1
    s_and_b32 s50, s60, 6
    s_xor_b32 s49, s49, s50
    s_lshl_b32 s49, 3, s49
    s_or_b32 vcc_lo, s49, 0x101
    s_mov_b32 vcc_hi, 0
    v_cndmask_b32 v100, v101, v100, vcc
    s_add_u32 m0, s55, 1024
    s_nop 0
    buffer_load_dwordx4 v61, s[12:15], s48 offen lds
    s_and_b32 s49, s44, 4
    s_add_u32 s50, s44, s49
    s_lshl2_add_u32 s50, s46, s50
    s_andn2_b32 s50, s50, 1
    s_lshl1_add_u32 s50, s50, s45
    s_lshl_b32 s50, s50, 6
    s_add_u32 s50, s50, s43
    v_writelane_b32 v100, s50, 63
    v_lshlrev_b32 v106, 7, v100
    v_add_u32 v106, 14229504, v106
    s_add_u32 m0, s55, 2048
    s_nop 0
    buffer_load_dwordx4 v62, s[12:15], s48 offen lds
    s_and_b32 s51, s51, 7
    s_add_u32 s65, s63, 0
    s_and_b32 s65, s65, 7
    s_mul_i32 s65, s65, 176128
    s_add_u32 m0, s57, 132096
    s_add_u32 s65, s65, s56
    buffer_load_dwordx4 v4, s[16:19], s65 offen lds
    s_add_u32 m0, s57, 133120
    s_nop 0
    buffer_load_dwordx4 v5, s[16:19], s65 offen lds
    s_waitcnt vmcnt(9)
    s_waitcnt lgkmcnt(0)
    s_barrier
    ds_read_b128 v[160:163], v112 offset:33024
    ds_read_b128 v[164:167], v113 offset:33024
    ds_read_b128 v[168:171], v114 offset:33024
    ds_read_b128 v[172:175], v115 offset:33024
    s_lshl_b32 s47, s51, 7
    s_add_u32 m0, s54, 33024
    s_add_u32 s47, s47, s52
    buffer_load_dwordx4 v117, s[8:11], s47 offen lds
    s_add_u32 m0, s54, 34048
    s_mul_i32 s48, s51, 196608
    buffer_load_dwordx4 v118, s[8:11], s47 offen lds
    s_add_u32 m0, s54, 35072
    s_add_u32 s47, s47, 16384
    buffer_load_dwordx4 v117, s[8:11], s47 offen lds
    s_add_u32 m0, s54, 36096
    s_add_u32 s48, s48, s53
    buffer_load_dwordx4 v118, s[8:11], s47 offen lds
    s_add_u32 m0, s55, 33024
    s_add_u32 s51, s51, 1
    buffer_load_dwordx4 v60, s[12:15], s48 offen lds
    s_add_u32 m0, s55, 34048
    s_nop 0
    buffer_load_dwordx4 v61, s[12:15], s48 offen lds
    s_add_u32 m0, s55, 35072
    s_nop 0
    buffer_load_dwordx4 v62, s[12:15], s48 offen lds
    s_and_b32 s51, s51, 7
    s_add_u32 m0, s57, 134144
    s_nop 0
    buffer_load_dwordx4 v6, s[16:19], s65 offen lds
    s_add_u32 m0, s57, 144416
    s_nop 0
    buffer_load_dwordx4 v4, s[20:23], s65 offen lds
    s_waitcnt vmcnt(11)
    s_waitcnt lgkmcnt(0)
    s_barrier
    v_subrev_u32 v112, 66048, v112
    v_subrev_u32 v113, 66048, v113
    v_subrev_u32 v114, 66048, v114
    v_subrev_u32 v115, 66048, v115
    ds_read_b128 v[176:179], v112 offset:0
    ds_read_b128 v[180:183], v113 offset:0
    ds_read_b128 v[184:187], v114 offset:0
    ds_read_b128 v[188:191], v115 offset:0
    s_lshl_b32 s47, s51, 7
    s_add_u32 m0, s54, 66048
    s_add_u32 s47, s47, s52
    buffer_load_dwordx4 v117, s[8:11], s47 offen lds
    s_add_u32 m0, s54, 67072
    s_mul_i32 s48, s51, 196608
    buffer_load_dwordx4 v118, s[8:11], s47 offen lds
    s_add_u32 m0, s54, 68096
    s_add_u32 s47, s47, 16384
    buffer_load_dwordx4 v117, s[8:11], s47 offen lds
    s_add_u32 m0, s54, 69120
    s_add_u32 s48, s48, s53
    buffer_load_dwordx4 v118, s[8:11], s47 offen lds
    s_add_u32 m0, s55, 66048
    s_add_u32 s51, s51, 1
    buffer_load_dwordx4 v60, s[12:15], s48 offen lds
    s_add_u32 m0, s55, 67072
    s_nop 0
    buffer_load_dwordx4 v61, s[12:15], s48 offen lds
    s_add_u32 m0, s55, 68096
    s_nop 0
    buffer_load_dwordx4 v62, s[12:15], s48 offen lds
    s_and_b32 s51, s51, 7
    s_add_u32 m0, s57, 145440
    s_nop 0
    buffer_load_dwordx4 v5, s[20:23], s65 offen lds
    s_add_u32 m0, s57, 146464
    s_nop 0
    buffer_load_dwordx4 v6, s[20:23], s65 offen lds
    s_waitcnt vmcnt(11)
    s_waitcnt lgkmcnt(0)
    s_barrier
    ds_read_b128 v[192:195], v112 offset:33024
    ds_read_b128 v[196:199], v113 offset:33024
    ds_read_b128 v[200:203], v114 offset:33024
    ds_read_b128 v[204:207], v115 offset:33024
    s_lshl_b32 s47, s51, 7
    s_add_u32 m0, s54, 99072
    s_add_u32 s47, s47, s52
    buffer_load_dwordx4 v117, s[8:11], s47 offen lds
    s_add_u32 m0, s54, 100096
    s_mul_i32 s48, s51, 196608
    buffer_load_dwordx4 v118, s[8:11], s47 offen lds
    s_add_u32 m0, s54, 101120
    s_add_u32 s47, s47, 16384
    buffer_load_dwordx4 v117, s[8:11], s47 offen lds
    s_add_u32 m0, s54, 102144
    s_add_u32 s48, s48, s53
    buffer_load_dwordx4 v118, s[8:11], s47 offen lds
    s_add_u32 m0, s55, 99072
    s_add_u32 s51, s51, 1
    buffer_load_dwordx4 v60, s[12:15], s48 offen lds
    s_add_u32 m0, s55, 100096
    s_nop 0
    buffer_load_dwordx4 v61, s[12:15], s48 offen lds
    s_add_u32 m0, s55, 101120
    s_nop 0
    buffer_load_dwordx4 v62, s[12:15], s48 offen lds
    s_and_b32 s51, s51, 7
    s_waitcnt vmcnt(9)
    s_waitcnt lgkmcnt(0)
    s_barrier
    v_add_u32 v112, 66048, v112
    v_add_u32 v113, 66048, v113
    v_add_u32 v114, 66048, v114
    v_add_u32 v115, 66048, v115
    ds_read_b128 v[208:211], v112 offset:0
    ds_read_b128 v[212:215], v113 offset:0
    ds_read_b128 v[216:219], v114 offset:0
    ds_read_b128 v[220:223], v115 offset:0
    buffer_load_dwordx4 v[108:111], v107, s[32:35], 0 offen sc1
    s_lshl_b32 s50, s67, 8
    s_add_u32 s50, s50, 15728640
    buffer_load_dwordx4 v[48:51], v2, s[32:35], s50 offen offset:0 sc1
    buffer_load_dwordx4 v[52:55], v2, s[32:35], s50 offen offset:1024 sc1
    buffer_load_dword v56, v106, s[32:35], 0 offen sc1
    s_lshl_b32 s47, s51, 7
    s_add_u32 m0, s54, 0
    s_add_u32 s47, s47, s52
    buffer_load_dwordx4 v117, s[8:11], s47 offen lds
    s_add_u32 m0, s54, 1024
    s_mul_i32 s48, s51, 196608
    buffer_load_dwordx4 v118, s[8:11], s47 offen lds
    s_add_u32 m0, s54, 2048
    s_add_u32 s47, s47, 16384
    buffer_load_dwordx4 v117, s[8:11], s47 offen lds
    s_add_u32 m0, s54, 3072
    s_add_u32 s48, s48, s53
    buffer_load_dwordx4 v118, s[8:11], s47 offen lds
    s_add_u32 m0, s55, 0
    s_add_u32 s51, s51, 1
    buffer_load_dwordx4 v60, s[12:15], s48 offen lds
    s_add_u32 m0, s55, 1024
    s_nop 0
    buffer_load_dwordx4 v61, s[12:15], s48 offen lds
    s_add_u32 m0, s55, 2048
    s_nop 0
    buffer_load_dwordx4 v62, s[12:15], s48 offen lds
    s_and_b32 s51, s51, 7
    s_waitcnt vmcnt(11)
    s_waitcnt lgkmcnt(0)
    s_barrier
    ds_read_b128 v[224:227], v112 offset:33024
    ds_read_b128 v[228:231], v113 offset:33024
    ds_read_b128 v[232:235], v114 offset:33024
    ds_read_b128 v[236:239], v115 offset:33024
    s_add_u32 s65, s63, 1
    s_and_b32 s65, s65, 7
    s_mul_i32 s65, s65, 176128
    s_add_u32 m0, s57, 33024
    s_add_u32 s65, s65, s56
    buffer_load_dwordx4 v4, s[16:19], s65 offen lds
    s_lshl_b32 s50, s45, 5
    v_add_u32 v100, s50, v3
    v_lshrrev_b32 v101, 5, v1
    v_lshl_add_u32 v101, v101, 30, v2
    ds_read_b64_tr_b16 v[64:65], v100 offset:0
    ds_read_b64_tr_b16 v[66:67], v100 offset:768
    ds_read_b64_tr_b16 v[68:69], v100 offset:3072
    ds_read_b64_tr_b16 v[70:71], v100 offset:3840
    ds_read_b64_tr_b16 v[72:73], v100 offset:6144
    ds_read_b64_tr_b16 v[74:75], v100 offset:6912
    s_add_u32 m0, s57, 34048
    s_nop 0
    buffer_load_dwordx4 v5, s[16:19], s65 offen lds
    ds_read_b64_tr_b16 v[76:77], v100 offset:9216
    ds_read_b64_tr_b16 v[78:79], v100 offset:9984
    ds_read_b64_tr_b16 v[80:81], v100 offset:128
    ds_read_b64_tr_b16 v[82:83], v100 offset:896
    ds_read_b64_tr_b16 v[84:85], v100 offset:3200
    ds_read_b64_tr_b16 v[86:87], v100 offset:3968
    ds_read_b64_tr_b16 v[88:89], v100 offset:6272
    ds_read_b64_tr_b16 v[90:91], v100 offset:7040
    ds_read_b64_tr_b16 v[92:93], v100 offset:9344
    ds_read_b64_tr_b16 v[94:95], v100 offset:10112
    s_add_u32 m0, s57, 35072
    s_nop 0
    buffer_load_dwordx4 v6, s[16:19], s65 offen lds
    s_waitcnt lgkmcnt(0)
    v_mfma_f32_16x16x32_bf16 v[120:123], v[124:127], v[64:67], 0
    v_mfma_f32_16x16x32_bf16 v[96:99], v[124:127], v[80:83], 0
    v_mfma_f32_16x16x32_bf16 v[120:123], v[124:127], v[68:71], v[120:123]
    v_mfma_f32_16x16x32_bf16 v[96:99], v[124:127], v[84:87], v[96:99]
    v_mfma_f32_16x16x32_bf16 v[120:123], v[124:127], v[72:75], v[120:123]
    v_mfma_f32_16x16x32_bf16 v[96:99], v[124:127], v[88:91], v[96:99]
    v_mfma_f32_16x16x32_bf16 v[120:123], v[124:127], v[76:79], v[120:123]
    v_mfma_f32_16x16x32_bf16 v[96:99], v[124:127], v[92:95], v[96:99]
    s_add_u32 m0, s57, 45344
    s_nop 0
    buffer_load_dwordx4 v4, s[20:23], s65 offen lds
    s_nop 3
    v_mov_b32 v121, v120
    v_mov_b32 v122, v96
    v_mov_b32 v123, s58
    v_permlane32_swap_b32 v120, v121
    v_permlane32_swap_b32 v96, v122
    v_add_f32 v120, v120, v121
    s_add_u32 m0, s57, 46368
    s_nop 0
    buffer_load_dwordx4 v5, s[20:23], s65 offen lds
    v_add_f32 v122, v122, v96
    v_mov_b32 v121, s58
    s_lshl_b32 s50, s63, 9
    s_add_u32 s50, s50, 15990784
    buffer_store_dwordx4 v[120:123], v101, s[32:35], s50 offen sc1
    s_add_u32 m0, s57, 47392
    s_nop 0
    buffer_load_dwordx4 v6, s[20:23], s65 offen lds
    s_waitcnt vmcnt(7)
    s_waitcnt lgkmcnt(0)
    s_barrier
    s_setprio 3
    v_subrev_u32 v112, 66048, v112
    v_subrev_u32 v113, 66048, v113
    v_subrev_u32 v114, 66048, v114
    v_subrev_u32 v115, 66048, v115
    ds_read_b128 v[240:243], v112 offset:0
    ds_read_b128 v[244:247], v113 offset:0
    ds_read_b128 v[248:251], v114 offset:0
    ds_read_b128 v[252:255], v115 offset:0
    v_and_b32 v102, 31, v1
    s_lshl_b32 s49, s45, 7
    s_add_u32 s49, s49, 161088
    v_lshl_add_u32 v102, v102, 2, s49
    s_lshl_b32 s49, s45, 3
    s_add_u32 s49, s49, 156992
    v_lshl_add_u32 v103, v1, 5, s49
    v_xor_b32 v100, s58, v109
    v_xor_b32 v101, s58, v111
    v_or_b32 v100, v100, v101
    v_xor_b32 v101, s58, v56
    v_or_b32 v100, v100, v101
    v_xor_b32 v101, s58, v49
    v_or_b32 v100, v100, v101
    v_xor_b32 v101, s58, v51
    v_or_b32 v100, v100, v101
    v_xor_b32 v101, s58, v53
    v_or_b32 v100, v100, v101
    v_xor_b32 v101, s58, v55
    v_or_b32 v100, v100, v101
    v_cmp_ne_u32 vcc, 0, v100
    s_nop 0
    s_cbranch_vccz L_st_ok_1
L_st_sl_2:
    s_mov_b32 s62, 65536
    s_nop 15
L_st_lp_3:
    s_sleep 1
    buffer_load_dwordx4 v[108:111], v107, s[32:35], 0 offen sc1
    s_lshl_b32 s50, s67, 8
    s_add_u32 s50, s50, 15728640
    buffer_load_dwordx4 v[48:51], v2, s[32:35], s50 offen offset:0 sc1
    buffer_load_dwordx4 v[52:55], v2, s[32:35], s50 offen offset:1024 sc1
    buffer_load_dword v56, v106, s[32:35], 0 offen sc1
    s_sub_u32 s62, s62, 1
    s_waitcnt vmcnt(0)
    s_cbranch_scc1 L_st_ok_1
    v_xor_b32 v100, s58, v109
    v_xor_b32 v101, s58, v111
    v_or_b32 v100, v100, v101
    v_xor_b32 v101, s58, v56
    v_or_b32 v100, v100, v101
    v_xor_b32 v101, s58, v49
    v_or_b32 v100, v100, v101
    v_xor_b32 v101, s58, v51
    v_or_b32 v100, v100, v101
    v_xor_b32 v101, s58, v53
    v_or_b32 v100, v100, v101
    v_xor_b32 v101, s58, v55
    v_or_b32 v100, v100, v101
    v_cmp_ne_u32 vcc, 0, v100
    s_nop 0
    s_cbranch_vccnz L_st_lp_3
L_st_ok_1:
    v_add_f32 v48, v48, v52
    v_add_f32 v50, v50, v54
    v_rsq_f32 v109, v110
    ds_write_b32 v102, v108 offset:512
    ds_write_b32 v102, v110 offset:1024
    v_permlane16_swap_b32 v48, v50
    ds_write_b32 v102, v109
    v_add_f32 v48, v48, v50
    v_cvt_pk_bf16_f32 v104, v48, v48
    v_and_b32 v101, 0xffff0000, v104
    v_sub_f32 v101, v48, v101
    v_cvt_pk_bf16_f32 v105, v101, v101
    ds_write_b64 v103, v[104:105]
    s_mov_b64 exec, 1
    ds_add_u32 v7, v7 offset:0
    s_mov_b64 exec, -1
    s_waitcnt lgkmcnt(5)
    s_mov_b64 exec, 1
    ds_add_u32 v7, v7 offset:12
    s_mov_b64 exec, -1
    s_setprio 0
    s_setprio 0
    v_subrev_u32 v3, 49536, v3
    ds_read_b64_tr_b16 v[8:9], v3 offset:49536
    ds_read_b64_tr_b16 v[10:11], v3 offset:50304
    ds_read_b64_tr_b16 v[12:13], v3 offset:49568
    ds_read_b64_tr_b16 v[14:15], v3 offset:50336
    ds_read_b64_tr_b16 v[16:17], v3 offset:49600
    ds_read_b64_tr_b16 v[18:19], v3 offset:50368
    ds_read_b64_tr_b16 v[20:21], v3 offset:49632
    ds_read_b64_tr_b16 v[22:23], v3 offset:50400
    ds_read_b64_tr_b16 v[24:25], v3 offset:49664
    ds_read_b64_tr_b16 v[26:27], v3 offset:50432
    ds_read_b64_tr_b16 v[28:29], v3 offset:52608
    ds_read_b64_tr_b16 v[30:31], v3 offset:53376
    s_waitcnt lgkmcnt(10)
    v_mfma_f32_32x32x16_bf16 v[32:47], v[8:11], v[128:131], 0
    s_waitcnt vmcnt(0)
    s_mov_b64 exec, 1
    ds_add_u32 v7, v7 offset:68
    s_mov_b64 exec, -1
    s_add_u32 s65, s63, 2
    s_and_b32 s65, s65, 7
    s_mul_i32 s65, s65, 176128
    s_add_u32 m0, s57, 57664
    s_add_u32 s65, s65, s56
    buffer_load_dwordx4 v4, s[16:19], s65 offen lds
    ds_read_b64_tr_b16 v[8:9], v3 offset:52640
    ds_read_b64_tr_b16 v[10:11], v3 offset:53408
    s_waitcnt lgkmcnt(11)
    v_mfma_f32_32x32x16_bf16 v[48:63], v[12:15], v[128:131], 0
    s_add_u32 m0, s57, 58688
    s_nop 0
    buffer_load_dwordx4 v5, s[16:19], s65 offen lds
    ds_read_b64_tr_b16 v[12:13], v3 offset:52672
    ds_read_b64_tr_b16 v[14:15], v3 offset:53440
    s_waitcnt lgkmcnt(11)
    v_mfma_f32_32x32x16_bf16 v[64:79], v[16:19], v[128:131], 0
    ds_read_b32 v0, v7 offset:68
    s_add_u32 m0, s57, 59712
    s_nop 0
    buffer_load_dwordx4 v6, s[16:19], s65 offen lds
    ds_read_b64_tr_b16 v[16:17], v3 offset:52704
    ds_read_b64_tr_b16 v[18:19], v3 offset:53472
    s_waitcnt lgkmcnt(12)
    v_mfma_f32_32x32x16_bf16 v[80:95], v[20:23], v[128:131], 0
    s_add_u32 m0, s57, 69984
    s_nop 0
    buffer_load_dwordx4 v4, s[20:23], s65 offen lds
    ds_read_b64_tr_b16 v[20:21], v3 offset:52736
    ds_read_b64_tr_b16 v[22:23], v3 offset:53504
    s_waitcnt lgkmcnt(12)
    v_mfma_f32_32x32x16_bf16 v[96:111], v[24:27], v[128:131], 0
    s_add_u32 m0, s57, 71008
    s_nop 0
    buffer_load_dwordx4 v5, s[20:23], s65 offen lds
    ds_read_b64_tr_b16 v[24:25], v3 offset:55680
    ds_read_b64_tr_b16 v[26:27], v3 offset:56448
    s_waitcnt lgkmcnt(12)
    v_mfma_f32_32x32x16_bf16 v[32:47], v[28:31], v[132:135], v[32:47]
    s_add_u32 m0, s57, 72032
    s_nop 0
    buffer_load_dwordx4 v6, s[20:23], s65 offen lds
    ds_read_b64_tr_b16 v[28:29], v3 offset:55712
    ds_read_b64_tr_b16 v[30:31], v3 offset:56480
    s_waitcnt lgkmcnt(11)
    v_mfma_f32_32x32x16_bf16 v[48:63], v[8:11], v[132:135], v[48:63]
    ds_read_b64_tr_b16 v[8:9], v3 offset:55744
    ds_read_b64_tr_b16 v[10:11], v3 offset:56512
    s_waitcnt lgkmcnt(11)
    v_mfma_f32_32x32x16_bf16 v[64:79], v[12:15], v[132:135], v[64:79]
    s_waitcnt lgkmcnt(10)
    v_cmp_ne_u32 vcc, 626944, v0
    s_nop 0
    s_cbranch_vccz L_eBE0_ok_4
L_eBE0_sl_5:
    s_sleep 1
    ds_read_b32 v0, v7 offset:68
    s_waitcnt lgkmcnt(0)
    v_cmp_ne_u32 vcc, 626944, v0
    s_nop 0
    s_cbranch_vccnz L_eBE0_sl_5
L_eBE0_ok_4:
    ds_read_b64_tr_b16 v[12:13], v3 offset:55776
    ds_read_b64_tr_b16 v[14:15], v3 offset:56544
    s_waitcnt lgkmcnt(10)
    v_mfma_f32_32x32x16_bf16 v[80:95], v[16:19], v[132:135], v[80:95]
    ds_read_b64_tr_b16 v[16:17], v3 offset:55808
    ds_read_b64_tr_b16 v[18:19], v3 offset:56576
    s_waitcnt lgkmcnt(10)
    v_mfma_f32_32x32x16_bf16 v[96:111], v[20:23], v[132:135], v[96:111]
    ds_read_b64_tr_b16 v[20:21], v3 offset:58752
    ds_read_b64_tr_b16 v[22:23], v3 offset:59520
    s_waitcnt lgkmcnt(10)
    v_mfma_f32_32x32x16_bf16 v[32:47], v[24:27], v[136:139], v[32:47]
    ds_read_b64_tr_b16 v[24:25], v3 offset:58784
    ds_read_b64_tr_b16 v[26:27], v3 offset:59552
    s_waitcnt lgkmcnt(10)
    v_mfma_f32_32x32x16_bf16 v[48:63], v[28:31], v[136:139], v[48:63]
    ds_read_b64_tr_b16 v[28:29], v3 offset:58816
    ds_read_b64_tr_b16 v[30:31], v3 offset:59584
    s_waitcnt lgkmcnt(10)
    v_mfma_f32_32x32x16_bf16 v[64:79], v[8:11], v[136:139], v[64:79]
    ds_read_b64_tr_b16 v[8:9], v3 offset:58848
    ds_read_b64_tr_b16 v[10:11], v3 offset:59616
    s_waitcnt lgkmcnt(10)
    v_mfma_f32_32x32x16_bf16 v[80:95], v[12:15], v[136:139], v[80:95]
    ds_read_b64_tr_b16 v[12:13], v3 offset:58880
    ds_read_b64_tr_b16 v[14:15], v3 offset:59648
    s_waitcnt lgkmcnt(10)
    v_mfma_f32_32x32x16_bf16 v[96:111], v[16:19], v[136:139], v[96:111]
    v_subrev_u32 v3, 49536, v3
    ds_read_b64_tr_b16 v[16:17], v3 offset:0
    ds_read_b64_tr_b16 v[18:19], v3 offset:768
    s_waitcnt lgkmcnt(10)
    v_mfma_f32_32x32x16_bf16 v[32:47], v[20:23], v[140:143], v[32:47]
    ds_read_b64_tr_b16 v[20:21], v3 offset:32
    ds_read_b64_tr_b16 v[22:23], v3 offset:800
    s_waitcnt lgkmcnt(10)
    v_mfma_f32_32x32x16_bf16 v[48:63], v[24:27], v[140:143], v[48:63]
    ds_read_b64_tr_b16 v[24:25], v3 offset:64
    ds_read_b64_tr_b16 v[26:27], v3 offset:832
    s_waitcnt lgkmcnt(10)
    v_mfma_f32_32x32x16_bf16 v[64:79], v[28:31], v[140:143], v[64:79]
    ds_read_b64_tr_b16 v[28:29], v3 offset:96
    ds_read_b64_tr_b16 v[30:31], v3 offset:864
    s_waitcnt lgkmcnt(10)
    v_mfma_f32_32x32x16_bf16 v[80:95], v[8:11], v[140:143], v[80:95]
    ds_read_b64_tr_b16 v[8:9], v3 offset:128
    ds_read_b64_tr_b16 v[10:11], v3 offset:896
    s_waitcnt lgkmcnt(10)
    v_mfma_f32_32x32x16_bf16 v[96:111], v[12:15], v[140:143], v[96:111]
    ds_read_b64_tr_b16 v[12:13], v3 offset:3072
    ds_read_b64_tr_b16 v[14:15], v3 offset:3840
    s_waitcnt lgkmcnt(10)
    v_mfma_f32_32x32x16_bf16 v[32:47], v[16:19], v[144:147], v[32:47]
    s_waitcnt vmcnt(0)
    s_mov_b64 exec, 1
    ds_add_u32 v7, v7 offset:72
    s_mov_b64 exec, -1
    s_setprio 3
    v_and_b32 v128, 31, v1
    s_lshl_b32 s50, s45, 7
    s_add_u32 s50, s50, 161088
    v_lshl_add_u32 v128, v128, 2, s50
    ds_read_b32 v138, v128 offset:0
    ds_read_b32 v139, v128 offset:512
    ds_read_b32 v136, v128 offset:1024
    s_setprio 0
    ds_read_b64_tr_b16 v[16:17], v3 offset:3104
    ds_read_b64_tr_b16 v[18:19], v3 offset:3872
    s_waitcnt lgkmcnt(14)
    v_mfma_f32_32x32x16_bf16 v[48:63], v[20:23], v[144:147], v[48:63]
    ds_read_b64_tr_b16 v[20:21], v3 offset:3136
    ds_read_b64_tr_b16 v[22:23], v3 offset:3904
    s_waitcnt lgkmcnt(14)
    v_mfma_f32_32x32x16_bf16 v[64:79], v[24:27], v[144:147], v[64:79]
    ds_read_b32 v0, v7 offset:72
    ds_read_b64_tr_b16 v[24:25], v3 offset:3168
    ds_read_b64_tr_b16 v[26:27], v3 offset:3936
    s_waitcnt lgkmcnt(15)
    v_mfma_f32_32x32x16_bf16 v[80:95], v[28:31], v[144:147], v[80:95]
    ds_read_b64_tr_b16 v[28:29], v3 offset:3200
    ds_read_b64_tr_b16 v[30:31], v3 offset:3968
    s_waitcnt lgkmcnt(15)
    v_mfma_f32_32x32x16_bf16 v[96:111], v[8:11], v[144:147], v[96:111]
    s_setprio 3
    s_waitcnt lgkmcnt(9)
    v_cvt_pk_bf16_f32 v128, v139, v139
    v_mul_f32 v137, v138, v138
    v_and_b32 v128, 0xffff0000, v128
    s_setprio 0
    ds_read_b64_tr_b16 v[8:9], v3 offset:6144
    ds_read_b64_tr_b16 v[10:11], v3 offset:6912
    v_mfma_f32_32x32x16_bf16 v[32:47], v[12:15], v[148:151], v[32:47]
    s_setprio 3
    v_mul_f32 v137, v137, v138
    v_sub_f32 v128, v139, v128
    v_mul_f32 v137, 0xbdd2d3e8, v137
    v_cvt_pk_bf16_f32 v140, v139, v128
    s_setprio 0
    ds_read_b64_tr_b16 v[12:13], v3 offset:6176
    ds_read_b64_tr_b16 v[14:15], v3 offset:6944
    s_waitcnt lgkmcnt(11)
    v_mfma_f32_32x32x16_bf16 v[48:63], v[16:19], v[148:151], v[48:63]
    s_setprio 3
    v_mul_f32 v138, 0xc0135761, v138
    v_mov_b32 v141, v140
    v_mov_b32 v142, 0
    v_mov_b32 v143, 0
    s_setprio 0
    ds_read_b64_tr_b16 v[16:17], v3 offset:6208
    ds_read_b64_tr_b16 v[18:19], v3 offset:6976
    s_waitcnt lgkmcnt(11)
    v_mfma_f32_32x32x16_bf16 v[64:79], v[20:23], v[148:151], v[64:79]
    s_waitcnt lgkmcnt(10)
    s_setprio 3
    v_cmp_ne_u32 vcc, 626944, v0
    s_setprio 0
    s_cbranch_vccz L_eBE1_ok_7
L_eBE1_sl_8:
    s_sleep 1
    ds_read_b32 v0, v7 offset:72
    s_waitcnt lgkmcnt(0)
    s_setprio 3
    v_cmp_ne_u32 vcc, 626944, v0
    s_setprio 0
    s_cbranch_vccnz L_eBE1_sl_8
L_eBE1_ok_7:
    s_setprio 3
    s_and_b32 s47, s60, 28
    s_add_u32 s47, s47, s45
    s_mul_i32 s47, s47, 8192
    s_add_u32 s47, s47, 14225408
    s_and_b32 s50, s60, 7
    v_xor_b32 v134, s50, v1
    v_lshl_add_u32 v134, v134, 7, s47
    s_mov_b32 vcc_lo, 0xe0e0e0e
    s_mov_b32 vcc_hi, 0
    v_mov_b32 v135, 1073741824
    v_cndmask_b32 v134, v135, v134, vcc
    s_and_b32 s64, s60, 7
    s_lshl4_add_u32 s64, s60, s64
    s_lshl2_add_u32 s64, s64, s45
    s_lshl_b32 s64, s64, 10
    s_mul_i32 s54, s45, 2064
    s_mov_b32 s13, 3598
    s_setprio 0
    ds_read_b64_tr_b16 v[20:21], v3 offset:6240
    ds_read_b64_tr_b16 v[22:23], v3 offset:7008
    s_waitcnt lgkmcnt(10)
    v_mfma_f32_32x32x16_bf16 v[80:95], v[24:27], v[148:151], v[80:95]
    ds_read_b64_tr_b16 v[24:25], v3 offset:6272
    ds_read_b64_tr_b16 v[26:27], v3 offset:7040
    s_waitcnt lgkmcnt(10)
    v_mfma_f32_32x32x16_bf16 v[96:111], v[28:31], v[148:151], v[96:111]
    ds_read_b64_tr_b16 v[28:29], v3 offset:9216
    ds_read_b64_tr_b16 v[30:31], v3 offset:9984
    s_waitcnt lgkmcnt(10)
    v_mfma_f32_32x32x16_bf16 v[32:47], v[8:11], v[152:155], v[32:47]
    ds_read_b64_tr_b16 v[8:9], v3 offset:9248
    ds_read_b64_tr_b16 v[10:11], v3 offset:10016
    s_waitcnt lgkmcnt(10)
    v_mfma_f32_32x32x16_bf16 v[48:63], v[12:15], v[152:155], v[48:63]
    ds_read_b64_tr_b16 v[12:13], v3 offset:9280
    ds_read_b64_tr_b16 v[14:15], v3 offset:10048
    s_waitcnt lgkmcnt(10)
    v_mfma_f32_32x32x16_bf16 v[64:79], v[16:19], v[152:155], v[64:79]
    ds_read_b64_tr_b16 v[16:17], v3 offset:9312
    ds_read_b64_tr_b16 v[18:19], v3 offset:10080
    s_waitcnt lgkmcnt(10)
    v_mfma_f32_32x32x16_bf16 v[80:95], v[20:23], v[152:155], v[80:95]
    ds_read_b64_tr_b16 v[20:21], v3 offset:9344
    ds_read_b64_tr_b16 v[22:23], v3 offset:10112
    s_waitcnt lgkmcnt(10)
    v_mfma_f32_32x32x16_bf16 v[96:111], v[24:27], v[152:155], v[96:111]
    ds_read_b64_tr_b16 v[24:25], v3 offset:24640
    ds_read_b64_tr_b16 v[26:27], v3 offset:25408
    s_waitcnt lgkmcnt(10)
    v_mfma_f32_32x32x16_bf16 v[32:47], v[28:31], v[156:159], v[32:47]
    ds_read_b64_tr_b16 v[28:29], v3 offset:24672
    ds_read_b64_tr_b16 v[30:31], v3 offset:25440
    s_waitcnt lgkmcnt(10)
    v_mfma_f32_32x32x16_bf16 v[48:63], v[8:11], v[156:159], v[48:63]
    ds_read_b64_tr_b16 v[8:9], v3 offset:24704
    ds_read_b64_tr_b16 v[10:11], v3 offset:25472
    s_waitcnt lgkmcnt(10)
    v_mfma_f32_32x32x16_bf16 v[64:79], v[12:15], v[156:159], v[64:79]
    ds_read_b64_tr_b16 v[12:13], v3 offset:24736
    ds_read_b64_tr_b16 v[14:15], v3 offset:25504
    s_waitcnt lgkmcnt(10)
    v_mfma_f32_32x32x16_bf16 v[80:95], v[16:19], v[156:159], v[80:95]
    ds_read_b64_tr_b16 v[16:17], v3 offset:24768
    ds_read_b64_tr_b16 v[18:19], v3 offset:25536
    s_waitcnt lgkmcnt(10)
    v_mfma_f32_32x32x16_bf16 v[96:111], v[20:23], v[156:159], v[96:111]
    ds_read_b64_tr_b16 v[20:21], v3 offset:27712
    ds_read_b64_tr_b16 v[22:23], v3 offset:28480
    s_waitcnt lgkmcnt(10)
    v_mfma_f32_32x32x16_bf16 v[32:47], v[24:27], v[160:163], v[32:47]
    s_add_u32 s65, s63, 3
    s_and_b32 s65, s65, 7
    s_mul_i32 s65, s65, 176128
    s_add_u32 m0, s57, 82560
    s_add_u32 s65, s65, s56
    buffer_load_dwordx4 v4, s[16:19], s65 offen lds
    ds_read_b64_tr_b16 v[24:25], v3 offset:27744
    ds_read_b64_tr_b16 v[26:27], v3 offset:28512
    s_waitcnt lgkmcnt(10)
    v_mfma_f32_32x32x16_bf16 v[48:63], v[28:31], v[160:163], v[48:63]
    s_add_u32 m0, s57, 83584
    s_nop 0
    buffer_load_dwordx4 v5, s[16:19], s65 offen lds
    ds_read_b64_tr_b16 v[28:29], v3 offset:27776
    ds_read_b64_tr_b16 v[30:31], v3 offset:28544
    s_waitcnt lgkmcnt(10)
    v_mfma_f32_32x32x16_bf16 v[64:79], v[8:11], v[160:163], v[64:79]
    s_add_u32 m0, s57, 84608
    s_nop 0
    buffer_load_dwordx4 v6, s[16:19], s65 offen lds
    ds_read_b64_tr_b16 v[8:9], v3 offset:27808
    ds_read_b64_tr_b16 v[10:11], v3 offset:28576
    s_waitcnt lgkmcnt(10)
    v_mfma_f32_32x32x16_bf16 v[80:95], v[12:15], v[160:163], v[80:95]
    s_add_u32 m0, s57, 94880
    s_nop 0
    buffer_load_dwordx4 v4, s[20:23], s65 offen lds
    ds_read_b64_tr_b16 v[12:13], v3 offset:27840
    ds_read_b64_tr_b16 v[14:15], v3 offset:28608
    s_waitcnt lgkmcnt(10)
    v_mfma_f32_32x32x16_bf16 v[96:111], v[16:19], v[160:163], v[96:111]
    s_add_u32 m0, s57, 95904
    s_nop 0
    buffer_load_dwordx4 v5, s[20:23], s65 offen lds
    ds_read_b64_tr_b16 v[16:17], v3 offset:30784
    ds_read_b64_tr_b16 v[18:19], v3 offset:31552
    s_waitcnt lgkmcnt(10)
    v_mfma_f32_32x32x16_bf16 v[32:47], v[20:23], v[164:167], v[32:47]
    s_add_u32 m0, s57, 96928
    s_nop 0
    buffer_load_dwordx4 v6, s[20:23], s65 offen lds
    s_setprio 3
    v_lshlrev_b32 v144, 6, v1
    v_add_u32 v144, 156992, v144
    s_lshl_b32 s50, s45, 3
    v_add_u32 v145, s50, v144
    s_and_b32 s47, s60, 28
    s_add_u32 s47, s47, s45
    s_mul_i32 s47, s47, 8192
    s_add_u32 s47, s47, 14225408
    s_and_b32 s50, s60, 7
    v_xor_b32 v150, s50, v1
    v_lshl_add_u32 v150, v150, 7, s47
    s_setprio 0
    ds_read_b64_tr_b16 v[20:21], v3 offset:30816
    ds_read_b64_tr_b16 v[22:23], v3 offset:31584
    s_waitcnt lgkmcnt(10)
    v_mfma_f32_32x32x16_bf16 v[48:63], v[24:27], v[164:167], v[48:63]
    s_setprio 3
    s_mov_b32 vcc_lo, 0xf0f0f0f0
    s_mov_b32 vcc_hi, 0
    v_mov_b32 v151, 1073741824
    v_cndmask_b32 v150, v151, v150, vcc
    v_and_b32 v152, 31, v1
    v_mul_u32_u24 v152, 2064, v152
    v_add_u32 v152, 35072, v152
    s_setprio 0
    ds_read_b64_tr_b16 v[24:25], v3 offset:30848
    ds_read_b64_tr_b16 v[26:27], v3 offset:31616
    s_waitcnt lgkmcnt(10)
    v_mfma_f32_32x32x16_bf16 v[64:79], v[28:31], v[164:167], v[64:79]
    s_waitcnt vmcnt(0)
    s_mov_b64 exec, 1
    ds_add_u32 v7, v7 offset:76
    s_mov_b64 exec, -1
    s_setprio 3
    v_mov_b32 v156, 0x4d804d80
    v_mov_b32 v157, 0x4d804d80
    v_mov_b32 v158, 0x4d804d80
    v_mov_b32 v159, 0x4d804d80
    s_setprio 0
    ds_read_b64_tr_b16 v[28:29], v3 offset:30880
    ds_read_b64_tr_b16 v[30:31], v3 offset:31648
    s_waitcnt lgkmcnt(11)
    v_mfma_f32_32x32x16_bf16 v[80:95], v[8:11], v[164:167], v[80:95]
    buffer_load_dword v135, v134, s[32:35], 0 offen sc1
    s_setprio 3
    v_lshrrev_b32 v128, 3, v1
    v_bfe_u32 v129, v1, 4, 1
    v_lshlrev_b32 v128, 10, v128
    v_lshlrev_b32 v130, 2, v129
    s_setprio 0
    ds_read_b64_tr_b16 v[8:9], v3 offset:30912
    ds_read_b64_tr_b16 v[10:11], v3 offset:31680
    s_waitcnt lgkmcnt(11)
    v_mfma_f32_32x32x16_bf16 v[96:111], v[12:15], v[164:167], v[96:111]
    ds_read_b32 v0, v7 offset:76
    s_setprio 3
    v_xor_b32 v130, v130, v1
    v_and_b32 v130, 7, v130
    v_lshl_add_u32 v146, v130, 4, v128
    v_and_b32 v128, 31, v1
    s_setprio 0
    ds_read_b64_tr_b16 v[12:13], v3 offset:33856
    ds_read_b64_tr_b16 v[14:15], v3 offset:34624
    s_waitcnt lgkmcnt(12)
    v_mfma_f32_32x32x16_bf16 v[32:47], v[16:19], v[168:171], v[32:47]
    s_add_u32 s65, s63, 4
    s_and_b32 s65, s65, 7
    s_mul_i32 s65, s65, 176128
    s_add_u32 m0, s57, 107200
    s_add_u32 s65, s65, s56
    buffer_load_dwordx4 v4, s[16:19], s65 offen lds
    ds_read_b64_tr_b16 v[16:17], v3 offset:33888
    ds_read_b64_tr_b16 v[18:19], v3 offset:34656
    s_waitcnt lgkmcnt(12)
    v_mfma_f32_32x32x16_bf16 v[48:63], v[20:23], v[168:171], v[48:63]
    s_add_u32 m0, s57, 108224
    s_nop 0
    buffer_load_dwordx4 v5, s[16:19], s65 offen lds
    ds_read_b64_tr_b16 v[20:21], v3 offset:33920
    ds_read_b64_tr_b16 v[22:23], v3 offset:34688
    s_waitcnt lgkmcnt(12)
    v_mfma_f32_32x32x16_bf16 v[64:79], v[24:27], v[168:171], v[64:79]
    s_add_u32 m0, s57, 109248
    s_nop 0
    buffer_load_dwordx4 v6, s[16:19], s65 offen lds
    ds_read_b64_tr_b16 v[24:25], v3 offset:33952
    ds_read_b64_tr_b16 v[26:27], v3 offset:34720
    s_waitcnt lgkmcnt(11)
    v_mfma_f32_32x32x16_bf16 v[80:95], v[28:31], v[168:171], v[80:95]
    s_add_u32 m0, s57, 119520
    s_nop 0
    buffer_load_dwordx4 v4, s[20:23], s65 offen lds
    ds_read_b64_tr_b16 v[28:29], v3 offset:33984
    ds_read_b64_tr_b16 v[30:31], v3 offset:34752
    s_waitcnt lgkmcnt(11)
    v_mfma_f32_32x32x16_bf16 v[96:111], v[8:11], v[168:171], v[96:111]
    s_waitcnt lgkmcnt(10)
    s_setprio 3
    v_cmp_ne_u32 vcc, 626944, v0
    s_setprio 0
    s_cbranch_vccz L_eBE2_ok_10
L_eBE2_sl_11:
    s_sleep 1
    ds_read_b32 v0, v7 offset:76
    s_waitcnt lgkmcnt(0)
    s_setprio 3
    v_cmp_ne_u32 vcc, 626944, v0
    s_setprio 0
    s_cbranch_vccnz L_eBE2_sl_11
L_eBE2_ok_10:
    s_add_u32 m0, s57, 120544
    s_nop 0
    buffer_load_dwordx4 v5, s[20:23], s65 offen lds
    v_add_u32 v3, 49536, v3
    ds_read_b64_tr_b16 v[8:9], v3 offset:0
    ds_read_b64_tr_b16 v[10:11], v3 offset:768
    s_waitcnt lgkmcnt(10)
    v_mfma_f32_32x32x16_bf16 v[32:47], v[12:15], v[172:175], v[32:47]
    s_add_u32 m0, s57, 121568
    s_nop 0
    buffer_load_dwordx4 v6, s[20:23], s65 offen lds
    s_setprio 3
    v_lshrrev_b32 v130, 5, v1
    v_mul_u32_u24 v131, 262144, v130
    v_lshl_add_u32 v147, v128, 7, v131
    v_lshlrev_b32 v128, 10, v128
    s_setprio 0
    ds_read_b64_tr_b16 v[12:13], v3 offset:32
    ds_read_b64_tr_b16 v[14:15], v3 offset:800
    s_waitcnt lgkmcnt(10)
    v_mfma_f32_32x32x16_bf16 v[48:63], v[16:19], v[172:175], v[48:63]
    s_setprio 3
    v_lshl_add_u32 v148, v130, 4, v128
    v_bfe_u32 v128, v1, 2, 2
    v_lshl_add_u32 v128, v130, 2, v128
    v_lshlrev_b32 v128, 7, v128
    s_setprio 0
    ds_read_b64_tr_b16 v[16:17], v3 offset:64
    ds_read_b64_tr_b16 v[18:19], v3 offset:832
    s_waitcnt lgkmcnt(10)
    v_mfma_f32_32x32x16_bf16 v[64:79], v[20:23], v[172:175], v[64:79]
    s_setprio 3
    v_lshl_add_u32 v128, v129, 5, v128
    v_and_b32 v130, 1, v1
    v_lshl_add_u32 v128, v130, 4, v128
    v_bfe_u32 v130, v1, 1, 1
    s_setprio 0
    ds_read_b64_tr_b16 v[20:21], v3 offset:96
    ds_read_b64_tr_b16 v[22:23], v3 offset:864
    s_waitcnt lgkmcnt(10)
    v_mfma_f32_32x32x16_bf16 v[80:95], v[24:27], v[172:175], v[80:95]
    ds_read_b32 v0, v7 offset:12
    s_setprio 3
    v_lshl_add_u32 v128, v130, 3, v128
    v_bfe_u32 v130, v1, 3, 1
    v_lshl_add_u32 v149, v130, 6, v128
    s_setprio 0
    ds_read_b64_tr_b16 v[24:25], v3 offset:128
    ds_read_b64_tr_b16 v[26:27], v3 offset:896
    s_waitcnt lgkmcnt(11)
    v_mfma_f32_32x32x16_bf16 v[96:111], v[28:31], v[172:175], v[96:111]
    ds_read_b64_tr_b16 v[28:29], v3 offset:3072
    ds_read_b64_tr_b16 v[30:31], v3 offset:3840
    s_waitcnt lgkmcnt(11)
    v_mfma_f32_32x32x16_bf16 v[32:47], v[8:11], v[176:179], v[32:47]
    s_waitcnt lgkmcnt(4)
    s_setprio 3
    v_cmp_ne_u32 vcc, 1253888, v0
    s_setprio 0
    s_cbranch_vccz L_eAD_ok_13
L_eAD_sl_14:
    s_sleep 1
    ds_read_b32 v0, v7 offset:12
    s_waitcnt lgkmcnt(0)
    s_setprio 3
    v_cmp_ne_u32 vcc, 1253888, v0
    s_setprio 0
    s_cbranch_vccnz L_eAD_sl_14
L_eAD_ok_13:
    s_waitcnt vmcnt(6)
    s_setprio 3
    v_cmp_eq_u32 vcc, s58, v135
    s_lshr_b32 s12, vcc_lo, 16
    s_and_b32 s12, s12, vcc_lo
    s_and_b32 s12, s12, s13
    s_bcnt1_i32_b32 s47, s12
    s_cmp_lt_u32 s47, 2
    s_cbranch_scc0 L_fa1_ok_16
L_fa1_sl_17:
    s_mov_b32 s62, 65536
    s_nop 15
L_fa1_lp_18:
    s_sleep 4
    buffer_load_dword v135, v134, s[32:35], 0 offen sc1
    s_sub_u32 s62, s62, 1
    s_waitcnt vmcnt(0)
    s_cbranch_scc1 L_fa1_ok_16
    v_cmp_eq_u32 vcc, s58, v135
    s_lshr_b32 s12, vcc_lo, 16
    s_and_b32 s12, s12, vcc_lo
    s_and_b32 s12, s12, s13
    s_bcnt1_i32_b32 s47, s12
    s_cmp_lt_u32 s47, 2
    s_cbranch_scc1 L_fa1_lp_18
L_fa1_ok_16:
    s_setprio 0
    s_ff1_i32_b32 s14, s12
    s_bitset0_b32 s12, s14
    s_bitset0_b32 s13, s14
    s_lshl_b32 s14, s14, 12
    s_xor_b32 s14, s14, s64
    s_add_u32 m0, s54, 16512
    s_add_u32 s47, s14, 2097152
    buffer_load_dwordx4 v2, s[32:35], s47 offen sc1 lds
    ds_read_b64_tr_b16 v[8:9], v3 offset:3104
    ds_read_b64_tr_b16 v[10:11], v3 offset:3872
    v_mfma_f32_32x32x16_bf16 v[48:63], v[12:15], v[176:179], v[48:63]
    s_add_u32 m0, s54, 17536
    s_add_u32 s47, s14, 4194304
    buffer_load_dwordx4 v2, s[32:35], s47 offen sc1 lds
    ds_read_b64_tr_b16 v[12:13], v3 offset:3136
    ds_read_b64_tr_b16 v[14:15], v3 offset:3904
    v_mfma_f32_32x32x16_bf16 v[64:79], v[16:19], v[176:179], v[64:79]
    s_ff1_i32_b32 s14, s12
    s_bitset0_b32 s12, s14
    s_bitset0_b32 s13, s14
    s_lshl_b32 s14, s14, 12
    s_xor_b32 s14, s14, s64
    s_add_u32 m0, s54, 24768
    s_add_u32 s47, s14, 2097152
    buffer_load_dwordx4 v2, s[32:35], s47 offen sc1 lds
    ds_read_b64_tr_b16 v[16:17], v3 offset:3168
    ds_read_b64_tr_b16 v[18:19], v3 offset:3936
    v_mfma_f32_32x32x16_bf16 v[80:95], v[20:23], v[176:179], v[80:95]
    s_add_u32 m0, s54, 25792
    s_add_u32 s47, s14, 4194304
    buffer_load_dwordx4 v2, s[32:35], s47 offen sc1 lds
    s_mov_b32 s12, s13
    ds_read_b64_tr_b16 v[20:21], v3 offset:3200
    ds_read_b64_tr_b16 v[22:23], v3 offset:3968
    s_waitcnt lgkmcnt(10)
    v_mfma_f32_32x32x16_bf16 v[96:111], v[24:27], v[176:179], v[96:111]
    s_add_u32 s65, s63, 5
    s_and_b32 s65, s65, 7
    s_mul_i32 s65, s65, 176128
    s_add_u32 m0, s57, 132096
    s_add_u32 s65, s65, s56
    buffer_load_dwordx4 v4, s[16:19], s65 offen lds
    ds_read_b64_tr_b16 v[24:25], v3 offset:6144
    ds_read_b64_tr_b16 v[26:27], v3 offset:6912
    s_waitcnt lgkmcnt(10)
    v_mfma_f32_32x32x16_bf16 v[32:47], v[28:31], v[180:183], v[32:47]
    s_add_u32 m0, s57, 133120
    s_nop 0
    buffer_load_dwordx4 v5, s[16:19], s65 offen lds
    ds_read_b64_tr_b16 v[28:29], v3 offset:6176
    ds_read_b64_tr_b16 v[30:31], v3 offset:6944
    s_waitcnt lgkmcnt(10)
    v_mfma_f32_32x32x16_bf16 v[48:63], v[8:11], v[180:183], v[48:63]
    s_add_u32 m0, s57, 134144
    s_nop 0
    buffer_load_dwordx4 v6, s[16:19], s65 offen lds
    ds_read_b64_tr_b16 v[8:9], v3 offset:6208
    ds_read_b64_tr_b16 v[10:11], v3 offset:6976
    s_waitcnt lgkmcnt(10)
    v_mfma_f32_32x32x16_bf16 v[64:79], v[12:15], v[180:183], v[64:79]
    s_waitcnt vmcnt(7)
    s_mov_b64 exec, 1
    ds_add_u32 v7, v7 offset:80
    s_mov_b64 exec, -1
    s_add_u32 m0, s57, 144416
    s_nop 0
    buffer_load_dwordx4 v4, s[20:23], s65 offen lds
    ds_read_b64_tr_b16 v[12:13], v3 offset:6240
    ds_read_b64_tr_b16 v[14:15], v3 offset:7008
    s_waitcnt lgkmcnt(11)
    v_mfma_f32_32x32x16_bf16 v[80:95], v[16:19], v[180:183], v[80:95]
    s_add_u32 m0, s57, 145440
    s_nop 0
    buffer_load_dwordx4 v5, s[20:23], s65 offen lds
    ds_read_b64_tr_b16 v[16:17], v3 offset:6272
    ds_read_b64_tr_b16 v[18:19], v3 offset:7040
    s_waitcnt lgkmcnt(11)
    v_mfma_f32_32x32x16_bf16 v[96:111], v[20:23], v[180:183], v[96:111]
    ds_read_b32 v0, v7 offset:80
    s_add_u32 m0, s57, 146464
    s_nop 0
    buffer_load_dwordx4 v6, s[20:23], s65 offen lds
    s_setprio 3
    s_lshl_b32 s50, s67, 9
    s_add_u32 s50, s50, 15990784
    buffer_load_dwordx4 v[160:163], v2, s[32:35], s50 offen offset:0 sc1
    buffer_load_dwordx4 v[164:167], v2, s[32:35], s50 offen offset:1024 sc1
    buffer_load_dwordx4 v[168:171], v2, s[32:35], s50 offen offset:2048 sc1
    buffer_load_dwordx4 v[172:175], v2, s[32:35], s50 offen offset:3072 sc1
    s_setprio 0
    ds_read_b64_tr_b16 v[20:21], v3 offset:9216
    ds_read_b64_tr_b16 v[22:23], v3 offset:9984
    s_waitcnt lgkmcnt(12)
    v_mfma_f32_32x32x16_bf16 v[32:47], v[24:27], v[184:187], v[32:47]
    ds_read_b64_tr_b16 v[24:25], v3 offset:9248
    ds_read_b64_tr_b16 v[26:27], v3 offset:10016
    s_waitcnt lgkmcnt(12)
    v_mfma_f32_32x32x16_bf16 v[48:63], v[28:31], v[184:187], v[48:63]
    ds_read_b64_tr_b16 v[28:29], v3 offset:9280
    ds_read_b64_tr_b16 v[30:31], v3 offset:10048
    s_waitcnt lgkmcnt(12)
    v_mfma_f32_32x32x16_bf16 v[64:79], v[8:11], v[184:187], v[64:79]
    ds_read_b64_tr_b16 v[8:9], v3 offset:9312
    ds_read_b64_tr_b16 v[10:11], v3 offset:10080
    s_waitcnt lgkmcnt(11)
    v_mfma_f32_32x32x16_bf16 v[80:95], v[12:15], v[184:187], v[80:95]
    ds_read_b64_tr_b16 v[12:13], v3 offset:9344
    ds_read_b64_tr_b16 v[14:15], v3 offset:10112
    s_waitcnt lgkmcnt(11)
    v_mfma_f32_32x32x16_bf16 v[96:111], v[16:19], v[184:187], v[96:111]
    s_waitcnt lgkmcnt(10)
    s_setprio 3
    v_cmp_ne_u32 vcc, 626944, v0
    s_setprio 0
    s_cbranch_vccz L_eBE3_ok_19
L_eBE3_sl_20:
    s_sleep 1
    ds_read_b32 v0, v7 offset:80
    s_waitcnt lgkmcnt(0)
    s_setprio 3
    v_cmp_ne_u32 vcc, 626944, v0
    s_setprio 0
    s_cbranch_vccnz L_eBE3_sl_20
L_eBE3_ok_19:
    s_waitcnt vmcnt(10)
    s_mov_b64 exec, 1
    ds_add_u32 v7, v7 offset:20
    s_mov_b64 exec, -1
    ds_read_b64_tr_b16 v[16:17], v3 offset:24640
    ds_read_b64_tr_b16 v[18:19], v3 offset:25408
    s_waitcnt lgkmcnt(11)
    v_mfma_f32_32x32x16_bf16 v[32:47], v[20:23], v[188:191], v[32:47]
    buffer_load_dword v135, v134, s[32:35], 0 offen sc1
    ds_read_b64_tr_b16 v[20:21], v3 offset:24672
    ds_read_b64_tr_b16 v[22:23], v3 offset:25440
    s_waitcnt lgkmcnt(11)
    v_mfma_f32_32x32x16_bf16 v[48:63], v[24:27], v[188:191], v[48:63]
    ds_read_b64_tr_b16 v[24:25], v3 offset:24704
    ds_read_b64_tr_b16 v[26:27], v3 offset:25472
    s_waitcnt lgkmcnt(11)
    v_mfma_f32_32x32x16_bf16 v[64:79], v[28:31], v[188:191], v[64:79]
    ds_read_b64_tr_b16 v[28:29], v3 offset:24736
    ds_read_b64_tr_b16 v[30:31], v3 offset:25504
    s_waitcnt lgkmcnt(11)
    v_mfma_f32_32x32x16_bf16 v[80:95], v[8:11], v[188:191], v[80:95]
    ds_read_b64_tr_b16 v[8:9], v3 offset:24768
    ds_read_b64_tr_b16 v[10:11], v3 offset:25536
    s_waitcnt lgkmcnt(11)
    v_mfma_f32_32x32x16_bf16 v[96:111], v[12:15], v[188:191], v[96:111]
    ds_read_b64_tr_b16 v[12:13], v3 offset:27712
    ds_read_b64_tr_b16 v[14:15], v3 offset:28480
    s_waitcnt lgkmcnt(10)
    v_mfma_f32_32x32x16_bf16 v[32:47], v[16:19], v[192:195], v[32:47]
    ds_read_b64_tr_b16 v[16:17], v3 offset:27744
    ds_read_b64_tr_b16 v[18:19], v3 offset:28512
    s_waitcnt lgkmcnt(10)
    v_mfma_f32_32x32x16_bf16 v[48:63], v[20:23], v[192:195], v[48:63]
    ds_read_b64_tr_b16 v[20:21], v3 offset:27776
    ds_read_b64_tr_b16 v[22:23], v3 offset:28544
    s_waitcnt lgkmcnt(10)
    v_mfma_f32_32x32x16_bf16 v[64:79], v[24:27], v[192:195], v[64:79]
    s_waitcnt vmcnt(1)
    s_setprio 3
    v_xor_b32 v128, s58, v161
    v_xor_b32 v129, s58, v163
    v_or_b32 v128, v128, v129
    v_xor_b32 v129, s58, v165
    v_or_b32 v128, v128, v129
    v_xor_b32 v129, s58, v167
    v_or_b32 v128, v128, v129
    v_xor_b32 v129, s58, v169
    v_or_b32 v128, v128, v129
    v_xor_b32 v129, s58, v171
    v_or_b32 v128, v128, v129
    v_xor_b32 v129, s58, v173
    v_or_b32 v128, v128, v129
    v_xor_b32 v129, s58, v175
    v_or_b32 v128, v128, v129
    v_cmp_ne_u32 vcc, 0, v128
    s_nop 0
    s_cbranch_vccz L_gb_ok_22
L_gb_sl_23:
    s_mov_b32 s62, 65536
    s_nop 15
L_gb_lp_24:
    s_sleep 1
    s_lshl_b32 s50, s67, 9
    s_add_u32 s50, s50, 15990784
    buffer_load_dwordx4 v[160:163], v2, s[32:35], s50 offen offset:0 sc1
    buffer_load_dwordx4 v[164:167], v2, s[32:35], s50 offen offset:1024 sc1
    buffer_load_dwordx4 v[168:171], v2, s[32:35], s50 offen offset:2048 sc1
    buffer_load_dwordx4 v[172:175], v2, s[32:35], s50 offen offset:3072 sc1
    s_sub_u32 s62, s62, 1
    s_waitcnt vmcnt(0)
    s_cbranch_scc1 L_gb_ok_22
    v_xor_b32 v128, s58, v161
    v_xor_b32 v129, s58, v163
    v_or_b32 v128, v128, v129
    v_xor_b32 v129, s58, v165
    v_or_b32 v128, v128, v129
    v_xor_b32 v129, s58, v167
    v_or_b32 v128, v128, v129
    v_xor_b32 v129, s58, v169
    v_or_b32 v128, v128, v129
    v_xor_b32 v129, s58, v171
    v_or_b32 v128, v128, v129
    v_xor_b32 v129, s58, v173
    v_or_b32 v128, v128, v129
    v_xor_b32 v129, s58, v175
    v_or_b32 v128, v128, v129
    v_cmp_ne_u32 vcc, 0, v128
    s_nop 0
    s_cbranch_vccnz L_gb_lp_24
L_gb_ok_22:
    s_setprio 0
    s_setprio 3
    v_add_f32 v160, v160, v164
    v_add_f32 v162, v162, v166
    v_add_f32 v168, v168, v172
    v_add_f32 v170, v170, v174
    s_setprio 0
    ds_read_b64_tr_b16 v[24:25], v3 offset:27808
    ds_read_b64_tr_b16 v[26:27], v3 offset:28576
    s_waitcnt lgkmcnt(10)
    v_mfma_f32_32x32x16_bf16 v[80:95], v[28:31], v[192:195], v[80:95]
    s_setprio 3
    v_add_f32 v160, v160, v168
    v_add_f32 v162, v162, v170
    v_cvt_pk_bf16_f32 v130, v160, v160
    v_cvt_pk_bf16_f32 v132, v162, v162
    s_setprio 0
    ds_read_b64_tr_b16 v[28:29], v3 offset:27840
    ds_read_b64_tr_b16 v[30:31], v3 offset:28608
    s_waitcnt lgkmcnt(10)
    v_mfma_f32_32x32x16_bf16 v[96:111], v[8:11], v[192:195], v[96:111]
    s_setprio 3
    v_and_b32 v128, 0xffff0000, v130
    v_and_b32 v129, 0xffff0000, v132
    v_sub_f32 v128, v160, v128
    v_sub_f32 v129, v162, v129
    s_setprio 0
    ds_read_b64_tr_b16 v[8:9], v3 offset:30784
    ds_read_b64_tr_b16 v[10:11], v3 offset:31552
    s_waitcnt lgkmcnt(10)
    v_mfma_f32_32x32x16_bf16 v[32:47], v[12:15], v[196:199], v[32:47]
    s_setprio 3
    v_cvt_pk_bf16_f32 v131, v128, v128
    v_cvt_pk_bf16_f32 v133, v129, v129
    ds_write_b64 v145, v[130:131]
    ds_write_b64 v145, v[132:133] offset:32
    s_setprio 0
    ds_read_b64_tr_b16 v[12:13], v3 offset:30816
    ds_read_b64_tr_b16 v[14:15], v3 offset:31584
    s_waitcnt lgkmcnt(12)
    v_mfma_f32_32x32x16_bf16 v[48:63], v[16:19], v[196:199], v[48:63]
    ds_read_b64_tr_b16 v[16:17], v3 offset:30848
    ds_read_b64_tr_b16 v[18:19], v3 offset:31616
    s_waitcnt lgkmcnt(12)
    v_mfma_f32_32x32x16_bf16 v[64:79], v[20:23], v[196:199], v[64:79]
    s_mov_b64 exec, 1
    ds_add_u32 v7, v7 offset:84
    s_mov_b64 exec, -1
    s_mov_b64 exec, 0xffffff
    ds_write_b128 v152, v[156:159]
    s_mov_b64 exec, -1
    s_waitcnt vmcnt(0)
    s_setprio 3
    v_cmp_ne_u32 vcc, s58, v135
    s_and_b32 s47, vcc_lo, 0xe0e0e0e
    s_cbranch_scc0 L_fa2_ok_25
L_fa2_sl_26:
    s_mov_b32 s62, 65536
    s_nop 15
L_fa2_lp_27:
    s_sleep 1
    buffer_load_dword v135, v134, s[32:35], 0 offen sc1
    s_sub_u32 s62, s62, 1
    s_waitcnt vmcnt(0)
    s_cbranch_scc1 L_fa2_ok_25
    v_cmp_ne_u32 vcc, s58, v135
    s_and_b32 s47, vcc_lo, 0xe0e0e0e
    s_cbranch_scc1 L_fa2_lp_27
L_fa2_ok_25:
    s_setprio 0
    s_ff1_i32_b32 s14, s12
    s_bitset0_b32 s12, s14
    s_lshl_b32 s14, s14, 12
    s_xor_b32 s14, s14, s64
    s_add_u32 m0, s54, 33024
    s_add_u32 s47, s14, 2097152
    buffer_load_dwordx4 v2, s[32:35], s47 offen sc1 lds
    ds_read_b64_tr_b16 v[20:21], v3 offset:30880
    ds_read_b64_tr_b16 v[22:23], v3 offset:31648
    s_waitcnt lgkmcnt(14)
    v_mfma_f32_32x32x16_bf16 v[80:95], v[24:27], v[196:199], v[80:95]
    s_add_u32 m0, s54, 34048
    s_add_u32 s47, s14, 4194304
    buffer_load_dwordx4 v2, s[32:35], s47 offen sc1 lds
    ds_read_b64_tr_b16 v[24:25], v3 offset:30912
    ds_read_b64_tr_b16 v[26:27], v3 offset:31680
    s_waitcnt lgkmcnt(14)
    v_mfma_f32_32x32x16_bf16 v[96:111], v[28:31], v[196:199], v[96:111]
    ds_read_b32 v0, v7 offset:84
    s_ff1_i32_b32 s14, s12
    s_bitset0_b32 s12, s14
    s_lshl_b32 s14, s14, 12
    s_xor_b32 s14, s14, s64
    s_add_u32 m0, s54, 41280
    s_add_u32 s47, s14, 2097152
    buffer_load_dwordx4 v2, s[32:35], s47 offen sc1 lds
    ds_read_b64_tr_b16 v[28:29], v3 offset:33856
    ds_read_b64_tr_b16 v[30:31], v3 offset:34624
    s_waitcnt lgkmcnt(15)
    v_mfma_f32_32x32x16_bf16 v[32:47], v[8:11], v[200:203], v[32:47]
    s_add_u32 m0, s54, 42304
    s_add_u32 s47, s14, 4194304
    buffer_load_dwordx4 v2, s[32:35], s47 offen sc1 lds
    ds_read_b64_tr_b16 v[8:9], v3 offset:33888
    ds_read_b64_tr_b16 v[10:11], v3 offset:34656
    s_waitcnt lgkmcnt(13)
    v_mfma_f32_32x32x16_bf16 v[48:63], v[12:15], v[200:203], v[48:63]
    s_ff1_i32_b32 s14, s12
    s_bitset0_b32 s12, s14
    s_lshl_b32 s14, s14, 12
    s_xor_b32 s14, s14, s64
    s_add_u32 m0, s54, 49536
    s_add_u32 s47, s14, 2097152
    buffer_load_dwordx4 v2, s[32:35], s47 offen sc1 lds
    ds_read_b64_tr_b16 v[12:13], v3 offset:33920
    ds_read_b64_tr_b16 v[14:15], v3 offset:34688
    s_waitcnt lgkmcnt(13)
    v_mfma_f32_32x32x16_bf16 v[64:79], v[16:19], v[200:203], v[64:79]
    s_add_u32 m0, s54, 50560
    s_add_u32 s47, s14, 4194304
    buffer_load_dwordx4 v2, s[32:35], s47 offen sc1 lds
    ds_read_b64_tr_b16 v[16:17], v3 offset:33952
    ds_read_b64_tr_b16 v[18:19], v3 offset:34720
    s_waitcnt lgkmcnt(11)
    v_mfma_f32_32x32x16_bf16 v[80:95], v[20:23], v[200:203], v[80:95]
    s_ff1_i32_b32 s14, s12
    s_bitset0_b32 s12, s14
    s_lshl_b32 s14, s14, 12
    s_xor_b32 s14, s14, s64
    s_add_u32 m0, s54, 57792
    s_add_u32 s47, s14, 2097152
    buffer_load_dwordx4 v2, s[32:35], s47 offen sc1 lds
    ds_read_b64_tr_b16 v[20:21], v3 offset:33984
    ds_read_b64_tr_b16 v[22:23], v3 offset:34752
    s_waitcnt lgkmcnt(11)
    v_mfma_f32_32x32x16_bf16 v[96:111], v[24:27], v[200:203], v[96:111]
    s_waitcnt lgkmcnt(10)
    s_setprio 3
    v_cmp_ne_u32 vcc, 626944, v0
    s_setprio 0
    s_cbranch_vccz L_eBE4_ok_28
L_eBE4_sl_29:
    s_sleep 1
    ds_read_b32 v0, v7 offset:84
    s_waitcnt lgkmcnt(0)
    s_setprio 3
    v_cmp_ne_u32 vcc, 626944, v0
    s_setprio 0
    s_cbranch_vccnz L_eBE4_sl_29
L_eBE4_ok_28:
    s_add_u32 m0, s54, 58816
    s_add_u32 s47, s14, 4194304
    buffer_load_dwordx4 v2, s[32:35], s47 offen sc1 lds
    ds_read_b64_tr_b16 v[24:25], v3 offset:49536
    ds_read_b64_tr_b16 v[26:27], v3 offset:50304
    s_waitcnt lgkmcnt(10)
    v_mfma_f32_32x32x16_bf16 v[32:47], v[28:31], v[204:207], v[32:47]
    s_add_u32 s65, s63, 6
    s_and_b32 s65, s65, 7
    s_mul_i32 s65, s65, 176128
    s_add_u32 m0, s57, 82560
    s_add_u32 s65, s65, s56
    buffer_load_dwordx4 v4, s[16:19], s65 offen lds
    ds_read_b64_tr_b16 v[28:29], v3 offset:49568
    ds_read_b64_tr_b16 v[30:31], v3 offset:50336
    s_waitcnt lgkmcnt(10)
    v_mfma_f32_32x32x16_bf16 v[48:63], v[8:11], v[204:207], v[48:63]
    s_add_u32 m0, s57, 83584
    s_nop 0
    buffer_load_dwordx4 v5, s[16:19], s65 offen lds
    ds_read_b64_tr_b16 v[8:9], v3 offset:49600
    ds_read_b64_tr_b16 v[10:11], v3 offset:50368
    s_waitcnt lgkmcnt(10)
    v_mfma_f32_32x32x16_bf16 v[64:79], v[12:15], v[204:207], v[64:79]
    s_add_u32 m0, s57, 84608
    s_nop 0
    buffer_load_dwordx4 v6, s[16:19], s65 offen lds
    ds_read_b64_tr_b16 v[12:13], v3 offset:49632
    ds_read_b64_tr_b16 v[14:15], v3 offset:50400
    s_waitcnt lgkmcnt(10)
    v_mfma_f32_32x32x16_bf16 v[80:95], v[16:19], v[204:207], v[80:95]
    s_add_u32 m0, s57, 94880
    s_nop 0
    buffer_load_dwordx4 v4, s[20:23], s65 offen lds
    ds_read_b64_tr_b16 v[16:17], v3 offset:49664
    ds_read_b64_tr_b16 v[18:19], v3 offset:50432
    s_waitcnt lgkmcnt(10)
    v_mfma_f32_32x32x16_bf16 v[96:111], v[20:23], v[204:207], v[96:111]
    s_add_u32 m0, s57, 95904
    s_nop 0
    buffer_load_dwordx4 v5, s[20:23], s65 offen lds
    ds_read_b64_tr_b16 v[20:21], v3 offset:52608
    ds_read_b64_tr_b16 v[22:23], v3 offset:53376
    s_waitcnt lgkmcnt(10)
    v_mfma_f32_32x32x16_bf16 v[32:47], v[24:27], v[208:211], v[32:47]
    s_add_u32 m0, s57, 96928
    s_nop 0
    buffer_load_dwordx4 v6, s[20:23], s65 offen lds
    ds_read_b64_tr_b16 v[24:25], v3 offset:52640
    ds_read_b64_tr_b16 v[26:27], v3 offset:53408
    s_waitcnt lgkmcnt(10)
    v_mfma_f32_32x32x16_bf16 v[48:63], v[28:31], v[208:211], v[48:63]
    ds_read_b64_tr_b16 v[28:29], v3 offset:52672
    ds_read_b64_tr_b16 v[30:31], v3 offset:53440
    s_waitcnt lgkmcnt(10)
    v_mfma_f32_32x32x16_bf16 v[64:79], v[8:11], v[208:211], v[64:79]
    ds_read_b64_tr_b16 v[8:9], v3 offset:52704
    ds_read_b64_tr_b16 v[10:11], v3 offset:53472
    s_waitcnt lgkmcnt(10)
    v_mfma_f32_32x32x16_bf16 v[80:95], v[12:15], v[208:211], v[80:95]
    ds_read_b64_tr_b16 v[12:13], v3 offset:52736
    ds_read_b64_tr_b16 v[14:15], v3 offset:53504
    s_waitcnt lgkmcnt(10)
    v_mfma_f32_32x32x16_bf16 v[96:111], v[16:19], v[208:211], v[96:111]
    s_waitcnt vmcnt(0)
    s_mov_b64 exec, 1
    ds_add_u32 v7, v7 offset:88
    s_mov_b64 exec, -1
    s_mov_b64 exec, 1
    ds_add_u32 v7, v7 offset:24
    s_mov_b64 exec, -1
    ds_read_b64_tr_b16 v[16:17], v3 offset:55680
    ds_read_b64_tr_b16 v[18:19], v3 offset:56448
    s_waitcnt lgkmcnt(12)
    v_mfma_f32_32x32x16_bf16 v[32:47], v[20:23], v[212:215], v[32:47]
    ds_read_b64_tr_b16 v[20:21], v3 offset:55712
    ds_read_b64_tr_b16 v[22:23], v3 offset:56480
    s_waitcnt lgkmcnt(12)
    v_mfma_f32_32x32x16_bf16 v[48:63], v[24:27], v[212:215], v[48:63]
    ds_read_b32 v0, v7 offset:88
    ds_read_b64_tr_b16 v[24:25], v3 offset:55744
    ds_read_b64_tr_b16 v[26:27], v3 offset:56512
    s_waitcnt lgkmcnt(13)
    v_mfma_f32_32x32x16_bf16 v[64:79], v[28:31], v[212:215], v[64:79]
    ds_read_b64_tr_b16 v[28:29], v3 offset:55776
    ds_read_b64_tr_b16 v[30:31], v3 offset:56544
    s_waitcnt lgkmcnt(13)
    v_mfma_f32_32x32x16_bf16 v[80:95], v[8:11], v[212:215], v[80:95]
    ds_read_b64_tr_b16 v[8:9], v3 offset:55808
    ds_read_b64_tr_b16 v[10:11], v3 offset:56576
    s_waitcnt lgkmcnt(13)
    v_mfma_f32_32x32x16_bf16 v[96:111], v[12:15], v[212:215], v[96:111]
    ds_read_b64_tr_b16 v[12:13], v3 offset:58752
    ds_read_b64_tr_b16 v[14:15], v3 offset:59520
    s_waitcnt lgkmcnt(11)
    v_mfma_f32_32x32x16_bf16 v[32:47], v[16:19], v[216:219], v[32:47]
    ds_read_b64_tr_b16 v[16:17], v3 offset:58784
    ds_read_b64_tr_b16 v[18:19], v3 offset:59552
    s_waitcnt lgkmcnt(11)
    v_mfma_f32_32x32x16_bf16 v[48:63], v[20:23], v[216:219], v[48:63]
    s_waitcnt lgkmcnt(10)
    s_setprio 3
    v_cmp_ne_u32 vcc, 626944, v0
    s_setprio 0
    s_cbranch_vccz L_eBE5_ok_31
L_eBE5_sl_32:
    s_sleep 1
    ds_read_b32 v0, v7 offset:88
    s_waitcnt lgkmcnt(0)
    s_setprio 3
    v_cmp_ne_u32 vcc, 626944, v0
    s_setprio 0
    s_cbranch_vccnz L_eBE5_sl_32
L_eBE5_ok_31:
    ds_read_b128 v[176:179], v144 offset:0
    ds_read_b128 v[180:183], v144 offset:16
    ds_read_b128 v[184:187], v144 offset:32
    ds_read_b128 v[188:191], v144 offset:48
    s_add_u32 s65, s63, 7
    s_and_b32 s65, s65, 7
    s_mul_i32 s65, s65, 176128
    s_add_u32 m0, s57, 107200
    s_add_u32 s65, s65, s56
    buffer_load_dwordx4 v4, s[16:19], s65 offen lds
    s_setprio 3
    s_setprio 0
    ds_read_b64_tr_b16 v[20:21], v3 offset:58816
    ds_read_b64_tr_b16 v[22:23], v3 offset:59584
    s_waitcnt lgkmcnt(14)
    v_mfma_f32_32x32x16_bf16 v[64:79], v[24:27], v[216:219], v[64:79]
    s_add_u32 m0, s57, 108224
    s_nop 0
    buffer_load_dwordx4 v5, s[16:19], s65 offen lds
    ds_read_b64_tr_b16 v[24:25], v3 offset:58848
    ds_read_b64_tr_b16 v[26:27], v3 offset:59616
    s_waitcnt lgkmcnt(14)
    v_mfma_f32_32x32x16_bf16 v[80:95], v[28:31], v[216:219], v[80:95]
    s_add_u32 m0, s57, 109248
    s_nop 0
    buffer_load_dwordx4 v6, s[16:19], s65 offen lds
    ds_read_b64_tr_b16 v[28:29], v3 offset:58880
    ds_read_b64_tr_b16 v[30:31], v3 offset:59648
    s_waitcnt lgkmcnt(14)
    v_mfma_f32_32x32x16_bf16 v[96:111], v[8:11], v[216:219], v[96:111]
    s_add_u32 m0, s57, 119520
    s_nop 0
    buffer_load_dwordx4 v4, s[20:23], s65 offen lds
    s_setprio 3
    s_waitcnt lgkmcnt(6)
    v_mov_b32 v186, 0
    v_mov_b32 v187, 0
    s_setprio 0
    ds_read_b64_tr_b16 v[8:9], v3 offset:0
    ds_read_b64_tr_b16 v[10:11], v3 offset:768
    v_mfma_f32_32x32x16_bf16 v[32:47], v[12:15], v[220:223], v[32:47]
    v_mfma_f32_32x32x16_bf16 v[64:79], v[180:183], v[140:143], v[64:79]
    s_add_u32 m0, s57, 120544
    s_nop 0
    buffer_load_dwordx4 v5, s[20:23], s65 offen lds
    ds_read_b64_tr_b16 v[12:13], v3 offset:32
    ds_read_b64_tr_b16 v[14:15], v3 offset:800
    v_mfma_f32_32x32x16_bf16 v[48:63], v[16:19], v[220:223], v[48:63]
    v_mfma_f32_32x32x16_bf16 v[80:95], v[182:185], v[140:143], v[80:95]
    s_add_u32 m0, s57, 121568
    s_nop 0
    buffer_load_dwordx4 v6, s[20:23], s65 offen lds
    ds_read_b64_tr_b16 v[16:17], v3 offset:64
    ds_read_b64_tr_b16 v[18:19], v3 offset:832
    s_waitcnt lgkmcnt(10)
    v_mfma_f32_32x32x16_bf16 v[64:79], v[20:23], v[220:223], v[64:79]
    v_mfma_f32_32x32x16_bf16 v[96:111], v[184:187], v[140:143], v[96:111]
    ds_read_b64_tr_b16 v[20:21], v3 offset:96
    ds_read_b64_tr_b16 v[22:23], v3 offset:864
    s_waitcnt lgkmcnt(10)
    v_mfma_f32_32x32x16_bf16 v[80:95], v[24:27], v[220:223], v[80:95]
    v_mfma_f32_32x32x16_bf16 v[32:47], v[176:179], v[140:143], v[32:47]
    ds_read_b64_tr_b16 v[24:25], v3 offset:128
    ds_read_b64_tr_b16 v[26:27], v3 offset:896
    s_waitcnt lgkmcnt(10)
    v_mfma_f32_32x32x16_bf16 v[96:111], v[28:31], v[220:223], v[96:111]
    v_mfma_f32_32x32x16_bf16 v[48:63], v[178:181], v[140:143], v[48:63]
    ds_read_b64_tr_b16 v[28:29], v3 offset:3072
    ds_read_b64_tr_b16 v[30:31], v3 offset:3840
    s_waitcnt lgkmcnt(10)
    v_mfma_f32_32x32x16_bf16 v[32:47], v[8:11], v[224:227], v[32:47]
    buffer_load_dword v151, v150, s[32:35], 0 offen sc1
    s_setprio 3
    v_mov_b32 v192, -1
    v_mov_b32 v193, -1
    v_mov_b32 v194, -1
    v_mov_b32 v195, -1
    s_setprio 0
    ds_read_b64_tr_b16 v[8:9], v3 offset:3104
    ds_read_b64_tr_b16 v[10:11], v3 offset:3872
    s_waitcnt lgkmcnt(10)
    v_mfma_f32_32x32x16_bf16 v[48:63], v[12:15], v[224:227], v[48:63]
    ds_read_b64_tr_b16 v[12:13], v3 offset:3136
    ds_read_b64_tr_b16 v[14:15], v3 offset:3904
    s_waitcnt lgkmcnt(10)
    v_mfma_f32_32x32x16_bf16 v[64:79], v[16:19], v[224:227], v[64:79]
    s_setprio 3
    v_mov_b32 v140, v137
    v_mov_b32 v141, v137
    v_mov_b32 v139, v138
    v_mov_b32 v137, v136
    s_setprio 0
    ds_read_b64_tr_b16 v[16:17], v3 offset:3168
    ds_read_b64_tr_b16 v[18:19], v3 offset:3936
    s_waitcnt lgkmcnt(10)
    v_mfma_f32_32x32x16_bf16 v[80:95], v[20:23], v[224:227], v[80:95]
    ds_read_b64_tr_b16 v[20:21], v3 offset:3200
    ds_read_b64_tr_b16 v[22:23], v3 offset:3968
    s_waitcnt lgkmcnt(10)
    v_mfma_f32_32x32x16_bf16 v[96:111], v[24:27], v[224:227], v[96:111]
    ds_read_b64_tr_b16 v[24:25], v3 offset:6144
    ds_read_b64_tr_b16 v[26:27], v3 offset:6912
    s_waitcnt lgkmcnt(10)
    v_mfma_f32_32x32x16_bf16 v[32:47], v[28:31], v[228:231], v[32:47]
    ds_read_b64_tr_b16 v[28:29], v3 offset:6176
    ds_read_b64_tr_b16 v[30:31], v3 offset:6944
    s_waitcnt lgkmcnt(10)
    v_mfma_f32_32x32x16_bf16 v[48:63], v[8:11], v[228:231], v[48:63]
    s_waitcnt vmcnt(1)
    s_mov_b64 exec, 1
    ds_add_u32 v7, v7 offset:92
    s_mov_b64 exec, -1
    ds_read_b64_tr_b16 v[8:9], v3 offset:6208
    ds_read_b64_tr_b16 v[10:11], v3 offset:6976
    s_waitcnt lgkmcnt(11)
    v_mfma_f32_32x32x16_bf16 v[64:79], v[12:15], v[228:231], v[64:79]
    s_setprio 3
    s_lshl2_add_u32 s49, s2, s45
    v_lshlrev_b32 v196, 7, v1
    s_mul_i32 s50, s49, 1408
    s_lshl_b32 s49, s49, 9
    s_mov_b64 exec, 0x7ff
    buffer_load_dword v197, v196, s[24:27], s50 offen
    s_mov_b64 exec, 15
    buffer_load_dword v197, v196, s[28:31], s49 offen
    s_mov_b64 exec, -1
    s_setprio 0
    ds_read_b64_tr_b16 v[12:13], v3 offset:6240
    ds_read_b64_tr_b16 v[14:15], v3 offset:7008
    s_waitcnt lgkmcnt(11)
    v_mfma_f32_32x32x16_bf16 v[80:95], v[16:19], v[228:231], v[80:95]
    ds_read_b32 v0, v7 offset:92
    ds_read_b64_tr_b16 v[16:17], v3 offset:6272
    ds_read_b64_tr_b16 v[18:19], v3 offset:7040
    s_waitcnt lgkmcnt(12)
    v_mfma_f32_32x32x16_bf16 v[96:111], v[20:23], v[228:231], v[96:111]
    ds_read_b64_tr_b16 v[20:21], v3 offset:9216
    ds_read_b64_tr_b16 v[22:23], v3 offset:9984
    s_waitcnt lgkmcnt(12)
    v_mfma_f32_32x32x16_bf16 v[32:47], v[24:27], v[232:235], v[32:47]
    ds_read_b64_tr_b16 v[24:25], v3 offset:9248
    ds_read_b64_tr_b16 v[26:27], v3 offset:10016
    s_waitcnt lgkmcnt(12)
    v_mfma_f32_32x32x16_bf16 v[48:63], v[28:31], v[232:235], v[48:63]
    ds_read_b64_tr_b16 v[28:29], v3 offset:9280
    ds_read_b64_tr_b16 v[30:31], v3 offset:10048
    s_waitcnt lgkmcnt(11)
    v_mfma_f32_32x32x16_bf16 v[64:79], v[8:11], v[232:235], v[64:79]
    ds_read_b64_tr_b16 v[8:9], v3 offset:9312
    ds_read_b64_tr_b16 v[10:11], v3 offset:10080
    s_waitcnt lgkmcnt(11)
    v_mfma_f32_32x32x16_bf16 v[80:95], v[12:15], v[232:235], v[80:95]
    s_waitcnt lgkmcnt(10)
    s_setprio 3
    v_cmp_ne_u32 vcc, 626944, v0
    s_setprio 0
    s_cbranch_vccz L_eBE6_ok_34
L_eBE6_sl_35:
    s_sleep 1
    ds_read_b32 v0, v7 offset:92
    s_waitcnt lgkmcnt(0)
    s_setprio 3
    v_cmp_ne_u32 vcc, 626944, v0
    s_setprio 0
    s_cbranch_vccnz L_eBE6_sl_35
L_eBE6_ok_34:
    ds_read_b64_tr_b16 v[12:13], v3 offset:9344
    ds_read_b64_tr_b16 v[14:15], v3 offset:10112
    s_waitcnt lgkmcnt(10)
    v_mfma_f32_32x32x16_bf16 v[96:111], v[16:19], v[232:235], v[96:111]
    s_waitcnt vmcnt(2)
    s_setprio 3
    v_cmp_ne_u32 vcc, s58, v151
    s_and_b32 s47, vcc_lo, 0xf0f0f0f0
    s_cbranch_scc0 L_gfa_ok_37
L_gfa_sl_38:
    s_mov_b32 s62, 65536
    s_nop 15
L_gfa_lp_39:
    s_sleep 8
    buffer_load_dword v151, v150, s[32:35], 0 offen sc1
    s_sub_u32 s62, s62, 1
    s_waitcnt vmcnt(0)
    s_cbranch_scc1 L_gfa_ok_37
    v_cmp_ne_u32 vcc, s58, v151
    s_and_b32 s47, vcc_lo, 0xf0f0f0f0
    s_cbranch_scc1 L_gfa_lp_39
L_gfa_ok_37:
    s_setprio 0
    s_add_u32 m0, s54, 66048
    s_xor_b32 s47, s64, 2113536
    buffer_load_dwordx4 v2, s[32:35], s47 offen sc1 lds
    ds_read_b64_tr_b16 v[16:17], v3 offset:24640
    ds_read_b64_tr_b16 v[18:19], v3 offset:25408
    s_waitcnt lgkmcnt(10)
    v_mfma_f32_32x32x16_bf16 v[32:47], v[20:23], v[236:239], v[32:47]
    s_add_u32 m0, s54, 67072
    s_xor_b32 s47, s64, 4210688
    buffer_load_dwordx4 v2, s[32:35], s47 offen sc1 lds
    ds_read_b64_tr_b16 v[20:21], v3 offset:24672
    ds_read_b64_tr_b16 v[22:23], v3 offset:25440
    s_waitcnt lgkmcnt(10)
    v_mfma_f32_32x32x16_bf16 v[48:63], v[24:27], v[236:239], v[48:63]
    s_add_u32 m0, s54, 74304
    s_xor_b32 s47, s64, 2117632
    buffer_load_dwordx4 v2, s[32:35], s47 offen sc1 lds
    ds_read_b64_tr_b16 v[24:25], v3 offset:24704
    ds_read_b64_tr_b16 v[26:27], v3 offset:25472
    s_waitcnt lgkmcnt(10)
    v_mfma_f32_32x32x16_bf16 v[64:79], v[28:31], v[236:239], v[64:79]
    s_add_u32 m0, s54, 75328
    s_xor_b32 s47, s64, 4214784
    buffer_load_dwordx4 v2, s[32:35], s47 offen sc1 lds
    ds_read_b64_tr_b16 v[28:29], v3 offset:24736
    ds_read_b64_tr_b16 v[30:31], v3 offset:25504
    s_waitcnt lgkmcnt(10)
    v_mfma_f32_32x32x16_bf16 v[80:95], v[8:11], v[236:239], v[80:95]
    ds_read_b64_tr_b16 v[8:9], v3 offset:24768
    ds_read_b64_tr_b16 v[10:11], v3 offset:25536
    s_waitcnt lgkmcnt(10)
    v_mfma_f32_32x32x16_bf16 v[96:111], v[12:15], v[236:239], v[96:111]
    ds_read_b64_tr_b16 v[12:13], v3 offset:27712
    ds_read_b64_tr_b16 v[14:15], v3 offset:28480
    s_waitcnt lgkmcnt(10)
    v_mfma_f32_32x32x16_bf16 v[32:47], v[16:19], v[240:243], v[32:47]
    ds_read_b64_tr_b16 v[16:17], v3 offset:27744
    ds_read_b64_tr_b16 v[18:19], v3 offset:28512
    s_waitcnt lgkmcnt(10)
    v_mfma_f32_32x32x16_bf16 v[48:63], v[20:23], v[240:243], v[48:63]
    ds_read_b64_tr_b16 v[20:21], v3 offset:27776
    ds_read_b64_tr_b16 v[22:23], v3 offset:28544
    s_waitcnt lgkmcnt(10)
    v_mfma_f32_32x32x16_bf16 v[64:79], v[24:27], v[240:243], v[64:79]
    ds_read_b64_tr_b16 v[24:25], v3 offset:27808
    ds_read_b64_tr_b16 v[26:27], v3 offset:28576
    s_waitcnt lgkmcnt(10)
    v_mfma_f32_32x32x16_bf16 v[80:95], v[28:31], v[240:243], v[80:95]
    ds_read_b64_tr_b16 v[28:29], v3 offset:27840
    ds_read_b64_tr_b16 v[30:31], v3 offset:28608
    s_waitcnt lgkmcnt(10)
    v_mfma_f32_32x32x16_bf16 v[96:111], v[8:11], v[240:243], v[96:111]
    ds_read_b64_tr_b16 v[8:9], v3 offset:30784
    ds_read_b64_tr_b16 v[10:11], v3 offset:31552
    s_waitcnt lgkmcnt(10)
    v_mfma_f32_32x32x16_bf16 v[32:47], v[12:15], v[244:247], v[32:47]
    ds_read_b64_tr_b16 v[12:13], v3 offset:30816
    ds_read_b64_tr_b16 v[14:15], v3 offset:31584
    s_waitcnt lgkmcnt(10)
    v_mfma_f32_32x32x16_bf16 v[48:63], v[16:19], v[244:247], v[48:63]
    ds_read_b64_tr_b16 v[16:17], v3 offset:30848
    ds_read_b64_tr_b16 v[18:19], v3 offset:31616
    s_waitcnt lgkmcnt(10)
    v_mfma_f32_32x32x16_bf16 v[64:79], v[20:23], v[244:247], v[64:79]
    ds_read_b64_tr_b16 v[20:21], v3 offset:30880
    ds_read_b64_tr_b16 v[22:23], v3 offset:31648
    s_waitcnt lgkmcnt(10)
    v_mfma_f32_32x32x16_bf16 v[80:95], v[24:27], v[244:247], v[80:95]
    ds_read_b64_tr_b16 v[24:25], v3 offset:30912
    ds_read_b64_tr_b16 v[26:27], v3 offset:31680
    s_waitcnt lgkmcnt(10)
    v_mfma_f32_32x32x16_bf16 v[96:111], v[28:31], v[244:247], v[96:111]
    ds_read_b64_tr_b16 v[28:29], v3 offset:33856
    ds_read_b64_tr_b16 v[30:31], v3 offset:34624
    s_waitcnt lgkmcnt(10)
    v_mfma_f32_32x32x16_bf16 v[32:47], v[8:11], v[248:251], v[32:47]
    ds_read_b64_tr_b16 v[8:9], v3 offset:33888
    ds_read_b64_tr_b16 v[10:11], v3 offset:34656
    s_waitcnt lgkmcnt(10)
    v_mfma_f32_32x32x16_bf16 v[48:63], v[12:15], v[248:251], v[48:63]
    ds_read_b64_tr_b16 v[12:13], v3 offset:33920
    ds_read_b64_tr_b16 v[14:15], v3 offset:34688
    s_waitcnt lgkmcnt(10)
    v_mfma_f32_32x32x16_bf16 v[64:79], v[16:19], v[248:251], v[64:79]
    ds_read_b64_tr_b16 v[16:17], v3 offset:33952
    ds_read_b64_tr_b16 v[18:19], v3 offset:34720
    s_waitcnt lgkmcnt(10)
    v_mfma_f32_32x32x16_bf16 v[80:95], v[20:23], v[248:251], v[80:95]
    ds_read_b64_tr_b16 v[20:21], v3 offset:33984
    ds_read_b64_tr_b16 v[22:23], v3 offset:34752
    s_waitcnt lgkmcnt(10)
    v_mfma_f32_32x32x16_bf16 v[96:111], v[24:27], v[248:251], v[96:111]
    s_waitcnt lgkmcnt(8)
    v_mfma_f32_32x32x16_bf16 v[32:47], v[28:31], v[252:255], v[32:47]
    s_waitcnt lgkmcnt(6)
    v_mfma_f32_32x32x16_bf16 v[48:63], v[8:11], v[252:255], v[48:63]
    s_waitcnt lgkmcnt(4)
    v_mfma_f32_32x32x16_bf16 v[64:79], v[12:15], v[252:255], v[64:79]
    s_waitcnt lgkmcnt(2)
    v_mfma_f32_32x32x16_bf16 v[80:95], v[16:19], v[252:255], v[80:95]
    s_waitcnt lgkmcnt(0)
    v_mfma_f32_32x32x16_bf16 v[96:111], v[20:23], v[252:255], v[96:111]
    s_setprio 3
    s_mov_b64 exec, 1
    ds_add_u32 v7, v7 offset:56
    s_mov_b64 exec, -1
    s_waitcnt vmcnt(0)
    s_mov_b64 exec, 1
    ds_add_u32 v7, v7 offset:28
    s_mov_b64 exec, -1
    s_lshl_b32 s48, s43, 2
    s_add_u32 s48, s48, s45
    s_mul_i32 s48, s48, 88
    s_mul_i32 s56, s44, 5
    s_add_u32 s48, s48, s56
    s_add_u32 s48, s48, 6192
    s_lshl_b32 s48, s48, 10
    v_pk_mul_f32 v[128:129], v[32:33], v[32:33]
    v_pk_mul_f32 v[130:131], v[34:35], v[34:35]
    v_pk_mul_f32 v[132:133], v[36:37], v[36:37]
    v_pk_mul_f32 v[134:135], v[38:39], v[38:39]
    v_pk_fma_f32 v[128:129], v[128:129], v[140:141], v[138:139]
    v_pk_fma_f32 v[130:131], v[130:131], v[140:141], v[138:139]
    v_pk_fma_f32 v[132:133], v[132:133], v[140:141], v[138:139]
    v_pk_fma_f32 v[134:135], v[134:135], v[140:141], v[138:139]
    v_pk_mul_f32 v[128:129], v[128:129], v[32:33]
    v_pk_mul_f32 v[130:131], v[130:131], v[34:35]
    v_pk_mul_f32 v[132:133], v[132:133], v[36:37]
    v_pk_mul_f32 v[134:135], v[134:135], v[38:39]
    ds_read_b32 v0, v7 offset:56
    v_exp_f32 v128, v128
    v_exp_f32 v129, v129
    v_pk_mul_f32 v[40:41], v[32:33], v[40:41]
    v_exp_f32 v130, v130
    v_exp_f32 v131, v131
    v_pk_mul_f32 v[42:43], v[34:35], v[42:43]
    v_exp_f32 v132, v132
    v_exp_f32 v133, v133
    v_pk_mul_f32 v[44:45], v[36:37], v[44:45]
    v_exp_f32 v134, v134
    v_exp_f32 v135, v135
    v_pk_mul_f32 v[46:47], v[38:39], v[46:47]
    v_pk_fma_f32 v[128:129], v[128:129], v[136:137], v[136:137]
    v_pk_fma_f32 v[130:131], v[130:131], v[136:137], v[136:137]
    v_pk_fma_f32 v[132:133], v[132:133], v[136:137], v[136:137]
    v_pk_fma_f32 v[134:135], v[134:135], v[136:137], v[136:137]
    v_rcp_f32 v128, v128
    v_rcp_f32 v129, v129
    v_rcp_f32 v130, v130
    v_rcp_f32 v131, v131
    v_rcp_f32 v132, v132
    v_rcp_f32 v133, v133
    v_rcp_f32 v134, v134
    v_rcp_f32 v135, v135
    v_pk_mul_f32 v[128:129], v[128:129], v[40:41]
    v_pk_mul_f32 v[130:131], v[130:131], v[42:43]
    v_pk_mul_f32 v[132:133], v[132:133], v[44:45]
    v_pk_mul_f32 v[134:135], v[134:135], v[46:47]
    v_cvt_pk_bf16_f32 v32, v128, v129
    v_cvt_pk_bf16_f32 v33, v130, v131
    v_cvt_pk_bf16_f32 v34, v132, v133
    v_cvt_pk_bf16_f32 v35, v134, v135
    s_add_u32 s50, s48, 0
    buffer_store_dwordx4 v[32:35], v2, s[32:35], s50 offen sc1
    s_waitcnt lgkmcnt(0)
    v_cmp_ne_u32 vcc, 626944, v0
    s_nop 0
    s_cbranch_vccz L_eBC7_ok_40
L_eBC7_sl_41:
    s_sleep 1
    ds_read_b32 v0, v7 offset:56
    s_waitcnt lgkmcnt(0)
    v_cmp_ne_u32 vcc, 626944, v0
    s_nop 0
    s_cbranch_vccnz L_eBC7_sl_41
L_eBC7_ok_40:
    ds_write_b128 v152, v[156:159] offset:33024
    s_lshl_b32 s66, s61, 3
    s_add_u32 s66, s66, s45
    s_lshl_b32 s66, s66, 5
    s_add_u32 s66, s66, s60
    s_lshl_b32 s66, s66, 10
    s_add_u32 s47, s66, 12058624
    buffer_store_dwordx4 v[192:195], v2, s[32:35], s47 offen sc1
    s_add_u32 s47, s66, 12189696
    buffer_store_dwordx4 v[192:195], v2, s[32:35], s47 offen sc1
    v_pk_mul_f32 v[128:129], v[48:49], v[48:49]
    s_add_u32 m0, s54, 82560
    s_xor_b32 s47, s64, 2121728
    buffer_load_dwordx4 v2, s[32:35], s47 offen sc1 lds
    v_pk_mul_f32 v[130:131], v[50:51], v[50:51]
    v_pk_mul_f32 v[132:133], v[52:53], v[52:53]
    v_pk_mul_f32 v[134:135], v[54:55], v[54:55]
    v_pk_fma_f32 v[128:129], v[128:129], v[140:141], v[138:139]
    v_pk_fma_f32 v[130:131], v[130:131], v[140:141], v[138:139]
    v_pk_fma_f32 v[132:133], v[132:133], v[140:141], v[138:139]
    v_pk_fma_f32 v[134:135], v[134:135], v[140:141], v[138:139]
    v_pk_mul_f32 v[128:129], v[128:129], v[48:49]
    s_add_u32 m0, s54, 83584
    s_xor_b32 s47, s64, 4218880
    buffer_load_dwordx4 v2, s[32:35], s47 offen sc1 lds
    v_pk_mul_f32 v[130:131], v[130:131], v[50:51]
    v_pk_mul_f32 v[132:133], v[132:133], v[52:53]
    v_pk_mul_f32 v[134:135], v[134:135], v[54:55]
    v_exp_f32 v128, v128
    v_exp_f32 v129, v129
    v_pk_mul_f32 v[56:57], v[48:49], v[56:57]
    v_exp_f32 v130, v130
    v_exp_f32 v131, v131
    s_add_u32 m0, s54, 90816
    s_xor_b32 s47, s64, 2125824
    buffer_load_dwordx4 v2, s[32:35], s47 offen sc1 lds
    v_pk_mul_f32 v[58:59], v[50:51], v[58:59]
    v_exp_f32 v132, v132
    v_exp_f32 v133, v133
    v_pk_mul_f32 v[60:61], v[52:53], v[60:61]
    v_exp_f32 v134, v134
    v_exp_f32 v135, v135
    v_pk_mul_f32 v[62:63], v[54:55], v[62:63]
    v_pk_fma_f32 v[128:129], v[128:129], v[136:137], v[136:137]
    s_add_u32 m0, s54, 91840
    s_xor_b32 s47, s64, 4222976
    buffer_load_dwordx4 v2, s[32:35], s47 offen sc1 lds
    v_pk_fma_f32 v[130:131], v[130:131], v[136:137], v[136:137]
    v_pk_fma_f32 v[132:133], v[132:133], v[136:137], v[136:137]
    v_pk_fma_f32 v[134:135], v[134:135], v[136:137], v[136:137]
    v_rcp_f32 v128, v128
    v_rcp_f32 v129, v129
    v_rcp_f32 v130, v130
    v_rcp_f32 v131, v131
    v_rcp_f32 v132, v132
    s_add_u32 m0, s54, 99072
    s_xor_b32 s47, s64, 2146304
    buffer_load_dwordx4 v2, s[32:35], s47 offen sc1 lds
    v_rcp_f32 v133, v133
    v_rcp_f32 v134, v134
    v_rcp_f32 v135, v135
    v_pk_mul_f32 v[128:129], v[128:129], v[56:57]
    v_pk_mul_f32 v[130:131], v[130:131], v[58:59]
    v_pk_mul_f32 v[132:133], v[132:133], v[60:61]
    v_pk_mul_f32 v[134:135], v[134:135], v[62:63]
    v_cvt_pk_bf16_f32 v48, v128, v129
    s_add_u32 m0, s54, 100096
    s_xor_b32 s47, s64, 4243456
    buffer_load_dwordx4 v2, s[32:35], s47 offen sc1 lds
    v_cvt_pk_bf16_f32 v49, v130, v131
    v_cvt_pk_bf16_f32 v50, v132, v133
    v_cvt_pk_bf16_f32 v51, v134, v135
    s_add_u32 s50, s48, 1024
    buffer_store_dwordx4 v[48:51], v2, s[32:35], s50 offen sc1
    v_pk_mul_f32 v[128:129], v[64:65], v[64:65]
    v_pk_mul_f32 v[130:131], v[66:67], v[66:67]
    v_pk_mul_f32 v[132:133], v[68:69], v[68:69]
    v_pk_mul_f32 v[134:135], v[70:71], v[70:71]
    s_add_u32 m0, s54, 107328
    s_xor_b32 s47, s64, 2150400
    buffer_load_dwordx4 v2, s[32:35], s47 offen sc1 lds
    v_pk_fma_f32 v[128:129], v[128:129], v[140:141], v[138:139]
    v_pk_fma_f32 v[130:131], v[130:131], v[140:141], v[138:139]
    v_pk_fma_f32 v[132:133], v[132:133], v[140:141], v[138:139]
    v_pk_fma_f32 v[134:135], v[134:135], v[140:141], v[138:139]
    v_pk_mul_f32 v[128:129], v[128:129], v[64:65]
    v_pk_mul_f32 v[130:131], v[130:131], v[66:67]
    v_pk_mul_f32 v[132:133], v[132:133], v[68:69]
    v_pk_mul_f32 v[134:135], v[134:135], v[70:71]
    s_add_u32 m0, s54, 108352
    s_xor_b32 s47, s64, 4247552
    buffer_load_dwordx4 v2, s[32:35], s47 offen sc1 lds
    v_exp_f32 v128, v128
    v_exp_f32 v129, v129
    v_pk_mul_f32 v[72:73], v[64:65], v[72:73]
    v_exp_f32 v130, v130
    v_exp_f32 v131, v131
    v_pk_mul_f32 v[74:75], v[66:67], v[74:75]
    v_exp_f32 v132, v132
    v_exp_f32 v133, v133
    s_add_u32 m0, s54, 115584
    s_xor_b32 s47, s64, 2154496
    buffer_load_dwordx4 v2, s[32:35], s47 offen sc1 lds
    v_pk_mul_f32 v[76:77], v[68:69], v[76:77]
    v_exp_f32 v134, v134
    v_exp_f32 v135, v135
    v_pk_mul_f32 v[78:79], v[70:71], v[78:79]
    v_pk_fma_f32 v[128:129], v[128:129], v[136:137], v[136:137]
    v_pk_fma_f32 v[130:131], v[130:131], v[136:137], v[136:137]
    v_pk_fma_f32 v[132:133], v[132:133], v[136:137], v[136:137]
    v_pk_fma_f32 v[134:135], v[134:135], v[136:137], v[136:137]
    s_add_u32 m0, s54, 116608
    s_xor_b32 s47, s64, 4251648
    buffer_load_dwordx4 v2, s[32:35], s47 offen sc1 lds
    v_rcp_f32 v128, v128
    v_rcp_f32 v129, v129
    v_rcp_f32 v130, v130
    v_rcp_f32 v131, v131
    v_rcp_f32 v132, v132
    v_rcp_f32 v133, v133
    v_rcp_f32 v134, v134
    v_rcp_f32 v135, v135
    s_add_u32 m0, s54, 123840
    s_xor_b32 s47, s64, 2158592
    buffer_load_dwordx4 v2, s[32:35], s47 offen sc1 lds
    v_pk_mul_f32 v[128:129], v[128:129], v[72:73]
    v_pk_mul_f32 v[130:131], v[130:131], v[74:75]
    v_pk_mul_f32 v[132:133], v[132:133], v[76:77]
    v_pk_mul_f32 v[134:135], v[134:135], v[78:79]
    v_cvt_pk_bf16_f32 v64, v128, v129
    v_cvt_pk_bf16_f32 v65, v130, v131
    v_cvt_pk_bf16_f32 v66, v132, v133
    v_cvt_pk_bf16_f32 v67, v134, v135
    s_add_u32 m0, s54, 124864
    s_xor_b32 s47, s64, 4255744
    buffer_load_dwordx4 v2, s[32:35], s47 offen sc1 lds
    s_add_u32 s50, s48, 2048
    buffer_store_dwordx4 v[64:67], v2, s[32:35], s50 offen sc1
    v_pk_mul_f32 v[128:129], v[80:81], v[80:81]
    v_pk_mul_f32 v[130:131], v[82:83], v[82:83]
    v_pk_mul_f32 v[132:133], v[84:85], v[84:85]
    v_pk_mul_f32 v[134:135], v[86:87], v[86:87]
    v_pk_fma_f32 v[128:129], v[128:129], v[140:141], v[138:139]
    v_pk_fma_f32 v[130:131], v[130:131], v[140:141], v[138:139]
    v_pk_fma_f32 v[132:133], v[132:133], v[140:141], v[138:139]
    v_pk_fma_f32 v[134:135], v[134:135], v[140:141], v[138:139]
    v_pk_mul_f32 v[128:129], v[128:129], v[80:81]
    v_pk_mul_f32 v[130:131], v[130:131], v[82:83]
    v_pk_mul_f32 v[132:133], v[132:133], v[84:85]
    v_pk_mul_f32 v[134:135], v[134:135], v[86:87]
    v_exp_f32 v128, v128
    v_exp_f32 v129, v129
    v_pk_mul_f32 v[88:89], v[80:81], v[88:89]
    v_exp_f32 v130, v130
    v_exp_f32 v131, v131
    v_pk_mul_f32 v[90:91], v[82:83], v[90:91]
    v_exp_f32 v132, v132
    v_exp_f32 v133, v133
    v_pk_mul_f32 v[92:93], v[84:85], v[92:93]
    v_exp_f32 v134, v134
    v_exp_f32 v135, v135
    v_pk_mul_f32 v[94:95], v[86:87], v[94:95]
    v_pk_fma_f32 v[128:129], v[128:129], v[136:137], v[136:137]
    v_pk_fma_f32 v[130:131], v[130:131], v[136:137], v[136:137]
    v_pk_fma_f32 v[132:133], v[132:133], v[136:137], v[136:137]
    v_pk_fma_f32 v[134:135], v[134:135], v[136:137], v[136:137]
    v_rcp_f32 v128, v128
    v_rcp_f32 v129, v129
    v_rcp_f32 v130, v130
    v_rcp_f32 v131, v131
    v_rcp_f32 v132, v132
    v_rcp_f32 v133, v133
    v_rcp_f32 v134, v134
    v_rcp_f32 v135, v135
    v_pk_mul_f32 v[128:129], v[128:129], v[88:89]
    v_pk_mul_f32 v[130:131], v[130:131], v[90:91]
    v_pk_mul_f32 v[132:133], v[132:133], v[92:93]
    v_pk_mul_f32 v[134:135], v[134:135], v[94:95]
    v_cvt_pk_bf16_f32 v80, v128, v129
    v_cvt_pk_bf16_f32 v81, v130, v131
    v_cvt_pk_bf16_f32 v82, v132, v133
    v_cvt_pk_bf16_f32 v83, v134, v135
    s_cmp_lt_u32 s44, 7
    s_cselect_b32 s48, s48, 1073741824
    s_add_u32 s50, s48, 3072
    buffer_store_dwordx4 v[80:83], v2, s[32:35], s50 offen sc1
    v_pk_mul_f32 v[128:129], v[96:97], v[96:97]
    v_pk_mul_f32 v[130:131], v[98:99], v[98:99]
    v_pk_mul_f32 v[132:133], v[100:101], v[100:101]
    v_pk_mul_f32 v[134:135], v[102:103], v[102:103]
    v_pk_fma_f32 v[128:129], v[128:129], v[140:141], v[138:139]
    v_pk_fma_f32 v[130:131], v[130:131], v[140:141], v[138:139]
    v_pk_fma_f32 v[132:133], v[132:133], v[140:141], v[138:139]
    v_pk_fma_f32 v[134:135], v[134:135], v[140:141], v[138:139]
    v_pk_mul_f32 v[128:129], v[128:129], v[96:97]
    v_pk_mul_f32 v[130:131], v[130:131], v[98:99]
    v_pk_mul_f32 v[132:133], v[132:133], v[100:101]
    v_pk_mul_f32 v[134:135], v[134:135], v[102:103]
    v_exp_f32 v128, v128
    v_exp_f32 v129, v129
    v_pk_mul_f32 v[104:105], v[96:97], v[104:105]
    v_exp_f32 v130, v130
    v_exp_f32 v131, v131
    v_pk_mul_f32 v[106:107], v[98:99], v[106:107]
    v_exp_f32 v132, v132
    v_exp_f32 v133, v133
    v_pk_mul_f32 v[108:109], v[100:101], v[108:109]
    v_exp_f32 v134, v134
    v_exp_f32 v135, v135
    v_pk_mul_f32 v[110:111], v[102:103], v[110:111]
    v_pk_fma_f32 v[128:129], v[128:129], v[136:137], v[136:137]
    v_pk_fma_f32 v[130:131], v[130:131], v[136:137], v[136:137]
    v_pk_fma_f32 v[132:133], v[132:133], v[136:137], v[136:137]
    v_pk_fma_f32 v[134:135], v[134:135], v[136:137], v[136:137]
    v_rcp_f32 v128, v128
    v_rcp_f32 v129, v129
    v_rcp_f32 v130, v130
    v_rcp_f32 v131, v131
    v_rcp_f32 v132, v132
    v_rcp_f32 v133, v133
    v_rcp_f32 v134, v134
    v_rcp_f32 v135, v135
    v_pk_mul_f32 v[128:129], v[128:129], v[104:105]
    v_pk_mul_f32 v[130:131], v[130:131], v[106:107]
    v_pk_mul_f32 v[132:133], v[132:133], v[108:109]
    v_pk_mul_f32 v[134:135], v[134:135], v[110:111]
    v_cvt_pk_bf16_f32 v96, v128, v129
    v_cvt_pk_bf16_f32 v97, v130, v131
    v_cvt_pk_bf16_f32 v98, v132, v133
    v_cvt_pk_bf16_f32 v99, v134, v135
    s_add_u32 s50, s48, 4096
    buffer_store_dwordx4 v[96:99], v2, s[32:35], s50 offen sc1
    s_setprio 3
    s_branch L_G_d
L_G_v:
    s_and_b32 s47, s44, 4
    s_add_u32 s53, s44, s47
    s_lshl2_add_u32 s53, s46, s53
    s_lshl_b32 s53, s53, 6
    s_lshl_b32 s47, s44, 7
    s_sub_u32 s47, s47, s53
    s_add_u32 s47, s47, 1984
    v_mov_b32 v103, s47
    s_mul_i32 s55, s45, 3072
    s_lshl4_add_u32 s53, s55, s53
    s_add_u32 s55, s55, 16384
    v_add_u32 v100, 0, v1
    v_mul_u32_u24 v101, 43691, v100
    v_lshrrev_b32 v101, 19, v101
    v_mul_u32_u24 v102, 12, v101
    v_sub_u32 v102, v100, v102
    v_cmp_le_u32 vcc, 4, v102
    v_mul_u32_u24 v101, 3072, v101
    v_lshl_add_u32 v101, v102, 4, v101
    v_cndmask_b32 v100, 0, v103, vcc
    v_add_u32 v60, v100, v101
    v_add_u32 v100, 64, v1
    v_mul_u32_u24 v101, 43691, v100
    v_lshrrev_b32 v101, 19, v101
    v_mul_u32_u24 v102, 12, v101
    v_sub_u32 v102, v100, v102
    v_cmp_le_u32 vcc, 4, v102
    v_mul_u32_u24 v101, 3072, v101
    v_lshl_add_u32 v101, v102, 4, v101
    v_cndmask_b32 v100, 0, v103, vcc
    v_add_u32 v61, v100, v101
    v_add_u32 v100, 128, v1
    v_mul_u32_u24 v101, 43691, v100
    v_lshrrev_b32 v101, 19, v101
    v_mul_u32_u24 v102, 12, v101
    v_sub_u32 v102, v100, v102
    v_cmp_le_u32 vcc, 4, v102
    v_mul_u32_u24 v101, 3072, v101
    v_lshl_add_u32 v101, v102, 4, v101
    v_cndmask_b32 v100, 0, v103, vcc
    v_add_u32 v62, v100, v101
    s_waitcnt lgkmcnt(0)
    s_mov_b64 s[8:9], s[68:69]
    s_mov_b64 s[12:13], s[70:71]
    s_mov_b64 s[32:33], s[86:87]
    s_lshl_b32 s47, s51, 7
    s_add_u32 m0, s54, 33024
    s_add_u32 s47, s47, s52
    buffer_load_dwordx4 v117, s[8:11], s47 offen lds
    s_add_u32 m0, s54, 34048
    s_mul_i32 s48, s51, 196608
    buffer_load_dwordx4 v118, s[8:11], s47 offen lds
    s_add_u32 m0, s54, 35072
    s_add_u32 s47, s47, 16384
    buffer_load_dwordx4 v117, s[8:11], s47 offen lds
    s_add_u32 m0, s54, 36096
    s_add_u32 s48, s48, s53
    buffer_load_dwordx4 v118, s[8:11], s47 offen lds
    s_add_u32 m0, s55, 33024
    s_add_u32 s51, s51, 1
    buffer_load_dwordx4 v60, s[12:15], s48 offen lds
    s_add_u32 m0, s55, 34048
    s_nop 0
    buffer_load_dwordx4 v61, s[12:15], s48 offen lds
    s_add_u32 m0, s55, 35072
    s_nop 0
    buffer_load_dwordx4 v62, s[12:15], s48 offen lds
    s_and_b32 s51, s51, 7
    buffer_load_dword v106, v106, s[32:35], 0 offen sc1
    v_and_b32 v100, 31, v1
    s_lshl_b32 s47, s45, 5
    v_add_u32 v100, s47, v100
    v_lshrrev_b32 v101, 1, v100
    v_lshrrev_b32 v102, 5, v1
    v_xor_b32 v101, v101, v102
    v_and_b32 v101, 7, v101
    v_lshlrev_b32 v101, 4, v101
    v_lshl_add_u32 v112, v100, 7, v101
    v_xor_b32 v113, 32, v112
    v_xor_b32 v114, 64, v112
    v_xor_b32 v115, 96, v112
    v_lshrrev_b32 v100, 5, v1
    v_lshlrev_b32 v100, 3, v100
    v_bfe_u32 v101, v1, 2, 2
    v_add_u32 v100, v100, v101
    v_bfe_u32 v102, v1, 4, 1
    v_and_b32 v103, 3, v1
    v_lshlrev_b32 v103, 3, v103
    v_mul_u32_u24 v116, 192, v100
    v_lshl_add_u32 v116, v102, 5, v116
    v_add_u32 v116, v116, v103
    s_min_u32 s47, s45, 2
    s_lshl_b32 s47, s47, 6
    s_add_u32 s47, s47, 16384
    v_add_u32 v116, s47, v116
    v_mul_u32_u24 v3, 192, v100
    v_mul_u32_u24 v102, 12320, v102
    v_add3_u32 v3, v3, v102, v103
    v_add_u32 v3, 132096, v3
    v_lshrrev_b32 v100, 4, v1
    v_cmp_eq_u32 vcc, v100, v101
    v_mov_b32 v101, 0x3f803f80
    v_mov_b32 v7, 156736
    v_cndmask_b32 v124, 0, v101, vcc
    v_mov_b32 v125, v124
    v_mov_b32 v126, v124
    v_mov_b32 v127, v124
    s_mov_b64 s[16:17], s[76:77]
    s_mov_b32 s18, 1409024
    s_mov_b32 s19, 0x00020000
    s_mov_b64 s[20:21], s[78:79]
    s_mov_b32 s22, 1409024
    s_mov_b32 s23, 0x00020000
    s_mov_b64 s[24:25], s[80:81]
    s_mov_b32 s26, 1409024
    s_mov_b32 s27, 0x00020000
    s_mov_b64 s[28:29], s[72:73]
    s_mov_b32 s30, 524288
    s_mov_b32 s31, 0x00020000
    s_mov_b64 s[36:37], s[82:83]
    s_mov_b32 s38, 2097152
    s_mov_b32 s39, 0x00020000
    s_lshl_b32 s47, s51, 7
    s_add_u32 m0, s54, 66048
    s_add_u32 s47, s47, s52
    buffer_load_dwordx4 v117, s[8:11], s47 offen lds
    s_add_u32 m0, s54, 67072
    s_mul_i32 s48, s51, 196608
    buffer_load_dwordx4 v118, s[8:11], s47 offen lds
    s_add_u32 m0, s54, 68096
    s_add_u32 s47, s47, 16384
    buffer_load_dwordx4 v117, s[8:11], s47 offen lds
    s_add_u32 m0, s54, 69120
    s_add_u32 s48, s48, s53
    buffer_load_dwordx4 v118, s[8:11], s47 offen lds
    s_add_u32 m0, s55, 66048
    s_add_u32 s51, s51, 1
    buffer_load_dwordx4 v60, s[12:15], s48 offen lds
    s_add_u32 m0, s55, 67072
    s_nop 0
    buffer_load_dwordx4 v61, s[12:15], s48 offen lds
    s_add_u32 m0, s55, 68096
    s_nop 0
    buffer_load_dwordx4 v62, s[12:15], s48 offen lds
    s_and_b32 s51, s51, 7
    v_and_b32 v107, 28, v1
    v_and_b32 v108, 31, v1
    v_add_u32 v107, v107, v108
    s_lshl_b32 s50, s43, 2
    s_add_u32 s50, s50, s45
    s_lshl_b32 s50, s50, 10
    s_add_u32 s50, s50, 14155776
    v_lshl_add_u32 v107, v107, 4, s50
    v_add_u32 v100, 0, v1
    v_mul_u32_u24 v101, 43691, v100
    v_lshrrev_b32 v101, 19, v101
    v_mul_u32_u24 v102, 12, v101
    v_sub_u32 v102, v100, v102
    v_mul_u32_u24 v101, 2752, v101
    v_lshl_add_u32 v4, v102, 4, v101
    v_add_u32 v100, 64, v1
    v_mul_u32_u24 v101, 43691, v100
    v_lshrrev_b32 v101, 19, v101
    v_mul_u32_u24 v102, 12, v101
    v_sub_u32 v102, v100, v102
    v_mul_u32_u24 v101, 2752, v101
    v_lshl_add_u32 v5, v102, 4, v101
    v_add_u32 v100, 128, v1
    v_mul_u32_u24 v101, 43691, v100
    v_lshrrev_b32 v101, 19, v101
    v_mul_u32_u24 v102, 12, v101
    v_sub_u32 v102, v100, v102
    v_mul_u32_u24 v101, 2752, v101
    v_lshl_add_u32 v6, v102, 4, v101
    s_mul_i32 s56, s44, 192
    s_mul_i32 s50, s45, 44032
    s_add_u32 s56, s56, s50
    s_add_u32 s56, s56, 0
    s_mul_i32 s57, s45, 3072
    v_and_b32 v100, 15, v1
    v_bfe_u32 v101, v1, 4, 1
    v_lshl_add_u32 v100, v100, 1, v101
    v_lshrrev_b32 v101, 5, v1
    v_lshlrev_b32 v101, 30, v101
    v_lshl_add_u32 v99, v100, 3, v101
    s_waitcnt vmcnt(7)
    s_waitcnt lgkmcnt(0)
    s_barrier
    ds_read_b128 v[128:131], v112 offset:33024
    ds_read_b128 v[132:135], v113 offset:33024
    ds_read_b128 v[136:139], v114 offset:33024
    ds_read_b128 v[140:143], v115 offset:33024
    ds_read_b64_tr_b16 v[64:65], v116 offset:33024
    ds_read_b64_tr_b16 v[66:67], v116 offset:33792
    ds_read_b64_tr_b16 v[68:69], v116 offset:36096
    ds_read_b64_tr_b16 v[70:71], v116 offset:36864
    ds_read_b64_tr_b16 v[72:73], v116 offset:39168
    ds_read_b64_tr_b16 v[74:75], v116 offset:39936
    ds_read_b64_tr_b16 v[76:77], v116 offset:42240
    ds_read_b64_tr_b16 v[78:79], v116 offset:43008
    s_lshl_b32 s47, s51, 7
    s_add_u32 m0, s54, 99072
    s_add_u32 s47, s47, s52
    buffer_load_dwordx4 v117, s[8:11], s47 offen lds
    v_readfirstlane_b32 s58, v106
    s_add_u32 m0, s54, 100096
    s_mul_i32 s48, s51, 196608
    buffer_load_dwordx4 v118, s[8:11], s47 offen lds
    s_mul_i32 s58, s58, 0x9e3779b1
    s_add_u32 s58, s58, 0x7f4a7c15
    s_add_u32 m0, s54, 101120
    s_add_u32 s47, s47, 16384
    buffer_load_dwordx4 v117, s[8:11], s47 offen lds
    s_waitcnt lgkmcnt(0)
    v_mfma_f32_16x16x32_bf16 v[120:123], v[124:127], v[64:67], 0
    v_mfma_f32_16x16x32_bf16 v[120:123], v[124:127], v[68:71], v[120:123]
    v_mfma_f32_16x16x32_bf16 v[120:123], v[124:127], v[72:75], v[120:123]
    v_mfma_f32_16x16x32_bf16 v[120:123], v[124:127], v[76:79], v[120:123]
    s_add_u32 m0, s54, 102144
    s_add_u32 s48, s48, s53
    buffer_load_dwordx4 v118, s[8:11], s47 offen lds
    s_nop 4
    v_mov_b32 v122, v120
    v_mov_b32 v121, s58
    s_add_u32 m0, s55, 99072
    s_add_u32 s51, s51, 1
    buffer_load_dwordx4 v60, s[12:15], s48 offen lds
    v_permlane32_swap_b32 v120, v122
    s_lshl_b32 s50, s63, 8
    s_add_u32 s50, s50, 15728640
    v_add_f32 v120, v120, v122
    buffer_store_dwordx2 v[120:121], v99, s[32:35], s50 offen sc1
    s_add_u32 m0, s55, 100096
    s_nop 0
    buffer_load_dwordx4 v61, s[12:15], s48 offen lds
    s_add_u32 m0, s55, 101120
    s_nop 0
    buffer_load_dwordx4 v62, s[12:15], s48 offen lds
    s_and_b32 s51, s51, 7
    s_lshl_b32 s47, s51, 7
    s_add_u32 m0, s54, 0
    s_add_u32 s47, s47, s52
    buffer_load_dwordx4 v117, s[8:11], s47 offen lds
    s_add_u32 m0, s54, 1024
    s_mul_i32 s48, s51, 196608
    buffer_load_dwordx4 v118, s[8:11], s47 offen lds
    s_add_u32 m0, s54, 2048
    s_add_u32 s47, s47, 16384
    buffer_load_dwordx4 v117, s[8:11], s47 offen lds
    s_add_u32 m0, s54, 3072
    s_add_u32 s48, s48, s53
    buffer_load_dwordx4 v118, s[8:11], s47 offen lds
    s_waitcnt vmcnt(12)
    s_waitcnt lgkmcnt(0)
    s_barrier
    v_add_u32 v112, 66048, v112
    v_add_u32 v113, 66048, v113
    v_add_u32 v114, 66048, v114
    v_add_u32 v115, 66048, v115
    ds_read_b128 v[144:147], v112 offset:0
    ds_read_b128 v[148:151], v113 offset:0
    ds_read_b128 v[152:155], v114 offset:0
    ds_read_b128 v[156:159], v115 offset:0
    s_add_u32 m0, s55, 0
    s_add_u32 s51, s51, 1
    buffer_load_dwordx4 v60, s[12:15], s48 offen lds
    s_and_b32 s50, s60, 7
    v_xor_b32 v100, s50, v1
    s_and_b32 s50, s60, 28
    s_add_u32 s50, s50, s45
    s_lshl_b32 s50, s50, 6
    v_add_u32 v100, s50, v100
    s_lshl2_add_u32 s50, s44, s45
    s_lshl_b32 s50, s50, 6
    s_add_u32 s50, s50, s43
    v_mov_b32 v101, s50
    s_lshl_b32 s49, s61, 1
    s_and_b32 s50, s60, 6
    s_xor_b32 s49, s49, s50
    s_lshl_b32 s49, 3, s49
    s_or_b32 vcc_lo, s49, 0x101
    s_mov_b32 vcc_hi, 0
    v_cndmask_b32 v100, v101, v100, vcc
    s_add_u32 m0, s55, 1024
    s_nop 0
    buffer_load_dwordx4 v61, s[12:15], s48 offen lds
    s_and_b32 s49, s44, 4
    s_add_u32 s50, s44, s49
    s_lshl2_add_u32 s50, s46, s50
    s_andn2_b32 s50, s50, 1
    s_lshl1_add_u32 s50, s50, s45
    s_lshl_b32 s50, s50, 6
    s_add_u32 s50, s50, s43
    v_writelane_b32 v100, s50, 63
    v_lshlrev_b32 v106, 7, v100
    v_add_u32 v106, 14229504, v106
    s_add_u32 m0, s55, 2048
    s_nop 0
    buffer_load_dwordx4 v62, s[12:15], s48 offen lds
    s_and_b32 s51, s51, 7
    s_add_u32 s65, s63, 0
    s_and_b32 s65, s65, 7
    s_mul_i32 s65, s65, 176128
    s_add_u32 m0, s57, 132096
    s_add_u32 s65, s65, s56
    buffer_load_dwordx4 v4, s[16:19], s65 offen lds
    s_add_u32 m0, s57, 133120
    s_nop 0
    buffer_load_dwordx4 v5, s[16:19], s65 offen lds
    s_waitcnt vmcnt(9)
    s_waitcnt lgkmcnt(0)
    s_barrier
    ds_read_b128 v[160:163], v112 offset:33024
    ds_read_b128 v[164:167], v113 offset:33024
    ds_read_b128 v[168:171], v114 offset:33024
    ds_read_b128 v[172:175], v115 offset:33024
    s_lshl_b32 s47, s51, 7
    s_add_u32 m0, s54, 33024
    s_add_u32 s47, s47, s52
    buffer_load_dwordx4 v117, s[8:11], s47 offen lds
    s_add_u32 m0, s54, 34048
    s_mul_i32 s48, s51, 196608
    buffer_load_dwordx4 v118, s[8:11], s47 offen lds
    s_add_u32 m0, s54, 35072
    s_add_u32 s47, s47, 16384
    buffer_load_dwordx4 v117, s[8:11], s47 offen lds
    s_add_u32 m0, s54, 36096
    s_add_u32 s48, s48, s53
    buffer_load_dwordx4 v118, s[8:11], s47 offen lds
    s_add_u32 m0, s55, 33024
    s_add_u32 s51, s51, 1
    buffer_load_dwordx4 v60, s[12:15], s48 offen lds
    s_add_u32 m0, s55, 34048
    s_nop 0
    buffer_load_dwordx4 v61, s[12:15], s48 offen lds
    s_add_u32 m0, s55, 35072
    s_nop 0
    buffer_load_dwordx4 v62, s[12:15], s48 offen lds
    s_and_b32 s51, s51, 7
    s_add_u32 m0, s57, 134144
    s_nop 0
    buffer_load_dwordx4 v6, s[16:19], s65 offen lds
    s_add_u32 m0, s57, 144416
    s_nop 0
    buffer_load_dwordx4 v4, s[20:23], s65 offen lds
    s_waitcnt vmcnt(11)
    s_waitcnt lgkmcnt(0)
    s_barrier
    v_subrev_u32 v112, 66048, v112
    v_subrev_u32 v113, 66048, v113
    v_subrev_u32 v114, 66048, v114
    v_subrev_u32 v115, 66048, v115
    ds_read_b128 v[176:179], v112 offset:0
    ds_read_b128 v[180:183], v113 offset:0
    ds_read_b128 v[184:187], v114 offset:0
    ds_read_b128 v[188:191], v115 offset:0
    s_lshl_b32 s47, s51, 7
    s_add_u32 m0, s54, 66048
    s_add_u32 s47, s47, s52
    buffer_load_dwordx4 v117, s[8:11], s47 offen lds
    s_add_u32 m0, s54, 67072
    s_mul_i32 s48, s51, 196608
    buffer_load_dwordx4 v118, s[8:11], s47 offen lds
    s_add_u32 m0, s54, 68096
    s_add_u32 s47, s47, 16384
    buffer_load_dwordx4 v117, s[8:11], s47 offen lds
    s_add_u32 m0, s54, 69120
    s_add_u32 s48, s48, s53
    buffer_load_dwordx4 v118, s[8:11], s47 offen lds
    s_add_u32 m0, s55, 66048
    s_add_u32 s51, s51, 1
    buffer_load_dwordx4 v60, s[12:15], s48 offen lds
    s_add_u32 m0, s55, 67072
    s_nop 0
    buffer_load_dwordx4 v61, s[12:15], s48 offen lds
    s_add_u32 m0, s55, 68096
    s_nop 0
    buffer_load_dwordx4 v62, s[12:15], s48 offen lds
    s_and_b32 s51, s51, 7
    s_add_u32 m0, s57, 145440
    s_nop 0
    buffer_load_dwordx4 v5, s[20:23], s65 offen lds
    s_add_u32 m0, s57, 146464
    s_nop 0
    buffer_load_dwordx4 v6, s[20:23], s65 offen lds
    s_waitcnt vmcnt(11)
    s_waitcnt lgkmcnt(0)
    s_barrier
    ds_read_b128 v[192:195], v112 offset:33024
    ds_read_b128 v[196:199], v113 offset:33024
    ds_read_b128 v[200:203], v114 offset:33024
    ds_read_b128 v[204:207], v115 offset:33024
    s_lshl_b32 s47, s51, 7
    s_add_u32 m0, s54, 99072
    s_add_u32 s47, s47, s52
    buffer_load_dwordx4 v117, s[8:11], s47 offen lds
    s_add_u32 m0, s54, 100096
    s_mul_i32 s48, s51, 196608
    buffer_load_dwordx4 v118, s[8:11], s47 offen lds
    s_add_u32 m0, s54, 101120
    s_add_u32 s47, s47, 16384
    buffer_load_dwordx4 v117, s[8:11], s47 offen lds
    s_add_u32 m0, s54, 102144
    s_add_u32 s48, s48, s53
    buffer_load_dwordx4 v118, s[8:11], s47 offen lds
    s_add_u32 m0, s55, 99072
    s_add_u32 s51, s51, 1
    buffer_load_dwordx4 v60, s[12:15], s48 offen lds
    s_add_u32 m0, s55, 100096
    s_nop 0
    buffer_load_dwordx4 v61, s[12:15], s48 offen lds
    s_add_u32 m0, s55, 101120
    s_nop 0
    buffer_load_dwordx4 v62, s[12:15], s48 offen lds
    s_and_b32 s51, s51, 7
    s_waitcnt vmcnt(9)
    s_waitcnt lgkmcnt(0)
    s_barrier
    v_add_u32 v112, 66048, v112
    v_add_u32 v113, 66048, v113
    v_add_u32 v114, 66048, v114
    v_add_u32 v115, 66048, v115
    ds_read_b128 v[208:211], v112 offset:0
    ds_read_b128 v[212:215], v113 offset:0
    ds_read_b128 v[216:219], v114 offset:0
    ds_read_b128 v[220:223], v115 offset:0
    buffer_load_dwordx4 v[108:111], v107, s[32:35], 0 offen sc1
    s_lshl_b32 s50, s67, 8
    s_add_u32 s50, s50, 15728640
    buffer_load_dwordx4 v[48:51], v2, s[32:35], s50 offen offset:0 sc1
    buffer_load_dwordx4 v[52:55], v2, s[32:35], s50 offen offset:1024 sc1
    buffer_load_dword v56, v106, s[32:35], 0 offen sc1
    s_lshl_b32 s47, s51, 7
    s_add_u32 m0, s54, 0
    s_add_u32 s47, s47, s52
    buffer_load_dwordx4 v117, s[8:11], s47 offen lds
    s_add_u32 m0, s54, 1024
    s_mul_i32 s48, s51, 196608
    buffer_load_dwordx4 v118, s[8:11], s47 offen lds
    s_add_u32 m0, s54, 2048
    s_add_u32 s47, s47, 16384
    buffer_load_dwordx4 v117, s[8:11], s47 offen lds
    s_add_u32 m0, s54, 3072
    s_add_u32 s48, s48, s53
    buffer_load_dwordx4 v118, s[8:11], s47 offen lds
    s_add_u32 m0, s55, 0
    s_add_u32 s51, s51, 1
    buffer_load_dwordx4 v60, s[12:15], s48 offen lds
    s_add_u32 m0, s55, 1024
    s_nop 0
    buffer_load_dwordx4 v61, s[12:15], s48 offen lds
    s_add_u32 m0, s55, 2048
    s_nop 0
    buffer_load_dwordx4 v62, s[12:15], s48 offen lds
    s_and_b32 s51, s51, 7
    s_waitcnt vmcnt(11)
    s_waitcnt lgkmcnt(0)
    s_barrier
    ds_read_b128 v[224:227], v112 offset:33024
    ds_read_b128 v[228:231], v113 offset:33024
    ds_read_b128 v[232:235], v114 offset:33024
    ds_read_b128 v[236:239], v115 offset:33024
    s_add_u32 s65, s63, 1
    s_and_b32 s65, s65, 7
    s_mul_i32 s65, s65, 176128
    s_add_u32 m0, s57, 33024
    s_add_u32 s65, s65, s56
    buffer_load_dwordx4 v4, s[16:19], s65 offen lds
    s_lshl_b32 s50, s45, 5
    v_add_u32 v100, s50, v3
    v_lshrrev_b32 v101, 5, v1
    v_lshl_add_u32 v101, v101, 30, v2
    ds_read_b64_tr_b16 v[64:65], v100 offset:0
    ds_read_b64_tr_b16 v[66:67], v100 offset:768
    ds_read_b64_tr_b16 v[68:69], v100 offset:3072
    ds_read_b64_tr_b16 v[70:71], v100 offset:3840
    ds_read_b64_tr_b16 v[72:73], v100 offset:6144
    ds_read_b64_tr_b16 v[74:75], v100 offset:6912
    s_add_u32 m0, s57, 34048
    s_nop 0
    buffer_load_dwordx4 v5, s[16:19], s65 offen lds
    ds_read_b64_tr_b16 v[76:77], v100 offset:9216
    ds_read_b64_tr_b16 v[78:79], v100 offset:9984
    ds_read_b64_tr_b16 v[80:81], v100 offset:128
    ds_read_b64_tr_b16 v[82:83], v100 offset:896
    ds_read_b64_tr_b16 v[84:85], v100 offset:3200
    ds_read_b64_tr_b16 v[86:87], v100 offset:3968
    ds_read_b64_tr_b16 v[88:89], v100 offset:6272
    ds_read_b64_tr_b16 v[90:91], v100 offset:7040
    ds_read_b64_tr_b16 v[92:93], v100 offset:9344
    ds_read_b64_tr_b16 v[94:95], v100 offset:10112
    s_add_u32 m0, s57, 35072
    s_nop 0
    buffer_load_dwordx4 v6, s[16:19], s65 offen lds
    s_waitcnt lgkmcnt(0)
    v_mfma_f32_16x16x32_bf16 v[120:123], v[124:127], v[64:67], 0
    v_mfma_f32_16x16x32_bf16 v[96:99], v[124:127], v[80:83], 0
    v_mfma_f32_16x16x32_bf16 v[120:123], v[124:127], v[68:71], v[120:123]
    v_mfma_f32_16x16x32_bf16 v[96:99], v[124:127], v[84:87], v[96:99]
    v_mfma_f32_16x16x32_bf16 v[120:123], v[124:127], v[72:75], v[120:123]
    v_mfma_f32_16x16x32_bf16 v[96:99], v[124:127], v[88:91], v[96:99]
    v_mfma_f32_16x16x32_bf16 v[120:123], v[124:127], v[76:79], v[120:123]
    v_mfma_f32_16x16x32_bf16 v[96:99], v[124:127], v[92:95], v[96:99]
    s_add_u32 m0, s57, 45344
    s_nop 0
    buffer_load_dwordx4 v4, s[20:23], s65 offen lds
    s_nop 3
    v_mov_b32 v121, v120
    v_mov_b32 v122, v96
    v_mov_b32 v123, s58
    v_permlane32_swap_b32 v120, v121
    v_permlane32_swap_b32 v96, v122
    v_add_f32 v120, v120, v121
    s_add_u32 m0, s57, 46368
    s_nop 0
    buffer_load_dwordx4 v5, s[20:23], s65 offen lds
    v_add_f32 v122, v122, v96
    v_mov_b32 v121, s58
    s_lshl_b32 s50, s63, 9
    s_add_u32 s50, s50, 15990784
    buffer_store_dwordx4 v[120:123], v101, s[32:35], s50 offen sc1
    s_add_u32 m0, s57, 47392
    s_nop 0
    buffer_load_dwordx4 v6, s[20:23], s65 offen lds
    s_waitcnt vmcnt(7)
    s_waitcnt lgkmcnt(0)
    s_barrier
    s_setprio 3
    v_subrev_u32 v112, 66048, v112
    v_subrev_u32 v113, 66048, v113
    v_subrev_u32 v114, 66048, v114
    v_subrev_u32 v115, 66048, v115
    ds_read_b128 v[240:243], v112 offset:0
    ds_read_b128 v[244:247], v113 offset:0
    ds_read_b128 v[248:251], v114 offset:0
    ds_read_b128 v[252:255], v115 offset:0
    v_and_b32 v102, 31, v1
    s_lshl_b32 s49, s45, 7
    s_add_u32 s49, s49, 161088
    v_lshl_add_u32 v102, v102, 2, s49
    s_lshl_b32 s49, s45, 3
    s_add_u32 s49, s49, 156992
    v_lshl_add_u32 v103, v1, 5, s49
    v_xor_b32 v100, s58, v109
    v_xor_b32 v101, s58, v111
    v_or_b32 v100, v100, v101
    v_xor_b32 v101, s58, v56
    v_or_b32 v100, v100, v101
    v_xor_b32 v101, s58, v49
    v_or_b32 v100, v100, v101
    v_xor_b32 v101, s58, v51
    v_or_b32 v100, v100, v101
    v_xor_b32 v101, s58, v53
    v_or_b32 v100, v100, v101
    v_xor_b32 v101, s58, v55
    v_or_b32 v100, v100, v101
    v_cmp_ne_u32 vcc, 0, v100
    s_nop 0
    s_cbranch_vccz L_st_ok_43
L_st_sl_44:
    s_mov_b32 s62, 65536
    s_nop 15
L_st_lp_45:
    s_sleep 1
    buffer_load_dwordx4 v[108:111], v107, s[32:35], 0 offen sc1
    s_lshl_b32 s50, s67, 8
    s_add_u32 s50, s50, 15728640
    buffer_load_dwordx4 v[48:51], v2, s[32:35], s50 offen offset:0 sc1
    buffer_load_dwordx4 v[52:55], v2, s[32:35], s50 offen offset:1024 sc1
    buffer_load_dword v56, v106, s[32:35], 0 offen sc1
    s_sub_u32 s62, s62, 1
    s_waitcnt vmcnt(0)
    s_cbranch_scc1 L_st_ok_43
    v_xor_b32 v100, s58, v109
    v_xor_b32 v101, s58, v111
    v_or_b32 v100, v100, v101
    v_xor_b32 v101, s58, v56
    v_or_b32 v100, v100, v101
    v_xor_b32 v101, s58, v49
    v_or_b32 v100, v100, v101
    v_xor_b32 v101, s58, v51
    v_or_b32 v100, v100, v101
    v_xor_b32 v101, s58, v53
    v_or_b32 v100, v100, v101
    v_xor_b32 v101, s58, v55
    v_or_b32 v100, v100, v101
    v_cmp_ne_u32 vcc, 0, v100
    s_nop 0
    s_cbranch_vccnz L_st_lp_45
L_st_ok_43:
    v_add_f32 v48, v48, v52
    v_add_f32 v50, v50, v54
    v_rsq_f32 v109, v110
    ds_write_b32 v102, v108 offset:512
    ds_write_b32 v102, v110 offset:1024
    v_permlane16_swap_b32 v48, v50
    v_mul_f32 v109, 0x4d800000, v109
    ds_write_b32 v102, v109
    v_add_f32 v48, v48, v50
    v_cvt_pk_bf16_f32 v104, v48, v48
    v_and_b32 v101, 0xffff0000, v104
    v_sub_f32 v101, v48, v101
    v_cvt_pk_bf16_f32 v105, v101, v101
    ds_write_b64 v103, v[104:105]
    s_mov_b64 exec, 1
    ds_add_u32 v7, v7 offset:0
    s_mov_b64 exec, -1
    s_waitcnt lgkmcnt(5)
    s_mov_b64 exec, 1
    ds_add_u32 v7, v7 offset:12
    s_mov_b64 exec, -1
    s_setprio 0
    s_setprio 0
    v_subrev_u32 v3, 49536, v3
    ds_read_b64_tr_b16 v[8:9], v3 offset:49536
    ds_read_b64_tr_b16 v[10:11], v3 offset:50304
    ds_read_b64_tr_b16 v[12:13], v3 offset:49568
    ds_read_b64_tr_b16 v[14:15], v3 offset:50336
    ds_read_b64_tr_b16 v[16:17], v3 offset:49600
    ds_read_b64_tr_b16 v[18:19], v3 offset:50368
    ds_read_b64_tr_b16 v[20:21], v3 offset:49632
    ds_read_b64_tr_b16 v[22:23], v3 offset:50400
    ds_read_b64_tr_b16 v[24:25], v3 offset:49664
    ds_read_b64_tr_b16 v[26:27], v3 offset:50432
    ds_read_b64_tr_b16 v[28:29], v3 offset:49696
    ds_read_b64_tr_b16 v[30:31], v3 offset:50464
    s_waitcnt lgkmcnt(10)
    v_mfma_f32_32x32x16_bf16 v[32:47], v[8:11], v[128:131], 0
    s_waitcnt vmcnt(0)
    s_mov_b64 exec, 1
    ds_add_u32 v7, v7 offset:68
    s_mov_b64 exec, -1
    s_add_u32 s65, s63, 2
    s_and_b32 s65, s65, 7
    s_mul_i32 s65, s65, 176128
    s_add_u32 m0, s57, 57664
    s_add_u32 s65, s65, s56
    buffer_load_dwordx4 v4, s[16:19], s65 offen lds
    ds_read_b64_tr_b16 v[8:9], v3 offset:52608
    ds_read_b64_tr_b16 v[10:11], v3 offset:53376
    s_waitcnt lgkmcnt(11)
    v_mfma_f32_32x32x16_bf16 v[48:63], v[12:15], v[128:131], 0
    s_add_u32 m0, s57, 58688
    s_nop 0
    buffer_load_dwordx4 v5, s[16:19], s65 offen lds
    ds_read_b64_tr_b16 v[12:13], v3 offset:52640
    ds_read_b64_tr_b16 v[14:15], v3 offset:53408
    s_waitcnt lgkmcnt(11)
    v_mfma_f32_32x32x16_bf16 v[64:79], v[16:19], v[128:131], 0
    ds_read_b32 v0, v7 offset:68
    s_add_u32 m0, s57, 59712
    s_nop 0
    buffer_load_dwordx4 v6, s[16:19], s65 offen lds
    ds_read_b64_tr_b16 v[16:17], v3 offset:52672
    ds_read_b64_tr_b16 v[18:19], v3 offset:53440
    s_waitcnt lgkmcnt(12)
    v_mfma_f32_32x32x16_bf16 v[80:95], v[20:23], v[128:131], 0
    s_add_u32 m0, s57, 69984
    s_nop 0
    buffer_load_dwordx4 v4, s[20:23], s65 offen lds
    ds_read_b64_tr_b16 v[20:21], v3 offset:52704
    ds_read_b64_tr_b16 v[22:23], v3 offset:53472
    s_waitcnt lgkmcnt(12)
    v_mfma_f32_32x32x16_bf16 v[96:111], v[24:27], v[128:131], 0
    s_add_u32 m0, s57, 71008
    s_nop 0
    buffer_load_dwordx4 v5, s[20:23], s65 offen lds
    ds_read_b64_tr_b16 v[24:25], v3 offset:52736
    ds_read_b64_tr_b16 v[26:27], v3 offset:53504
    s_waitcnt lgkmcnt(12)
    v_mfma_f32_32x32x16_bf16 v[112:127], v[28:31], v[128:131], 0
    s_add_u32 m0, s57, 72032
    s_nop 0
    buffer_load_dwordx4 v6, s[20:23], s65 offen lds
    ds_read_b64_tr_b16 v[28:29], v3 offset:52768
    ds_read_b64_tr_b16 v[30:31], v3 offset:53536
    s_waitcnt lgkmcnt(11)
    v_mfma_f32_32x32x16_bf16 v[32:47], v[8:11], v[132:135], v[32:47]
    ds_read_b64_tr_b16 v[8:9], v3 offset:55680
    ds_read_b64_tr_b16 v[10:11], v3 offset:56448
    s_waitcnt lgkmcnt(11)
    v_mfma_f32_32x32x16_bf16 v[48:63], v[12:15], v[132:135], v[48:63]
    s_waitcnt lgkmcnt(10)
    v_cmp_ne_u32 vcc, 626944, v0
    s_nop 0
    s_cbranch_vccz L_eBE0_ok_46
L_eBE0_sl_47:
    s_sleep 1
    ds_read_b32 v0, v7 offset:68
    s_waitcnt lgkmcnt(0)
    v_cmp_ne_u32 vcc, 626944, v0
    s_nop 0
    s_cbranch_vccnz L_eBE0_sl_47
L_eBE0_ok_46:
    ds_read_b64_tr_b16 v[12:13], v3 offset:55712
    ds_read_b64_tr_b16 v[14:15], v3 offset:56480
    s_waitcnt lgkmcnt(10)
    v_mfma_f32_32x32x16_bf16 v[64:79], v[16:19], v[132:135], v[64:79]
    ds_read_b64_tr_b16 v[16:17], v3 offset:55744
    ds_read_b64_tr_b16 v[18:19], v3 offset:56512
    s_waitcnt lgkmcnt(10)
    v_mfma_f32_32x32x16_bf16 v[80:95], v[20:23], v[132:135], v[80:95]
    ds_read_b64_tr_b16 v[20:21], v3 offset:55776
    ds_read_b64_tr_b16 v[22:23], v3 offset:56544
    s_waitcnt lgkmcnt(10)
    v_mfma_f32_32x32x16_bf16 v[96:111], v[24:27], v[132:135], v[96:111]
    ds_read_b64_tr_b16 v[24:25], v3 offset:55808
    ds_read_b64_tr_b16 v[26:27], v3 offset:56576
    s_waitcnt lgkmcnt(10)
    v_mfma_f32_32x32x16_bf16 v[112:127], v[28:31], v[132:135], v[112:127]
    ds_read_b64_tr_b16 v[28:29], v3 offset:55840
    ds_read_b64_tr_b16 v[30:31], v3 offset:56608
    s_waitcnt lgkmcnt(10)
    v_mfma_f32_32x32x16_bf16 v[32:47], v[8:11], v[136:139], v[32:47]
    ds_read_b64_tr_b16 v[8:9], v3 offset:58752
    ds_read_b64_tr_b16 v[10:11], v3 offset:59520
    s_waitcnt lgkmcnt(10)
    v_mfma_f32_32x32x16_bf16 v[48:63], v[12:15], v[136:139], v[48:63]
    ds_read_b64_tr_b16 v[12:13], v3 offset:58784
    ds_read_b64_tr_b16 v[14:15], v3 offset:59552
    s_waitcnt lgkmcnt(10)
    v_mfma_f32_32x32x16_bf16 v[64:79], v[16:19], v[136:139], v[64:79]
    ds_read_b64_tr_b16 v[16:17], v3 offset:58816
    ds_read_b64_tr_b16 v[18:19], v3 offset:59584
    s_waitcnt lgkmcnt(10)
    v_mfma_f32_32x32x16_bf16 v[80:95], v[20:23], v[136:139], v[80:95]
    ds_read_b64_tr_b16 v[20:21], v3 offset:58848
    ds_read_b64_tr_b16 v[22:23], v3 offset:59616
    s_waitcnt lgkmcnt(10)
    v_mfma_f32_32x32x16_bf16 v[96:111], v[24:27], v[136:139], v[96:111]
    ds_read_b64_tr_b16 v[24:25], v3 offset:58880
    ds_read_b64_tr_b16 v[26:27], v3 offset:59648
    s_waitcnt lgkmcnt(10)
    v_mfma_f32_32x32x16_bf16 v[112:127], v[28:31], v[136:139], v[112:127]
    ds_read_b64_tr_b16 v[28:29], v3 offset:58912
    ds_read_b64_tr_b16 v[30:31], v3 offset:59680
    s_waitcnt lgkmcnt(10)
    v_mfma_f32_32x32x16_bf16 v[32:47], v[8:11], v[140:143], v[32:47]
    v_subrev_u32 v3, 49536, v3
    ds_read_b64_tr_b16 v[8:9], v3 offset:0
    ds_read_b64_tr_b16 v[10:11], v3 offset:768
    s_waitcnt lgkmcnt(10)
    v_mfma_f32_32x32x16_bf16 v[48:63], v[12:15], v[140:143], v[48:63]
    ds_read_b64_tr_b16 v[12:13], v3 offset:32
    ds_read_b64_tr_b16 v[14:15], v3 offset:800
    s_waitcnt lgkmcnt(10)
    v_mfma_f32_32x32x16_bf16 v[64:79], v[16:19], v[140:143], v[64:79]
    ds_read_b64_tr_b16 v[16:17], v3 offset:64
    ds_read_b64_tr_b16 v[18:19], v3 offset:832
    s_waitcnt lgkmcnt(10)
    v_mfma_f32_32x32x16_bf16 v[80:95], v[20:23], v[140:143], v[80:95]
    ds_read_b64_tr_b16 v[20:21], v3 offset:96
    ds_read_b64_tr_b16 v[22:23], v3 offset:864
    s_waitcnt lgkmcnt(10)
    v_mfma_f32_32x32x16_bf16 v[96:111], v[24:27], v[140:143], v[96:111]
    ds_read_b64_tr_b16 v[24:25], v3 offset:128
    ds_read_b64_tr_b16 v[26:27], v3 offset:896
    s_waitcnt lgkmcnt(10)
    v_mfma_f32_32x32x16_bf16 v[112:127], v[28:31], v[140:143], v[112:127]
    ds_read_b64_tr_b16 v[28:29], v3 offset:160
    ds_read_b64_tr_b16 v[30:31], v3 offset:928
    s_waitcnt lgkmcnt(10)
    v_mfma_f32_32x32x16_bf16 v[32:47], v[8:11], v[144:147], v[32:47]
    s_waitcnt vmcnt(0)
    s_mov_b64 exec, 1
    ds_add_u32 v7, v7 offset:72
    s_mov_b64 exec, -1
    s_setprio 3
    v_and_b32 v128, 31, v1
    s_lshl_b32 s50, s45, 7
    s_add_u32 s50, s50, 161088
    v_lshl_add_u32 v128, v128, 2, s50
    ds_read_b32 v138, v128 offset:0
    ds_read_b32 v139, v128 offset:512
    ds_read_b32 v136, v128 offset:1024
    s_setprio 0
    ds_read_b64_tr_b16 v[8:9], v3 offset:3072
    ds_read_b64_tr_b16 v[10:11], v3 offset:3840
    s_waitcnt lgkmcnt(14)
    v_mfma_f32_32x32x16_bf16 v[48:63], v[12:15], v[144:147], v[48:63]
    ds_read_b64_tr_b16 v[12:13], v3 offset:3104
    ds_read_b64_tr_b16 v[14:15], v3 offset:3872
    s_waitcnt lgkmcnt(14)
    v_mfma_f32_32x32x16_bf16 v[64:79], v[16:19], v[144:147], v[64:79]
    ds_read_b32 v0, v7 offset:72
    ds_read_b64_tr_b16 v[16:17], v3 offset:3136
    ds_read_b64_tr_b16 v[18:19], v3 offset:3904
    s_waitcnt lgkmcnt(15)
    v_mfma_f32_32x32x16_bf16 v[80:95], v[20:23], v[144:147], v[80:95]
    ds_read_b64_tr_b16 v[20:21], v3 offset:3168
    ds_read_b64_tr_b16 v[22:23], v3 offset:3936
    s_waitcnt lgkmcnt(15)
    v_mfma_f32_32x32x16_bf16 v[96:111], v[24:27], v[144:147], v[96:111]
    s_setprio 3
    s_waitcnt lgkmcnt(9)
    v_mul_f32 v138, 0x31800000, v138
    v_cvt_pk_bf16_f32 v128, v139, v139
    v_mul_f32 v137, v138, v138
    s_setprio 0
    ds_read_b64_tr_b16 v[24:25], v3 offset:3200
    ds_read_b64_tr_b16 v[26:27], v3 offset:3968
    v_mfma_f32_32x32x16_bf16 v[112:127], v[28:31], v[144:147], v[112:127]
    s_setprio 3
    v_and_b32 v128, 0xffff0000, v128
    v_mul_f32 v137, v137, v138
    v_sub_f32 v128, v139, v128
    v_mul_f32 v137, 0xbdd2d3e8, v137
    s_setprio 0
    ds_read_b64_tr_b16 v[28:29], v3 offset:3232
    ds_read_b64_tr_b16 v[30:31], v3 offset:4000
    s_waitcnt lgkmcnt(11)
    v_mfma_f32_32x32x16_bf16 v[32:47], v[8:11], v[148:151], v[32:47]
    s_setprio 3
    v_cvt_pk_bf16_f32 v140, v139, v128
    v_mul_f32 v138, 0xc0135761, v138
    v_mov_b32 v141, v140
    v_mov_b32 v142, 0
    s_setprio 0
    ds_read_b64_tr_b16 v[8:9], v3 offset:6144
    ds_read_b64_tr_b16 v[10:11], v3 offset:6912
    s_waitcnt lgkmcnt(11)
    v_mfma_f32_32x32x16_bf16 v[48:63], v[12:15], v[148:151], v[48:63]
    s_waitcnt lgkmcnt(10)
    s_setprio 3
    v_cmp_ne_u32 vcc, 626944, v0
    s_setprio 0
    s_cbranch_vccz L_eBE1_ok_49
L_eBE1_sl_50:
    s_sleep 1
    ds_read_b32 v0, v7 offset:72
    s_waitcnt lgkmcnt(0)
    s_setprio 3
    v_cmp_ne_u32 vcc, 626944, v0
    s_setprio 0
    s_cbranch_vccnz L_eBE1_sl_50
L_eBE1_ok_49:
    s_setprio 3
    v_mov_b32 v143, 0
    s_and_b32 s47, s60, 28
    s_add_u32 s47, s47, s45
    s_mul_i32 s47, s47, 8192
    s_add_u32 s47, s47, 14225408
    s_and_b32 s50, s60, 7
    v_xor_b32 v134, s50, v1
    v_lshl_add_u32 v134, v134, 7, s47
    s_mov_b32 vcc_lo, 0xe0e0e0e
    s_mov_b32 vcc_hi, 0
    v_mov_b32 v135, 1073741824
    v_cndmask_b32 v134, v135, v134, vcc
    s_and_b32 s64, s60, 7
    s_lshl4_add_u32 s64, s60, s64
    s_lshl2_add_u32 s64, s64, s45
    s_lshl_b32 s64, s64, 10
    s_mul_i32 s54, s45, 2064
    s_mov_b32 s13, 3598
    s_setprio 0
    ds_read_b64_tr_b16 v[12:13], v3 offset:6176
    ds_read_b64_tr_b16 v[14:15], v3 offset:6944
    s_waitcnt lgkmcnt(10)
    v_mfma_f32_32x32x16_bf16 v[64:79], v[16:19], v[148:151], v[64:79]
    ds_read_b64_tr_b16 v[16:17], v3 offset:6208
    ds_read_b64_tr_b16 v[18:19], v3 offset:6976
    s_waitcnt lgkmcnt(10)
    v_mfma_f32_32x32x16_bf16 v[80:95], v[20:23], v[148:151], v[80:95]
    ds_read_b64_tr_b16 v[20:21], v3 offset:6240
    ds_read_b64_tr_b16 v[22:23], v3 offset:7008
    s_waitcnt lgkmcnt(10)
    v_mfma_f32_32x32x16_bf16 v[96:111], v[24:27], v[148:151], v[96:111]
    ds_read_b64_tr_b16 v[24:25], v3 offset:6272
    ds_read_b64_tr_b16 v[26:27], v3 offset:7040
    s_waitcnt lgkmcnt(10)
    v_mfma_f32_32x32x16_bf16 v[112:127], v[28:31], v[148:151], v[112:127]
    ds_read_b64_tr_b16 v[28:29], v3 offset:6304
    ds_read_b64_tr_b16 v[30:31], v3 offset:7072
    s_waitcnt lgkmcnt(10)
    v_mfma_f32_32x32x16_bf16 v[32:47], v[8:11], v[152:155], v[32:47]
    ds_read_b64_tr_b16 v[8:9], v3 offset:9216
    ds_read_b64_tr_b16 v[10:11], v3 offset:9984
    s_waitcnt lgkmcnt(10)
    v_mfma_f32_32x32x16_bf16 v[48:63], v[12:15], v[152:155], v[48:63]
    ds_read_b64_tr_b16 v[12:13], v3 offset:9248
    ds_read_b64_tr_b16 v[14:15], v3 offset:10016
    s_waitcnt lgkmcnt(10)
    v_mfma_f32_32x32x16_bf16 v[64:79], v[16:19], v[152:155], v[64:79]
    ds_read_b64_tr_b16 v[16:17], v3 offset:9280
    ds_read_b64_tr_b16 v[18:19], v3 offset:10048
    s_waitcnt lgkmcnt(10)
    v_mfma_f32_32x32x16_bf16 v[80:95], v[20:23], v[152:155], v[80:95]
    ds_read_b64_tr_b16 v[20:21], v3 offset:9312
    ds_read_b64_tr_b16 v[22:23], v3 offset:10080
    s_waitcnt lgkmcnt(10)
    v_mfma_f32_32x32x16_bf16 v[96:111], v[24:27], v[152:155], v[96:111]
    ds_read_b64_tr_b16 v[24:25], v3 offset:9344
    ds_read_b64_tr_b16 v[26:27], v3 offset:10112
    s_waitcnt lgkmcnt(10)
    v_mfma_f32_32x32x16_bf16 v[112:127], v[28:31], v[152:155], v[112:127]
    ds_read_b64_tr_b16 v[28:29], v3 offset:9376
    ds_read_b64_tr_b16 v[30:31], v3 offset:10144
    s_waitcnt lgkmcnt(10)
    v_mfma_f32_32x32x16_bf16 v[32:47], v[8:11], v[156:159], v[32:47]
    ds_read_b64_tr_b16 v[8:9], v3 offset:24640
    ds_read_b64_tr_b16 v[10:11], v3 offset:25408
    s_waitcnt lgkmcnt(10)
    v_mfma_f32_32x32x16_bf16 v[48:63], v[12:15], v[156:159], v[48:63]
    ds_read_b64_tr_b16 v[12:13], v3 offset:24672
    ds_read_b64_tr_b16 v[14:15], v3 offset:25440
    s_waitcnt lgkmcnt(10)
    v_mfma_f32_32x32x16_bf16 v[64:79], v[16:19], v[156:159], v[64:79]
    ds_read_b64_tr_b16 v[16:17], v3 offset:24704
    ds_read_b64_tr_b16 v[18:19], v3 offset:25472
    s_waitcnt lgkmcnt(10)
    v_mfma_f32_32x32x16_bf16 v[80:95], v[20:23], v[156:159], v[80:95]
    ds_read_b64_tr_b16 v[20:21], v3 offset:24736
    ds_read_b64_tr_b16 v[22:23], v3 offset:25504
    s_waitcnt lgkmcnt(10)
    v_mfma_f32_32x32x16_bf16 v[96:111], v[24:27], v[156:159], v[96:111]
    ds_read_b64_tr_b16 v[24:25], v3 offset:24768
    ds_read_b64_tr_b16 v[26:27], v3 offset:25536
    s_waitcnt lgkmcnt(10)
    v_mfma_f32_32x32x16_bf16 v[112:127], v[28:31], v[156:159], v[112:127]
    ds_read_b64_tr_b16 v[28:29], v3 offset:24800
    ds_read_b64_tr_b16 v[30:31], v3 offset:25568
    s_waitcnt lgkmcnt(10)
    v_mfma_f32_32x32x16_bf16 v[32:47], v[8:11], v[160:163], v[32:47]
    s_add_u32 s65, s63, 3
    s_and_b32 s65, s65, 7
    s_mul_i32 s65, s65, 176128
    s_add_u32 m0, s57, 82560
    s_add_u32 s65, s65, s56
    buffer_load_dwordx4 v4, s[16:19], s65 offen lds
    ds_read_b64_tr_b16 v[8:9], v3 offset:27712
    ds_read_b64_tr_b16 v[10:11], v3 offset:28480
    s_waitcnt lgkmcnt(10)
    v_mfma_f32_32x32x16_bf16 v[48:63], v[12:15], v[160:163], v[48:63]
    s_add_u32 m0, s57, 83584
    s_nop 0
    buffer_load_dwordx4 v5, s[16:19], s65 offen lds
    ds_read_b64_tr_b16 v[12:13], v3 offset:27744
    ds_read_b64_tr_b16 v[14:15], v3 offset:28512
    s_waitcnt lgkmcnt(10)
    v_mfma_f32_32x32x16_bf16 v[64:79], v[16:19], v[160:163], v[64:79]
    s_add_u32 m0, s57, 84608
    s_nop 0
    buffer_load_dwordx4 v6, s[16:19], s65 offen lds
    ds_read_b64_tr_b16 v[16:17], v3 offset:27776
    ds_read_b64_tr_b16 v[18:19], v3 offset:28544
    s_waitcnt lgkmcnt(10)
    v_mfma_f32_32x32x16_bf16 v[80:95], v[20:23], v[160:163], v[80:95]
    s_add_u32 m0, s57, 94880
    s_nop 0
    buffer_load_dwordx4 v4, s[20:23], s65 offen lds
    ds_read_b64_tr_b16 v[20:21], v3 offset:27808
    ds_read_b64_tr_b16 v[22:23], v3 offset:28576
    s_waitcnt lgkmcnt(10)
    v_mfma_f32_32x32x16_bf16 v[96:111], v[24:27], v[160:163], v[96:111]
    s_add_u32 m0, s57, 95904
    s_nop 0
    buffer_load_dwordx4 v5, s[20:23], s65 offen lds
    ds_read_b64_tr_b16 v[24:25], v3 offset:27840
    ds_read_b64_tr_b16 v[26:27], v3 offset:28608
    s_waitcnt lgkmcnt(10)
    v_mfma_f32_32x32x16_bf16 v[112:127], v[28:31], v[160:163], v[112:127]
    s_add_u32 m0, s57, 96928
    s_nop 0
    buffer_load_dwordx4 v6, s[20:23], s65 offen lds
    s_setprio 3
    v_lshlrev_b32 v144, 6, v1
    v_add_u32 v144, 156992, v144
    s_lshl_b32 s50, s45, 3
    v_add_u32 v145, s50, v144
    s_and_b32 s47, s60, 28
    s_add_u32 s47, s47, s45
    s_mul_i32 s47, s47, 8192
    s_add_u32 s47, s47, 14225408
    s_and_b32 s50, s60, 7
    v_xor_b32 v150, s50, v1
    v_lshl_add_u32 v150, v150, 7, s47
    s_setprio 0
    ds_read_b64_tr_b16 v[28:29], v3 offset:27872
    ds_read_b64_tr_b16 v[30:31], v3 offset:28640
    s_waitcnt lgkmcnt(10)
    v_mfma_f32_32x32x16_bf16 v[32:47], v[8:11], v[164:167], v[32:47]
    s_setprio 3
    s_mov_b32 vcc_lo, 0xf0f0f0f0
    s_mov_b32 vcc_hi, 0
    v_mov_b32 v151, 1073741824
    v_cndmask_b32 v150, v151, v150, vcc
    v_and_b32 v152, 31, v1
    v_mul_u32_u24 v152, 2064, v152
    v_add_u32 v152, 35072, v152
    s_setprio 0
    ds_read_b64_tr_b16 v[8:9], v3 offset:30784
    ds_read_b64_tr_b16 v[10:11], v3 offset:31552
    s_waitcnt lgkmcnt(10)
    v_mfma_f32_32x32x16_bf16 v[48:63], v[12:15], v[164:167], v[48:63]
    s_waitcnt vmcnt(0)
    s_mov_b64 exec, 1
    ds_add_u32 v7, v7 offset:76
    s_mov_b64 exec, -1
    s_setprio 3
    v_mov_b32 v156, 0x4d804d80
    v_mov_b32 v157, 0x4d804d80
    v_mov_b32 v158, 0x4d804d80
    v_mov_b32 v159, 0x4d804d80
    s_setprio 0
    ds_read_b64_tr_b16 v[12:13], v3 offset:30816
    ds_read_b64_tr_b16 v[14:15], v3 offset:31584
    s_waitcnt lgkmcnt(11)
    v_mfma_f32_32x32x16_bf16 v[64:79], v[16:19], v[164:167], v[64:79]
    buffer_load_dword v135, v134, s[32:35], 0 offen sc1
    s_setprio 3
    v_lshrrev_b32 v128, 3, v1
    v_bfe_u32 v129, v1, 4, 1
    v_lshlrev_b32 v128, 10, v128
    v_lshlrev_b32 v130, 2, v129
    s_setprio 0
    ds_read_b64_tr_b16 v[16:17], v3 offset:30848
    ds_read_b64_tr_b16 v[18:19], v3 offset:31616
    s_waitcnt lgkmcnt(11)
    v_mfma_f32_32x32x16_bf16 v[80:95], v[20:23], v[164:167], v[80:95]
    ds_read_b32 v0, v7 offset:76
    s_setprio 3
    v_xor_b32 v130, v130, v1
    v_and_b32 v130, 7, v130
    v_lshl_add_u32 v146, v130, 4, v128
    v_and_b32 v128, 31, v1
    s_setprio 0
    ds_read_b64_tr_b16 v[20:21], v3 offset:30880
    ds_read_b64_tr_b16 v[22:23], v3 offset:31648
    s_waitcnt lgkmcnt(12)
    v_mfma_f32_32x32x16_bf16 v[96:111], v[24:27], v[164:167], v[96:111]
    s_setprio 3
    v_lshrrev_b32 v130, 5, v1
    v_mul_u32_u24 v131, 262144, v130
    v_lshl_add_u32 v147, v128, 7, v131
    v_lshlrev_b32 v128, 10, v128
    s_setprio 0
    ds_read_b64_tr_b16 v[24:25], v3 offset:30912
    ds_read_b64_tr_b16 v[26:27], v3 offset:31680
    s_waitcnt lgkmcnt(12)
    v_mfma_f32_32x32x16_bf16 v[112:127], v[28:31], v[164:167], v[112:127]
    s_setprio 3
    v_lshl_add_u32 v148, v130, 4, v128
    v_bfe_u32 v128, v1, 2, 2
    v_lshl_add_u32 v128, v130, 2, v128
    v_lshlrev_b32 v128, 7, v128
    s_setprio 0
    ds_read_b64_tr_b16 v[28:29], v3 offset:30944
    ds_read_b64_tr_b16 v[30:31], v3 offset:31712
    s_waitcnt lgkmcnt(12)
    v_mfma_f32_32x32x16_bf16 v[32:47], v[8:11], v[168:171], v[32:47]
    s_add_u32 s65, s63, 4
    s_and_b32 s65, s65, 7
    s_mul_i32 s65, s65, 176128
    s_add_u32 m0, s57, 107200
    s_add_u32 s65, s65, s56
    buffer_load_dwordx4 v4, s[16:19], s65 offen lds
    ds_read_b64_tr_b16 v[8:9], v3 offset:33856
    ds_read_b64_tr_b16 v[10:11], v3 offset:34624
    s_waitcnt lgkmcnt(11)
    v_mfma_f32_32x32x16_bf16 v[48:63], v[12:15], v[168:171], v[48:63]
    s_add_u32 m0, s57, 108224
    s_nop 0
    buffer_load_dwordx4 v5, s[16:19], s65 offen lds
    ds_read_b64_tr_b16 v[12:13], v3 offset:33888
    ds_read_b64_tr_b16 v[14:15], v3 offset:34656
    s_waitcnt lgkmcnt(11)
    v_mfma_f32_32x32x16_bf16 v[64:79], v[16:19], v[168:171], v[64:79]
    s_waitcnt lgkmcnt(10)
    s_setprio 3
    v_cmp_ne_u32 vcc, 626944, v0
    s_setprio 0
    s_cbranch_vccz L_eBE2_ok_52
L_eBE2_sl_53:
    s_sleep 1
    ds_read_b32 v0, v7 offset:76
    s_waitcnt lgkmcnt(0)
    s_setprio 3
    v_cmp_ne_u32 vcc, 626944, v0
    s_setprio 0
    s_cbranch_vccnz L_eBE2_sl_53
L_eBE2_ok_52:
    s_add_u32 m0, s57, 109248
    s_nop 0
    buffer_load_dwordx4 v6, s[16:19], s65 offen lds
    ds_read_b64_tr_b16 v[16:17], v3 offset:33920
    ds_read_b64_tr_b16 v[18:19], v3 offset:34688
    s_waitcnt lgkmcnt(10)
    v_mfma_f32_32x32x16_bf16 v[80:95], v[20:23], v[168:171], v[80:95]
    s_add_u32 m0, s57, 119520
    s_nop 0
    buffer_load_dwordx4 v4, s[20:23], s65 offen lds
    ds_read_b64_tr_b16 v[20:21], v3 offset:33952
    ds_read_b64_tr_b16 v[22:23], v3 offset:34720
    s_waitcnt lgkmcnt(10)
    v_mfma_f32_32x32x16_bf16 v[96:111], v[24:27], v[168:171], v[96:111]
    s_add_u32 m0, s57, 120544
    s_nop 0
    buffer_load_dwordx4 v5, s[20:23], s65 offen lds
    ds_read_b64_tr_b16 v[24:25], v3 offset:33984
    ds_read_b64_tr_b16 v[26:27], v3 offset:34752
    s_waitcnt lgkmcnt(10)
    v_mfma_f32_32x32x16_bf16 v[112:127], v[28:31], v[168:171], v[112:127]
    s_add_u32 m0, s57, 121568
    s_nop 0
    buffer_load_dwordx4 v6, s[20:23], s65 offen lds
    s_setprio 3
    v_lshl_add_u32 v128, v129, 5, v128
    v_and_b32 v130, 1, v1
    v_lshl_add_u32 v128, v130, 4, v128
    v_bfe_u32 v130, v1, 1, 1
    s_setprio 0
    ds_read_b64_tr_b16 v[28:29], v3 offset:34016
    ds_read_b64_tr_b16 v[30:31], v3 offset:34784
    s_waitcnt lgkmcnt(10)
    v_mfma_f32_32x32x16_bf16 v[32:47], v[8:11], v[172:175], v[32:47]
    s_setprio 3
    v_lshl_add_u32 v128, v130, 3, v128
    v_bfe_u32 v130, v1, 3, 1
    v_lshl_add_u32 v149, v130, 6, v128
    s_setprio 0
    v_add_u32 v3, 49536, v3
    ds_read_b64_tr_b16 v[8:9], v3 offset:0
    ds_read_b64_tr_b16 v[10:11], v3 offset:768
    s_waitcnt lgkmcnt(10)
    v_mfma_f32_32x32x16_bf16 v[48:63], v[12:15], v[172:175], v[48:63]
    ds_read_b64_tr_b16 v[12:13], v3 offset:32
    ds_read_b64_tr_b16 v[14:15], v3 offset:800
    s_waitcnt lgkmcnt(10)
    v_mfma_f32_32x32x16_bf16 v[64:79], v[16:19], v[172:175], v[64:79]
    ds_read_b64_tr_b16 v[16:17], v3 offset:64
    ds_read_b64_tr_b16 v[18:19], v3 offset:832
    s_waitcnt lgkmcnt(10)
    v_mfma_f32_32x32x16_bf16 v[80:95], v[20:23], v[172:175], v[80:95]
    ds_read_b64_tr_b16 v[20:21], v3 offset:96
    ds_read_b64_tr_b16 v[22:23], v3 offset:864
    s_waitcnt lgkmcnt(10)
    v_mfma_f32_32x32x16_bf16 v[96:111], v[24:27], v[172:175], v[96:111]
    ds_read_b32 v0, v7 offset:12
    ds_read_b64_tr_b16 v[24:25], v3 offset:128
    ds_read_b64_tr_b16 v[26:27], v3 offset:896
    s_waitcnt lgkmcnt(11)
    v_mfma_f32_32x32x16_bf16 v[112:127], v[28:31], v[172:175], v[112:127]
    ds_read_b64_tr_b16 v[28:29], v3 offset:160
    ds_read_b64_tr_b16 v[30:31], v3 offset:928
    s_waitcnt lgkmcnt(11)
    v_mfma_f32_32x32x16_bf16 v[32:47], v[8:11], v[176:179], v[32:47]
    s_waitcnt lgkmcnt(4)
    s_setprio 3
    v_cmp_ne_u32 vcc, 1253888, v0
    s_setprio 0
    s_cbranch_vccz L_eAD_ok_55
L_eAD_sl_56:
    s_sleep 1
    ds_read_b32 v0, v7 offset:12
    s_waitcnt lgkmcnt(0)
    s_setprio 3
    v_cmp_ne_u32 vcc, 1253888, v0
    s_setprio 0
    s_cbranch_vccnz L_eAD_sl_56
L_eAD_ok_55:
    s_waitcnt vmcnt(6)
    s_setprio 3
    v_cmp_eq_u32 vcc, s58, v135
    s_lshr_b32 s12, vcc_lo, 16
    s_and_b32 s12, s12, vcc_lo
    s_and_b32 s12, s12, s13
    s_bcnt1_i32_b32 s47, s12
    s_cmp_lt_u32 s47, 2
    s_cbranch_scc0 L_fa1_ok_58
L_fa1_sl_59:
    s_mov_b32 s62, 65536
    s_nop 15
L_fa1_lp_60:
    s_sleep 4
    buffer_load_dword v135, v134, s[32:35], 0 offen sc1
    s_sub_u32 s62, s62, 1
    s_waitcnt vmcnt(0)
    s_cbranch_scc1 L_fa1_ok_58
    v_cmp_eq_u32 vcc, s58, v135
    s_lshr_b32 s12, vcc_lo, 16
    s_and_b32 s12, s12, vcc_lo
    s_and_b32 s12, s12, s13
    s_bcnt1_i32_b32 s47, s12
    s_cmp_lt_u32 s47, 2
    s_cbranch_scc1 L_fa1_lp_60
L_fa1_ok_58:
    s_setprio 0
    s_ff1_i32_b32 s14, s12
    s_bitset0_b32 s12, s14
    s_bitset0_b32 s13, s14
    s_lshl_b32 s14, s14, 12
    s_xor_b32 s14, s14, s64
    s_add_u32 m0, s54, 16512
    s_add_u32 s47, s14, 2097152
    buffer_load_dwordx4 v2, s[32:35], s47 offen sc1 lds
    ds_read_b64_tr_b16 v[8:9], v3 offset:3072
    ds_read_b64_tr_b16 v[10:11], v3 offset:3840
    v_mfma_f32_32x32x16_bf16 v[48:63], v[12:15], v[176:179], v[48:63]
    s_add_u32 m0, s54, 17536
    s_add_u32 s47, s14, 4194304
    buffer_load_dwordx4 v2, s[32:35], s47 offen sc1 lds
    ds_read_b64_tr_b16 v[12:13], v3 offset:3104
    ds_read_b64_tr_b16 v[14:15], v3 offset:3872
    v_mfma_f32_32x32x16_bf16 v[64:79], v[16:19], v[176:179], v[64:79]
    s_ff1_i32_b32 s14, s12
    s_bitset0_b32 s12, s14
    s_bitset0_b32 s13, s14
    s_lshl_b32 s14, s14, 12
    s_xor_b32 s14, s14, s64
    s_add_u32 m0, s54, 24768
    s_add_u32 s47, s14, 2097152
    buffer_load_dwordx4 v2, s[32:35], s47 offen sc1 lds
    ds_read_b64_tr_b16 v[16:17], v3 offset:3136
    ds_read_b64_tr_b16 v[18:19], v3 offset:3904
    v_mfma_f32_32x32x16_bf16 v[80:95], v[20:23], v[176:179], v[80:95]
    s_add_u32 m0, s54, 25792
    s_add_u32 s47, s14, 4194304
    buffer_load_dwordx4 v2, s[32:35], s47 offen sc1 lds
    s_mov_b32 s12, s13
    ds_read_b64_tr_b16 v[20:21], v3 offset:3168
    ds_read_b64_tr_b16 v[22:23], v3 offset:3936
    s_waitcnt lgkmcnt(10)
    v_mfma_f32_32x32x16_bf16 v[96:111], v[24:27], v[176:179], v[96:111]
    s_add_u32 s65, s63, 5
    s_and_b32 s65, s65, 7
    s_mul_i32 s65, s65, 176128
    s_add_u32 m0, s57, 132096
    s_add_u32 s65, s65, s56
    buffer_load_dwordx4 v4, s[16:19], s65 offen lds
    ds_read_b64_tr_b16 v[24:25], v3 offset:3200
    ds_read_b64_tr_b16 v[26:27], v3 offset:3968
    s_waitcnt lgkmcnt(10)
    v_mfma_f32_32x32x16_bf16 v[112:127], v[28:31], v[176:179], v[112:127]
    s_add_u32 m0, s57, 133120
    s_nop 0
    buffer_load_dwordx4 v5, s[16:19], s65 offen lds
    ds_read_b64_tr_b16 v[28:29], v3 offset:3232
    ds_read_b64_tr_b16 v[30:31], v3 offset:4000
    s_waitcnt lgkmcnt(10)
    v_mfma_f32_32x32x16_bf16 v[32:47], v[8:11], v[180:183], v[32:47]
    s_add_u32 m0, s57, 134144
    s_nop 0
    buffer_load_dwordx4 v6, s[16:19], s65 offen lds
    ds_read_b64_tr_b16 v[8:9], v3 offset:6144
    ds_read_b64_tr_b16 v[10:11], v3 offset:6912
    s_waitcnt lgkmcnt(10)
    v_mfma_f32_32x32x16_bf16 v[48:63], v[12:15], v[180:183], v[48:63]
    s_waitcnt vmcnt(7)
    s_mov_b64 exec, 1
    ds_add_u32 v7, v7 offset:80
    s_mov_b64 exec, -1
    s_add_u32 m0, s57, 144416
    s_nop 0
    buffer_load_dwordx4 v4, s[20:23], s65 offen lds
    ds_read_b64_tr_b16 v[12:13], v3 offset:6176
    ds_read_b64_tr_b16 v[14:15], v3 offset:6944
    s_waitcnt lgkmcnt(11)
    v_mfma_f32_32x32x16_bf16 v[64:79], v[16:19], v[180:183], v[64:79]
    s_add_u32 m0, s57, 145440
    s_nop 0
    buffer_load_dwordx4 v5, s[20:23], s65 offen lds
    ds_read_b64_tr_b16 v[16:17], v3 offset:6208
    ds_read_b64_tr_b16 v[18:19], v3 offset:6976
    s_waitcnt lgkmcnt(11)
    v_mfma_f32_32x32x16_bf16 v[80:95], v[20:23], v[180:183], v[80:95]
    ds_read_b32 v0, v7 offset:80
    s_add_u32 m0, s57, 146464
    s_nop 0
    buffer_load_dwordx4 v6, s[20:23], s65 offen lds
    s_setprio 3
    s_lshl_b32 s50, s67, 9
    s_add_u32 s50, s50, 15990784
    buffer_load_dwordx4 v[160:163], v2, s[32:35], s50 offen offset:0 sc1
    buffer_load_dwordx4 v[164:167], v2, s[32:35], s50 offen offset:1024 sc1
    buffer_load_dwordx4 v[168:171], v2, s[32:35], s50 offen offset:2048 sc1
    buffer_load_dwordx4 v[172:175], v2, s[32:35], s50 offen offset:3072 sc1
    s_setprio 0
    ds_read_b64_tr_b16 v[20:21], v3 offset:6240
    ds_read_b64_tr_b16 v[22:23], v3 offset:7008
    s_waitcnt lgkmcnt(12)
    v_mfma_f32_32x32x16_bf16 v[96:111], v[24:27], v[180:183], v[96:111]
    ds_read_b64_tr_b16 v[24:25], v3 offset:6272
    ds_read_b64_tr_b16 v[26:27], v3 offset:7040
    s_waitcnt lgkmcnt(12)
    v_mfma_f32_32x32x16_bf16 v[112:127], v[28:31], v[180:183], v[112:127]
    ds_read_b64_tr_b16 v[28:29], v3 offset:6304
    ds_read_b64_tr_b16 v[30:31], v3 offset:7072
    s_waitcnt lgkmcnt(12)
    v_mfma_f32_32x32x16_bf16 v[32:47], v[8:11], v[184:187], v[32:47]
    ds_read_b64_tr_b16 v[8:9], v3 offset:9216
    ds_read_b64_tr_b16 v[10:11], v3 offset:9984
    s_waitcnt lgkmcnt(11)
    v_mfma_f32_32x32x16_bf16 v[48:63], v[12:15], v[184:187], v[48:63]
    ds_read_b64_tr_b16 v[12:13], v3 offset:9248
    ds_read_b64_tr_b16 v[14:15], v3 offset:10016
    s_waitcnt lgkmcnt(11)
    v_mfma_f32_32x32x16_bf16 v[64:79], v[16:19], v[184:187], v[64:79]
    s_waitcnt lgkmcnt(10)
    s_setprio 3
    v_cmp_ne_u32 vcc, 626944, v0
    s_setprio 0
    s_cbranch_vccz L_eBE3_ok_61
L_eBE3_sl_62:
    s_sleep 1
    ds_read_b32 v0, v7 offset:80
    s_waitcnt lgkmcnt(0)
    s_setprio 3
    v_cmp_ne_u32 vcc, 626944, v0
    s_setprio 0
    s_cbranch_vccnz L_eBE3_sl_62
L_eBE3_ok_61:
    s_waitcnt vmcnt(10)
    s_mov_b64 exec, 1
    ds_add_u32 v7, v7 offset:20
    s_mov_b64 exec, -1
    ds_read_b64_tr_b16 v[16:17], v3 offset:9280
    ds_read_b64_tr_b16 v[18:19], v3 offset:10048
    s_waitcnt lgkmcnt(11)
    v_mfma_f32_32x32x16_bf16 v[80:95], v[20:23], v[184:187], v[80:95]
    buffer_load_dword v135, v134, s[32:35], 0 offen sc1
    ds_read_b64_tr_b16 v[20:21], v3 offset:9312
    ds_read_b64_tr_b16 v[22:23], v3 offset:10080
    s_waitcnt lgkmcnt(11)
    v_mfma_f32_32x32x16_bf16 v[96:111], v[24:27], v[184:187], v[96:111]
    ds_read_b64_tr_b16 v[24:25], v3 offset:9344
    ds_read_b64_tr_b16 v[26:27], v3 offset:10112
    s_waitcnt lgkmcnt(11)
    v_mfma_f32_32x32x16_bf16 v[112:127], v[28:31], v[184:187], v[112:127]
    ds_read_b64_tr_b16 v[28:29], v3 offset:9376
    ds_read_b64_tr_b16 v[30:31], v3 offset:10144
    s_waitcnt lgkmcnt(11)
    v_mfma_f32_32x32x16_bf16 v[32:47], v[8:11], v[188:191], v[32:47]
    ds_read_b64_tr_b16 v[8:9], v3 offset:24640
    ds_read_b64_tr_b16 v[10:11], v3 offset:25408
    s_waitcnt lgkmcnt(11)
    v_mfma_f32_32x32x16_bf16 v[48:63], v[12:15], v[188:191], v[48:63]
    ds_read_b64_tr_b16 v[12:13], v3 offset:24672
    ds_read_b64_tr_b16 v[14:15], v3 offset:25440
    s_waitcnt lgkmcnt(10)
    v_mfma_f32_32x32x16_bf16 v[64:79], v[16:19], v[188:191], v[64:79]
    ds_read_b64_tr_b16 v[16:17], v3 offset:24704
    ds_read_b64_tr_b16 v[18:19], v3 offset:25472
    s_waitcnt lgkmcnt(10)
    v_mfma_f32_32x32x16_bf16 v[80:95], v[20:23], v[188:191], v[80:95]
    ds_read_b64_tr_b16 v[20:21], v3 offset:24736
    ds_read_b64_tr_b16 v[22:23], v3 offset:25504
    s_waitcnt lgkmcnt(10)
    v_mfma_f32_32x32x16_bf16 v[96:111], v[24:27], v[188:191], v[96:111]
    ds_read_b64_tr_b16 v[24:25], v3 offset:24768
    ds_read_b64_tr_b16 v[26:27], v3 offset:25536
    s_waitcnt lgkmcnt(10)
    v_mfma_f32_32x32x16_bf16 v[112:127], v[28:31], v[188:191], v[112:127]
    ds_read_b64_tr_b16 v[28:29], v3 offset:24800
    ds_read_b64_tr_b16 v[30:31], v3 offset:25568
    s_waitcnt lgkmcnt(10)
    v_mfma_f32_32x32x16_bf16 v[32:47], v[8:11], v[192:195], v[32:47]
    ds_read_b64_tr_b16 v[8:9], v3 offset:27712
    ds_read_b64_tr_b16 v[10:11], v3 offset:28480
    s_waitcnt lgkmcnt(10)
    v_mfma_f32_32x32x16_bf16 v[48:63], v[12:15], v[192:195], v[48:63]
    ds_read_b64_tr_b16 v[12:13], v3 offset:27744
    ds_read_b64_tr_b16 v[14:15], v3 offset:28512
    s_waitcnt lgkmcnt(10)
    v_mfma_f32_32x32x16_bf16 v[64:79], v[16:19], v[192:195], v[64:79]
    s_waitcnt vmcnt(1)
    s_setprio 3
    v_xor_b32 v128, s58, v161
    v_xor_b32 v129, s58, v163
    v_or_b32 v128, v128, v129
    v_xor_b32 v129, s58, v165
    v_or_b32 v128, v128, v129
    v_xor_b32 v129, s58, v167
    v_or_b32 v128, v128, v129
    v_xor_b32 v129, s58, v169
    v_or_b32 v128, v128, v129
    v_xor_b32 v129, s58, v171
    v_or_b32 v128, v128, v129
    v_xor_b32 v129, s58, v173
    v_or_b32 v128, v128, v129
    v_xor_b32 v129, s58, v175
    v_or_b32 v128, v128, v129
    v_cmp_ne_u32 vcc, 0, v128
    s_nop 0
    s_cbranch_vccz L_gb_ok_64
L_gb_sl_65:
    s_mov_b32 s62, 65536
    s_nop 15
L_gb_lp_66:
    s_sleep 1
    s_lshl_b32 s50, s67, 9
    s_add_u32 s50, s50, 15990784
    buffer_load_dwordx4 v[160:163], v2, s[32:35], s50 offen offset:0 sc1
    buffer_load_dwordx4 v[164:167], v2, s[32:35], s50 offen offset:1024 sc1
    buffer_load_dwordx4 v[168:171], v2, s[32:35], s50 offen offset:2048 sc1
    buffer_load_dwordx4 v[172:175], v2, s[32:35], s50 offen offset:3072 sc1
    s_sub_u32 s62, s62, 1
    s_waitcnt vmcnt(0)
    s_cbranch_scc1 L_gb_ok_64
    v_xor_b32 v128, s58, v161
    v_xor_b32 v129, s58, v163
    v_or_b32 v128, v128, v129
    v_xor_b32 v129, s58, v165
    v_or_b32 v128, v128, v129
    v_xor_b32 v129, s58, v167
    v_or_b32 v128, v128, v129
    v_xor_b32 v129, s58, v169
    v_or_b32 v128, v128, v129
    v_xor_b32 v129, s58, v171
    v_or_b32 v128, v128, v129
    v_xor_b32 v129, s58, v173
    v_or_b32 v128, v128, v129
    v_xor_b32 v129, s58, v175
    v_or_b32 v128, v128, v129
    v_cmp_ne_u32 vcc, 0, v128
    s_nop 0
    s_cbranch_vccnz L_gb_lp_66
L_gb_ok_64:
    s_setprio 0
    s_setprio 3
    v_add_f32 v160, v160, v164
    v_add_f32 v162, v162, v166
    v_add_f32 v168, v168, v172
    v_add_f32 v170, v170, v174
    s_setprio 0
    ds_read_b64_tr_b16 v[16:17], v3 offset:27776
    ds_read_b64_tr_b16 v[18:19], v3 offset:28544
    s_waitcnt lgkmcnt(10)
    v_mfma_f32_32x32x16_bf16 v[80:95], v[20:23], v[192:195], v[80:95]
    s_setprio 3
    v_add_f32 v160, v160, v168
    v_add_f32 v162, v162, v170
    v_cvt_pk_bf16_f32 v130, v160, v160
    v_cvt_pk_bf16_f32 v132, v162, v162
    s_setprio 0
    ds_read_b64_tr_b16 v[20:21], v3 offset:27808
    ds_read_b64_tr_b16 v[22:23], v3 offset:28576
    s_waitcnt lgkmcnt(10)
    v_mfma_f32_32x32x16_bf16 v[96:111], v[24:27], v[192:195], v[96:111]
    s_setprio 3
    v_and_b32 v128, 0xffff0000, v130
    v_and_b32 v129, 0xffff0000, v132
    v_sub_f32 v128, v160, v128
    v_sub_f32 v129, v162, v129
    s_setprio 0
    ds_read_b64_tr_b16 v[24:25], v3 offset:27840
    ds_read_b64_tr_b16 v[26:27], v3 offset:28608
    s_waitcnt lgkmcnt(10)
    v_mfma_f32_32x32x16_bf16 v[112:127], v[28:31], v[192:195], v[112:127]
    s_setprio 3
    v_cvt_pk_bf16_f32 v131, v128, v128
    v_cvt_pk_bf16_f32 v133, v129, v129
    ds_write_b64 v145, v[130:131]
    ds_write_b64 v145, v[132:133] offset:32
    s_setprio 0
    ds_read_b64_tr_b16 v[28:29], v3 offset:27872
    ds_read_b64_tr_b16 v[30:31], v3 offset:28640
    s_waitcnt lgkmcnt(12)
    v_mfma_f32_32x32x16_bf16 v[32:47], v[8:11], v[196:199], v[32:47]
    ds_read_b64_tr_b16 v[8:9], v3 offset:30784
    ds_read_b64_tr_b16 v[10:11], v3 offset:31552
    s_waitcnt lgkmcnt(12)
    v_mfma_f32_32x32x16_bf16 v[48:63], v[12:15], v[196:199], v[48:63]
    s_mov_b64 exec, 1
    ds_add_u32 v7, v7 offset:84
    s_mov_b64 exec, -1
    s_mov_b64 exec, 0xffffff
    ds_write_b128 v152, v[156:159]
    s_mov_b64 exec, -1
    s_waitcnt vmcnt(0)
    s_setprio 3
    v_cmp_ne_u32 vcc, s58, v135
    s_and_b32 s47, vcc_lo, 0xe0e0e0e
    s_cbranch_scc0 L_fa2_ok_67
L_fa2_sl_68:
    s_mov_b32 s62, 65536
    s_nop 15
L_fa2_lp_69:
    s_sleep 1
    buffer_load_dword v135, v134, s[32:35], 0 offen sc1
    s_sub_u32 s62, s62, 1
    s_waitcnt vmcnt(0)
    s_cbranch_scc1 L_fa2_ok_67
    v_cmp_ne_u32 vcc, s58, v135
    s_and_b32 s47, vcc_lo, 0xe0e0e0e
    s_cbranch_scc1 L_fa2_lp_69
L_fa2_ok_67:
    s_setprio 0
    s_ff1_i32_b32 s14, s12
    s_bitset0_b32 s12, s14
    s_lshl_b32 s14, s14, 12
    s_xor_b32 s14, s14, s64
    s_add_u32 m0, s54, 33024
    s_add_u32 s47, s14, 2097152
    buffer_load_dwordx4 v2, s[32:35], s47 offen sc1 lds
    ds_read_b64_tr_b16 v[12:13], v3 offset:30816
    ds_read_b64_tr_b16 v[14:15], v3 offset:31584
    s_waitcnt lgkmcnt(14)
    v_mfma_f32_32x32x16_bf16 v[64:79], v[16:19], v[196:199], v[64:79]
    s_add_u32 m0, s54, 34048
    s_add_u32 s47, s14, 4194304
    buffer_load_dwordx4 v2, s[32:35], s47 offen sc1 lds
    ds_read_b64_tr_b16 v[16:17], v3 offset:30848
    ds_read_b64_tr_b16 v[18:19], v3 offset:31616
    s_waitcnt lgkmcnt(14)
    v_mfma_f32_32x32x16_bf16 v[80:95], v[20:23], v[196:199], v[80:95]
    ds_read_b32 v0, v7 offset:84
    s_ff1_i32_b32 s14, s12
    s_bitset0_b32 s12, s14
    s_lshl_b32 s14, s14, 12
    s_xor_b32 s14, s14, s64
    s_add_u32 m0, s54, 41280
    s_add_u32 s47, s14, 2097152
    buffer_load_dwordx4 v2, s[32:35], s47 offen sc1 lds
    ds_read_b64_tr_b16 v[20:21], v3 offset:30880
    ds_read_b64_tr_b16 v[22:23], v3 offset:31648
    s_waitcnt lgkmcnt(15)
    v_mfma_f32_32x32x16_bf16 v[96:111], v[24:27], v[196:199], v[96:111]
    s_add_u32 m0, s54, 42304
    s_add_u32 s47, s14, 4194304
    buffer_load_dwordx4 v2, s[32:35], s47 offen sc1 lds
    ds_read_b64_tr_b16 v[24:25], v3 offset:30912
    ds_read_b64_tr_b16 v[26:27], v3 offset:31680
    s_waitcnt lgkmcnt(13)
    v_mfma_f32_32x32x16_bf16 v[112:127], v[28:31], v[196:199], v[112:127]
    s_ff1_i32_b32 s14, s12
    s_bitset0_b32 s12, s14
    s_lshl_b32 s14, s14, 12
    s_xor_b32 s14, s14, s64
    s_add_u32 m0, s54, 49536
    s_add_u32 s47, s14, 2097152
    buffer_load_dwordx4 v2, s[32:35], s47 offen sc1 lds
    ds_read_b64_tr_b16 v[28:29], v3 offset:30944
    ds_read_b64_tr_b16 v[30:31], v3 offset:31712
    s_waitcnt lgkmcnt(13)
    v_mfma_f32_32x32x16_bf16 v[32:47], v[8:11], v[200:203], v[32:47]
    s_add_u32 m0, s54, 50560
    s_add_u32 s47, s14, 4194304
    buffer_load_dwordx4 v2, s[32:35], s47 offen sc1 lds
    ds_read_b64_tr_b16 v[8:9], v3 offset:33856
    ds_read_b64_tr_b16 v[10:11], v3 offset:34624
    s_waitcnt lgkmcnt(11)
    v_mfma_f32_32x32x16_bf16 v[48:63], v[12:15], v[200:203], v[48:63]
    s_ff1_i32_b32 s14, s12
    s_bitset0_b32 s12, s14
    s_lshl_b32 s14, s14, 12
    s_xor_b32 s14, s14, s64
    s_add_u32 m0, s54, 57792
    s_add_u32 s47, s14, 2097152
    buffer_load_dwordx4 v2, s[32:35], s47 offen sc1 lds
    ds_read_b64_tr_b16 v[12:13], v3 offset:33888
    ds_read_b64_tr_b16 v[14:15], v3 offset:34656
    s_waitcnt lgkmcnt(11)
    v_mfma_f32_32x32x16_bf16 v[64:79], v[16:19], v[200:203], v[64:79]
    s_waitcnt lgkmcnt(10)
    s_setprio 3
    v_cmp_ne_u32 vcc, 626944, v0
    s_setprio 0
    s_cbranch_vccz L_eBE4_ok_70
L_eBE4_sl_71:
    s_sleep 1
    ds_read_b32 v0, v7 offset:84
    s_waitcnt lgkmcnt(0)
    s_setprio 3
    v_cmp_ne_u32 vcc, 626944, v0
    s_setprio 0
    s_cbranch_vccnz L_eBE4_sl_71
L_eBE4_ok_70:
    s_add_u32 m0, s54, 58816
    s_add_u32 s47, s14, 4194304
    buffer_load_dwordx4 v2, s[32:35], s47 offen sc1 lds
    ds_read_b64_tr_b16 v[16:17], v3 offset:33920
    ds_read_b64_tr_b16 v[18:19], v3 offset:34688
    s_waitcnt lgkmcnt(10)
    v_mfma_f32_32x32x16_bf16 v[80:95], v[20:23], v[200:203], v[80:95]
    s_add_u32 s65, s63, 6
    s_and_b32 s65, s65, 7
    s_mul_i32 s65, s65, 176128
    s_add_u32 m0, s57, 82560
    s_add_u32 s65, s65, s56
    buffer_load_dwordx4 v4, s[16:19], s65 offen lds
    ds_read_b64_tr_b16 v[20:21], v3 offset:33952
    ds_read_b64_tr_b16 v[22:23], v3 offset:34720
    s_waitcnt lgkmcnt(10)
    v_mfma_f32_32x32x16_bf16 v[96:111], v[24:27], v[200:203], v[96:111]
    s_add_u32 m0, s57, 83584
    s_nop 0
    buffer_load_dwordx4 v5, s[16:19], s65 offen lds
    ds_read_b64_tr_b16 v[24:25], v3 offset:33984
    ds_read_b64_tr_b16 v[26:27], v3 offset:34752
    s_waitcnt lgkmcnt(10)
    v_mfma_f32_32x32x16_bf16 v[112:127], v[28:31], v[200:203], v[112:127]
    s_add_u32 m0, s57, 84608
    s_nop 0
    buffer_load_dwordx4 v6, s[16:19], s65 offen lds
    ds_read_b64_tr_b16 v[28:29], v3 offset:34016
    ds_read_b64_tr_b16 v[30:31], v3 offset:34784
    s_waitcnt lgkmcnt(10)
    v_mfma_f32_32x32x16_bf16 v[32:47], v[8:11], v[204:207], v[32:47]
    s_add_u32 m0, s57, 94880
    s_nop 0
    buffer_load_dwordx4 v4, s[20:23], s65 offen lds
    ds_read_b64_tr_b16 v[8:9], v3 offset:49536
    ds_read_b64_tr_b16 v[10:11], v3 offset:50304
    s_waitcnt lgkmcnt(10)
    v_mfma_f32_32x32x16_bf16 v[48:63], v[12:15], v[204:207], v[48:63]
    s_add_u32 m0, s57, 95904
    s_nop 0
    buffer_load_dwordx4 v5, s[20:23], s65 offen lds
    ds_read_b64_tr_b16 v[12:13], v3 offset:49568
    ds_read_b64_tr_b16 v[14:15], v3 offset:50336
    s_waitcnt lgkmcnt(10)
    v_mfma_f32_32x32x16_bf16 v[64:79], v[16:19], v[204:207], v[64:79]
    s_add_u32 m0, s57, 96928
    s_nop 0
    buffer_load_dwordx4 v6, s[20:23], s65 offen lds
    ds_read_b64_tr_b16 v[16:17], v3 offset:49600
    ds_read_b64_tr_b16 v[18:19], v3 offset:50368
    s_waitcnt lgkmcnt(10)
    v_mfma_f32_32x32x16_bf16 v[80:95], v[20:23], v[204:207], v[80:95]
    ds_read_b64_tr_b16 v[20:21], v3 offset:49632
    ds_read_b64_tr_b16 v[22:23], v3 offset:50400
    s_waitcnt lgkmcnt(10)
    v_mfma_f32_32x32x16_bf16 v[96:111], v[24:27], v[204:207], v[96:111]
    ds_read_b64_tr_b16 v[24:25], v3 offset:49664
    ds_read_b64_tr_b16 v[26:27], v3 offset:50432
    s_waitcnt lgkmcnt(10)
    v_mfma_f32_32x32x16_bf16 v[112:127], v[28:31], v[204:207], v[112:127]
    ds_read_b64_tr_b16 v[28:29], v3 offset:49696
    ds_read_b64_tr_b16 v[30:31], v3 offset:50464
    s_waitcnt lgkmcnt(10)
    v_mfma_f32_32x32x16_bf16 v[32:47], v[8:11], v[208:211], v[32:47]
    ds_read_b64_tr_b16 v[8:9], v3 offset:52608
    ds_read_b64_tr_b16 v[10:11], v3 offset:53376
    s_waitcnt lgkmcnt(10)
    v_mfma_f32_32x32x16_bf16 v[48:63], v[12:15], v[208:211], v[48:63]
    ds_read_b64_tr_b16 v[12:13], v3 offset:52640
    ds_read_b64_tr_b16 v[14:15], v3 offset:53408
    s_waitcnt lgkmcnt(10)
    v_mfma_f32_32x32x16_bf16 v[64:79], v[16:19], v[208:211], v[64:79]
    ds_read_b64_tr_b16 v[16:17], v3 offset:52672
    ds_read_b64_tr_b16 v[18:19], v3 offset:53440
    s_waitcnt lgkmcnt(10)
    v_mfma_f32_32x32x16_bf16 v[80:95], v[20:23], v[208:211], v[80:95]
    ds_read_b64_tr_b16 v[20:21], v3 offset:52704
    ds_read_b64_tr_b16 v[22:23], v3 offset:53472
    s_waitcnt lgkmcnt(10)
    v_mfma_f32_32x32x16_bf16 v[96:111], v[24:27], v[208:211], v[96:111]
    s_waitcnt vmcnt(0)
    s_mov_b64 exec, 1
    ds_add_u32 v7, v7 offset:88
    s_mov_b64 exec, -1
    s_mov_b64 exec, 1
    ds_add_u32 v7, v7 offset:24
    s_mov_b64 exec, -1
    ds_read_b64_tr_b16 v[24:25], v3 offset:52736
    ds_read_b64_tr_b16 v[26:27], v3 offset:53504
    s_waitcnt lgkmcnt(12)
    v_mfma_f32_32x32x16_bf16 v[112:127], v[28:31], v[208:211], v[112:127]
    ds_read_b64_tr_b16 v[28:29], v3 offset:52768
    ds_read_b64_tr_b16 v[30:31], v3 offset:53536
    s_waitcnt lgkmcnt(12)
    v_mfma_f32_32x32x16_bf16 v[32:47], v[8:11], v[212:215], v[32:47]
    ds_read_b32 v0, v7 offset:88
    ds_read_b64_tr_b16 v[8:9], v3 offset:55680
    ds_read_b64_tr_b16 v[10:11], v3 offset:56448
    s_waitcnt lgkmcnt(13)
    v_mfma_f32_32x32x16_bf16 v[48:63], v[12:15], v[212:215], v[48:63]
    ds_read_b64_tr_b16 v[12:13], v3 offset:55712
    ds_read_b64_tr_b16 v[14:15], v3 offset:56480
    s_waitcnt lgkmcnt(13)
    v_mfma_f32_32x32x16_bf16 v[64:79], v[16:19], v[212:215], v[64:79]
    ds_read_b64_tr_b16 v[16:17], v3 offset:55744
    ds_read_b64_tr_b16 v[18:19], v3 offset:56512
    s_waitcnt lgkmcnt(13)
    v_mfma_f32_32x32x16_bf16 v[80:95], v[20:23], v[212:215], v[80:95]
    ds_read_b64_tr_b16 v[20:21], v3 offset:55776
    ds_read_b64_tr_b16 v[22:23], v3 offset:56544
    s_waitcnt lgkmcnt(11)
    v_mfma_f32_32x32x16_bf16 v[96:111], v[24:27], v[212:215], v[96:111]
    ds_read_b64_tr_b16 v[24:25], v3 offset:55808
    ds_read_b64_tr_b16 v[26:27], v3 offset:56576
    s_waitcnt lgkmcnt(11)
    v_mfma_f32_32x32x16_bf16 v[112:127], v[28:31], v[212:215], v[112:127]
    s_waitcnt lgkmcnt(10)
    s_setprio 3
    v_cmp_ne_u32 vcc, 626944, v0
    s_setprio 0
    s_cbranch_vccz L_eBE5_ok_73
L_eBE5_sl_74:
    s_sleep 1
    ds_read_b32 v0, v7 offset:88
    s_waitcnt lgkmcnt(0)
    s_setprio 3
    v_cmp_ne_u32 vcc, 626944, v0
    s_setprio 0
    s_cbranch_vccnz L_eBE5_sl_74
L_eBE5_ok_73:
    ds_read_b128 v[176:179], v144 offset:0
    ds_read_b128 v[180:183], v144 offset:16
    ds_read_b128 v[184:187], v144 offset:32
    ds_read_b128 v[188:191], v144 offset:48
    s_add_u32 s65, s63, 7
    s_and_b32 s65, s65, 7
    s_mul_i32 s65, s65, 176128
    s_add_u32 m0, s57, 107200
    s_add_u32 s65, s65, s56
    buffer_load_dwordx4 v4, s[16:19], s65 offen lds
    s_setprio 3
    s_setprio 0
    ds_read_b64_tr_b16 v[28:29], v3 offset:55840
    ds_read_b64_tr_b16 v[30:31], v3 offset:56608
    s_waitcnt lgkmcnt(14)
    v_mfma_f32_32x32x16_bf16 v[32:47], v[8:11], v[216:219], v[32:47]
    s_add_u32 m0, s57, 108224
    s_nop 0
    buffer_load_dwordx4 v5, s[16:19], s65 offen lds
    ds_read_b64_tr_b16 v[8:9], v3 offset:58752
    ds_read_b64_tr_b16 v[10:11], v3 offset:59520
    s_waitcnt lgkmcnt(14)
    v_mfma_f32_32x32x16_bf16 v[48:63], v[12:15], v[216:219], v[48:63]
    s_add_u32 m0, s57, 109248
    s_nop 0
    buffer_load_dwordx4 v6, s[16:19], s65 offen lds
    ds_read_b64_tr_b16 v[12:13], v3 offset:58784
    ds_read_b64_tr_b16 v[14:15], v3 offset:59552
    s_waitcnt lgkmcnt(14)
    v_mfma_f32_32x32x16_bf16 v[64:79], v[16:19], v[216:219], v[64:79]
    s_add_u32 m0, s57, 119520
    s_nop 0
    buffer_load_dwordx4 v4, s[20:23], s65 offen lds
    s_setprio 3
    s_waitcnt lgkmcnt(6)
    v_mov_b32 v188, 0
    v_mov_b32 v189, 0
    s_setprio 0
    ds_read_b64_tr_b16 v[16:17], v3 offset:58816
    ds_read_b64_tr_b16 v[18:19], v3 offset:59584
    v_mfma_f32_32x32x16_bf16 v[80:95], v[20:23], v[216:219], v[80:95]
    s_add_u32 m0, s57, 120544
    s_nop 0
    buffer_load_dwordx4 v5, s[20:23], s65 offen lds
    ds_read_b64_tr_b16 v[20:21], v3 offset:58848
    ds_read_b64_tr_b16 v[22:23], v3 offset:59616
    v_mfma_f32_32x32x16_bf16 v[96:111], v[24:27], v[216:219], v[96:111]
    s_add_u32 m0, s57, 121568
    s_nop 0
    buffer_load_dwordx4 v6, s[20:23], s65 offen lds
    ds_read_b64_tr_b16 v[24:25], v3 offset:58880
    ds_read_b64_tr_b16 v[26:27], v3 offset:59648
    s_waitcnt lgkmcnt(10)
    v_mfma_f32_32x32x16_bf16 v[112:127], v[28:31], v[216:219], v[112:127]
    ds_read_b64_tr_b16 v[28:29], v3 offset:58912
    ds_read_b64_tr_b16 v[30:31], v3 offset:59680
    s_waitcnt lgkmcnt(10)
    v_mfma_f32_32x32x16_bf16 v[32:47], v[8:11], v[220:223], v[32:47]
    v_mfma_f32_32x32x16_bf16 v[80:95], v[182:185], v[140:143], v[80:95]
    ds_read_b64_tr_b16 v[8:9], v3 offset:0
    ds_read_b64_tr_b16 v[10:11], v3 offset:768
    s_waitcnt lgkmcnt(10)
    v_mfma_f32_32x32x16_bf16 v[48:63], v[12:15], v[220:223], v[48:63]
    v_mfma_f32_32x32x16_bf16 v[96:111], v[184:187], v[140:143], v[96:111]
    ds_read_b64_tr_b16 v[12:13], v3 offset:32
    ds_read_b64_tr_b16 v[14:15], v3 offset:800
    s_waitcnt lgkmcnt(10)
    v_mfma_f32_32x32x16_bf16 v[64:79], v[16:19], v[220:223], v[64:79]
    v_mfma_f32_32x32x16_bf16 v[112:127], v[186:189], v[140:143], v[112:127]
    ds_read_b64_tr_b16 v[16:17], v3 offset:64
    ds_read_b64_tr_b16 v[18:19], v3 offset:832
    s_waitcnt lgkmcnt(10)
    v_mfma_f32_32x32x16_bf16 v[80:95], v[20:23], v[220:223], v[80:95]
    v_mfma_f32_32x32x16_bf16 v[32:47], v[176:179], v[140:143], v[32:47]
    ds_read_b64_tr_b16 v[20:21], v3 offset:96
    ds_read_b64_tr_b16 v[22:23], v3 offset:864
    s_waitcnt lgkmcnt(10)
    v_mfma_f32_32x32x16_bf16 v[96:111], v[24:27], v[220:223], v[96:111]
    v_mfma_f32_32x32x16_bf16 v[48:63], v[178:181], v[140:143], v[48:63]
    ds_read_b64_tr_b16 v[24:25], v3 offset:128
    ds_read_b64_tr_b16 v[26:27], v3 offset:896
    s_waitcnt lgkmcnt(10)
    v_mfma_f32_32x32x16_bf16 v[112:127], v[28:31], v[220:223], v[112:127]
    v_mfma_f32_32x32x16_bf16 v[64:79], v[180:183], v[140:143], v[64:79]
    ds_read_b64_tr_b16 v[28:29], v3 offset:160
    ds_read_b64_tr_b16 v[30:31], v3 offset:928
    s_waitcnt lgkmcnt(10)
    v_mfma_f32_32x32x16_bf16 v[32:47], v[8:11], v[224:227], v[32:47]
    buffer_load_dword v151, v150, s[32:35], 0 offen sc1
    s_setprio 3
    v_mov_b32 v192, -1
    v_mov_b32 v193, -1
    v_mov_b32 v194, -1
    v_mov_b32 v195, -1
    s_setprio 0
    ds_read_b64_tr_b16 v[8:9], v3 offset:3072
    ds_read_b64_tr_b16 v[10:11], v3 offset:3840
    s_waitcnt lgkmcnt(10)
    v_mfma_f32_32x32x16_bf16 v[48:63], v[12:15], v[224:227], v[48:63]
    ds_read_b64_tr_b16 v[12:13], v3 offset:3104
    ds_read_b64_tr_b16 v[14:15], v3 offset:3872
    s_waitcnt lgkmcnt(10)
    v_mfma_f32_32x32x16_bf16 v[64:79], v[16:19], v[224:227], v[64:79]
    s_setprio 3
    v_mov_b32 v140, v137
    v_mov_b32 v141, v137
    v_mov_b32 v139, v138
    v_mov_b32 v137, v136
    s_setprio 0
    ds_read_b64_tr_b16 v[16:17], v3 offset:3136
    ds_read_b64_tr_b16 v[18:19], v3 offset:3904
    s_waitcnt lgkmcnt(10)
    v_mfma_f32_32x32x16_bf16 v[80:95], v[20:23], v[224:227], v[80:95]
    ds_read_b64_tr_b16 v[20:21], v3 offset:3168
    ds_read_b64_tr_b16 v[22:23], v3 offset:3936
    s_waitcnt lgkmcnt(10)
    v_mfma_f32_32x32x16_bf16 v[96:111], v[24:27], v[224:227], v[96:111]
    ds_read_b64_tr_b16 v[24:25], v3 offset:3200
    ds_read_b64_tr_b16 v[26:27], v3 offset:3968
    s_waitcnt lgkmcnt(10)
    v_mfma_f32_32x32x16_bf16 v[112:127], v[28:31], v[224:227], v[112:127]
    ds_read_b64_tr_b16 v[28:29], v3 offset:3232
    ds_read_b64_tr_b16 v[30:31], v3 offset:4000
    s_waitcnt lgkmcnt(10)
    v_mfma_f32_32x32x16_bf16 v[32:47], v[8:11], v[228:231], v[32:47]
    s_waitcnt vmcnt(1)
    s_mov_b64 exec, 1
    ds_add_u32 v7, v7 offset:92
    s_mov_b64 exec, -1
    ds_read_b64_tr_b16 v[8:9], v3 offset:6144
    ds_read_b64_tr_b16 v[10:11], v3 offset:6912
    s_waitcnt lgkmcnt(11)
    v_mfma_f32_32x32x16_bf16 v[48:63], v[12:15], v[228:231], v[48:63]
    s_setprio 3
    s_lshl2_add_u32 s49, s2, s45
    v_lshlrev_b32 v196, 7, v1
    s_mul_i32 s50, s49, 1408
    s_lshl_b32 s49, s49, 9
    s_mov_b64 exec, 0x7ff
    buffer_load_dword v197, v196, s[24:27], s50 offen
    s_mov_b64 exec, 15
    buffer_load_dword v197, v196, s[28:31], s49 offen
    s_mov_b64 exec, -1
    s_setprio 0
    ds_read_b64_tr_b16 v[12:13], v3 offset:6176
    ds_read_b64_tr_b16 v[14:15], v3 offset:6944
    s_waitcnt lgkmcnt(11)
    v_mfma_f32_32x32x16_bf16 v[64:79], v[16:19], v[228:231], v[64:79]
    ds_read_b32 v0, v7 offset:92
    ds_read_b64_tr_b16 v[16:17], v3 offset:6208
    ds_read_b64_tr_b16 v[18:19], v3 offset:6976
    s_waitcnt lgkmcnt(12)
    v_mfma_f32_32x32x16_bf16 v[80:95], v[20:23], v[228:231], v[80:95]
    ds_read_b64_tr_b16 v[20:21], v3 offset:6240
    ds_read_b64_tr_b16 v[22:23], v3 offset:7008
    s_waitcnt lgkmcnt(12)
    v_mfma_f32_32x32x16_bf16 v[96:111], v[24:27], v[228:231], v[96:111]
    ds_read_b64_tr_b16 v[24:25], v3 offset:6272
    ds_read_b64_tr_b16 v[26:27], v3 offset:7040
    s_waitcnt lgkmcnt(12)
    v_mfma_f32_32x32x16_bf16 v[112:127], v[28:31], v[228:231], v[112:127]
    ds_read_b64_tr_b16 v[28:29], v3 offset:6304
    ds_read_b64_tr_b16 v[30:31], v3 offset:7072
    s_waitcnt lgkmcnt(11)
    v_mfma_f32_32x32x16_bf16 v[32:47], v[8:11], v[232:235], v[32:47]
    ds_read_b64_tr_b16 v[8:9], v3 offset:9216
    ds_read_b64_tr_b16 v[10:11], v3 offset:9984
    s_waitcnt lgkmcnt(11)
    v_mfma_f32_32x32x16_bf16 v[48:63], v[12:15], v[232:235], v[48:63]
    s_waitcnt lgkmcnt(10)
    s_setprio 3
    v_cmp_ne_u32 vcc, 626944, v0
    s_setprio 0
    s_cbranch_vccz L_eBE6_ok_76
L_eBE6_sl_77:
    s_sleep 1
    ds_read_b32 v0, v7 offset:92
    s_waitcnt lgkmcnt(0)
    s_setprio 3
    v_cmp_ne_u32 vcc, 626944, v0
    s_setprio 0
    s_cbranch_vccnz L_eBE6_sl_77
L_eBE6_ok_76:
    ds_read_b64_tr_b16 v[12:13], v3 offset:9248
    ds_read_b64_tr_b16 v[14:15], v3 offset:10016
    s_waitcnt lgkmcnt(10)
    v_mfma_f32_32x32x16_bf16 v[64:79], v[16:19], v[232:235], v[64:79]
    s_waitcnt vmcnt(2)
    s_setprio 3
    v_cmp_ne_u32 vcc, s58, v151
    s_and_b32 s47, vcc_lo, 0xf0f0f0f0
    s_cbranch_scc0 L_gfa_ok_79
L_gfa_sl_80:
    s_mov_b32 s62, 65536
    s_nop 15
L_gfa_lp_81:
    s_sleep 8
    buffer_load_dword v151, v150, s[32:35], 0 offen sc1
    s_sub_u32 s62, s62, 1
    s_waitcnt vmcnt(0)
    s_cbranch_scc1 L_gfa_ok_79
    v_cmp_ne_u32 vcc, s58, v151
    s_and_b32 s47, vcc_lo, 0xf0f0f0f0
    s_cbranch_scc1 L_gfa_lp_81
L_gfa_ok_79:
    s_setprio 0
    s_add_u32 m0, s54, 66048
    s_xor_b32 s47, s64, 2113536
    buffer_load_dwordx4 v2, s[32:35], s47 offen sc1 lds
    ds_read_b64_tr_b16 v[16:17], v3 offset:9280
    ds_read_b64_tr_b16 v[18:19], v3 offset:10048
    s_waitcnt lgkmcnt(10)
    v_mfma_f32_32x32x16_bf16 v[80:95], v[20:23], v[232:235], v[80:95]
    s_add_u32 m0, s54, 67072
    s_xor_b32 s47, s64, 4210688
    buffer_load_dwordx4 v2, s[32:35], s47 offen sc1 lds
    ds_read_b64_tr_b16 v[20:21], v3 offset:9312
    ds_read_b64_tr_b16 v[22:23], v3 offset:10080
    s_waitcnt lgkmcnt(10)
    v_mfma_f32_32x32x16_bf16 v[96:111], v[24:27], v[232:235], v[96:111]
    s_add_u32 m0, s54, 74304
    s_xor_b32 s47, s64, 2117632
    buffer_load_dwordx4 v2, s[32:35], s47 offen sc1 lds
    ds_read_b64_tr_b16 v[24:25], v3 offset:9344
    ds_read_b64_tr_b16 v[26:27], v3 offset:10112
    s_waitcnt lgkmcnt(10)
    v_mfma_f32_32x32x16_bf16 v[112:127], v[28:31], v[232:235], v[112:127]
    s_add_u32 m0, s54, 75328
    s_xor_b32 s47, s64, 4214784
    buffer_load_dwordx4 v2, s[32:35], s47 offen sc1 lds
    ds_read_b64_tr_b16 v[28:29], v3 offset:9376
    ds_read_b64_tr_b16 v[30:31], v3 offset:10144
    s_waitcnt lgkmcnt(10)
    v_mfma_f32_32x32x16_bf16 v[32:47], v[8:11], v[236:239], v[32:47]
    ds_read_b64_tr_b16 v[8:9], v3 offset:24640
    ds_read_b64_tr_b16 v[10:11], v3 offset:25408
    s_waitcnt lgkmcnt(10)
    v_mfma_f32_32x32x16_bf16 v[48:63], v[12:15], v[236:239], v[48:63]
    ds_read_b64_tr_b16 v[12:13], v3 offset:24672
    ds_read_b64_tr_b16 v[14:15], v3 offset:25440
    s_waitcnt lgkmcnt(10)
    v_mfma_f32_32x32x16_bf16 v[64:79], v[16:19], v[236:239], v[64:79]
    ds_read_b64_tr_b16 v[16:17], v3 offset:24704
    ds_read_b64_tr_b16 v[18:19], v3 offset:25472
    s_waitcnt lgkmcnt(10)
    v_mfma_f32_32x32x16_bf16 v[80:95], v[20:23], v[236:239], v[80:95]
    ds_read_b64_tr_b16 v[20:21], v3 offset:24736
    ds_read_b64_tr_b16 v[22:23], v3 offset:25504
    s_waitcnt lgkmcnt(10)
    v_mfma_f32_32x32x16_bf16 v[96:111], v[24:27], v[236:239], v[96:111]
    ds_read_b64_tr_b16 v[24:25], v3 offset:24768
    ds_read_b64_tr_b16 v[26:27], v3 offset:25536
    s_waitcnt lgkmcnt(10)
    v_mfma_f32_32x32x16_bf16 v[112:127], v[28:31], v[236:239], v[112:127]
    ds_read_b64_tr_b16 v[28:29], v3 offset:24800
    ds_read_b64_tr_b16 v[30:31], v3 offset:25568
    s_waitcnt lgkmcnt(10)
    v_mfma_f32_32x32x16_bf16 v[32:47], v[8:11], v[240:243], v[32:47]
    ds_read_b64_tr_b16 v[8:9], v3 offset:27712
    ds_read_b64_tr_b16 v[10:11], v3 offset:28480
    s_waitcnt lgkmcnt(10)
    v_mfma_f32_32x32x16_bf16 v[48:63], v[12:15], v[240:243], v[48:63]
    ds_read_b64_tr_b16 v[12:13], v3 offset:27744
    ds_read_b64_tr_b16 v[14:15], v3 offset:28512
    s_waitcnt lgkmcnt(10)
    v_mfma_f32_32x32x16_bf16 v[64:79], v[16:19], v[240:243], v[64:79]
    ds_read_b64_tr_b16 v[16:17], v3 offset:27776
    ds_read_b64_tr_b16 v[18:19], v3 offset:28544
    s_waitcnt lgkmcnt(10)
    v_mfma_f32_32x32x16_bf16 v[80:95], v[20:23], v[240:243], v[80:95]
    ds_read_b64_tr_b16 v[20:21], v3 offset:27808
    ds_read_b64_tr_b16 v[22:23], v3 offset:28576
    s_waitcnt lgkmcnt(10)
    v_mfma_f32_32x32x16_bf16 v[96:111], v[24:27], v[240:243], v[96:111]
    ds_read_b64_tr_b16 v[24:25], v3 offset:27840
    ds_read_b64_tr_b16 v[26:27], v3 offset:28608
    s_waitcnt lgkmcnt(10)
    v_mfma_f32_32x32x16_bf16 v[112:127], v[28:31], v[240:243], v[112:127]
    ds_read_b64_tr_b16 v[28:29], v3 offset:27872
    ds_read_b64_tr_b16 v[30:31], v3 offset:28640
    s_waitcnt lgkmcnt(10)
    v_mfma_f32_32x32x16_bf16 v[32:47], v[8:11], v[244:247], v[32:47]
    ds_read_b64_tr_b16 v[8:9], v3 offset:30784
    ds_read_b64_tr_b16 v[10:11], v3 offset:31552
    s_waitcnt lgkmcnt(10)
    v_mfma_f32_32x32x16_bf16 v[48:63], v[12:15], v[244:247], v[48:63]
    ds_read_b64_tr_b16 v[12:13], v3 offset:30816
    ds_read_b64_tr_b16 v[14:15], v3 offset:31584
    s_waitcnt lgkmcnt(10)
    v_mfma_f32_32x32x16_bf16 v[64:79], v[16:19], v[244:247], v[64:79]
    ds_read_b64_tr_b16 v[16:17], v3 offset:30848
    ds_read_b64_tr_b16 v[18:19], v3 offset:31616
    s_waitcnt lgkmcnt(10)
    v_mfma_f32_32x32x16_bf16 v[80:95], v[20:23], v[244:247], v[80:95]
    ds_read_b64_tr_b16 v[20:21], v3 offset:30880
    ds_read_b64_tr_b16 v[22:23], v3 offset:31648
    s_waitcnt lgkmcnt(10)
    v_mfma_f32_32x32x16_bf16 v[96:111], v[24:27], v[244:247], v[96:111]
    ds_read_b64_tr_b16 v[24:25], v3 offset:30912
    ds_read_b64_tr_b16 v[26:27], v3 offset:31680
    s_waitcnt lgkmcnt(10)
    v_mfma_f32_32x32x16_bf16 v[112:127], v[28:31], v[244:247], v[112:127]
    ds_read_b64_tr_b16 v[28:29], v3 offset:30944
    ds_read_b64_tr_b16 v[30:31], v3 offset:31712
    s_waitcnt lgkmcnt(10)
    v_mfma_f32_32x32x16_bf16 v[32:47], v[8:11], v[248:251], v[32:47]
    ds_read_b64_tr_b16 v[8:9], v3 offset:33856
    ds_read_b64_tr_b16 v[10:11], v3 offset:34624
    s_waitcnt lgkmcnt(10)
    v_mfma_f32_32x32x16_bf16 v[48:63], v[12:15], v[248:251], v[48:63]
    ds_read_b64_tr_b16 v[12:13], v3 offset:33888
    ds_read_b64_tr_b16 v[14:15], v3 offset:34656
    s_waitcnt lgkmcnt(10)
    v_mfma_f32_32x32x16_bf16 v[64:79], v[16:19], v[248:251], v[64:79]
    ds_read_b64_tr_b16 v[16:17], v3 offset:33920
    ds_read_b64_tr_b16 v[18:19], v3 offset:34688
    s_waitcnt lgkmcnt(10)
    v_mfma_f32_32x32x16_bf16 v[80:95], v[20:23], v[248:251], v[80:95]
    ds_read_b64_tr_b16 v[20:21], v3 offset:33952
    ds_read_b64_tr_b16 v[22:23], v3 offset:34720
    s_waitcnt lgkmcnt(10)
    v_mfma_f32_32x32x16_bf16 v[96:111], v[24:27], v[248:251], v[96:111]
    ds_read_b64_tr_b16 v[24:25], v3 offset:33984
    ds_read_b64_tr_b16 v[26:27], v3 offset:34752
    s_waitcnt lgkmcnt(10)
    v_mfma_f32_32x32x16_bf16 v[112:127], v[28:31], v[248:251], v[112:127]
    ds_read_b64_tr_b16 v[28:29], v3 offset:34016
    ds_read_b64_tr_b16 v[30:31], v3 offset:34784
    s_waitcnt lgkmcnt(10)
    v_mfma_f32_32x32x16_bf16 v[32:47], v[8:11], v[252:255], v[32:47]
    s_waitcnt lgkmcnt(8)
    v_mfma_f32_32x32x16_bf16 v[48:63], v[12:15], v[252:255], v[48:63]
    s_waitcnt lgkmcnt(6)
    v_mfma_f32_32x32x16_bf16 v[64:79], v[16:19], v[252:255], v[64:79]
    s_waitcnt lgkmcnt(4)
    v_mfma_f32_32x32x16_bf16 v[80:95], v[20:23], v[252:255], v[80:95]
    s_waitcnt lgkmcnt(2)
    v_mfma_f32_32x32x16_bf16 v[96:111], v[24:27], v[252:255], v[96:111]
    s_waitcnt lgkmcnt(0)
    v_mfma_f32_32x32x16_bf16 v[112:127], v[28:31], v[252:255], v[112:127]
    s_setprio 3
    s_mov_b64 exec, 1
    ds_add_u32 v7, v7 offset:56
    s_mov_b64 exec, -1
    s_waitcnt vmcnt(0)
    s_mov_b64 exec, 1
    ds_add_u32 v7, v7 offset:28
    s_mov_b64 exec, -1
    s_lshl_b32 s48, s43, 2
    s_add_u32 s48, s48, s45
    s_mul_i32 s48, s48, 88
    s_mul_i32 s56, s44, 6
    s_add_u32 s48, s48, s56
    s_add_u32 s48, s48, 6144
    s_lshl_b32 s48, s48, 10
    v_pk_mul_f32 v[128:129], v[32:33], v[32:33]
    v_pk_mul_f32 v[130:131], v[34:35], v[34:35]
    v_pk_mul_f32 v[132:133], v[36:37], v[36:37]
    v_pk_mul_f32 v[134:135], v[38:39], v[38:39]
    v_pk_fma_f32 v[128:129], v[128:129], v[140:141], v[138:139]
    v_pk_fma_f32 v[130:131], v[130:131], v[140:141], v[138:139]
    v_pk_fma_f32 v[132:133], v[132:133], v[140:141], v[138:139]
    v_pk_fma_f32 v[134:135], v[134:135], v[140:141], v[138:139]
    v_pk_mul_f32 v[128:129], v[128:129], v[32:33]
    v_pk_mul_f32 v[130:131], v[130:131], v[34:35]
    v_pk_mul_f32 v[132:133], v[132:133], v[36:37]
    v_pk_mul_f32 v[134:135], v[134:135], v[38:39]
    ds_read_b32 v0, v7 offset:56
    v_exp_f32 v128, v128
    v_exp_f32 v129, v129
    v_pk_mul_f32 v[40:41], v[32:33], v[40:41]
    v_exp_f32 v130, v130
    v_exp_f32 v131, v131
    v_pk_mul_f32 v[42:43], v[34:35], v[42:43]
    v_exp_f32 v132, v132
    v_exp_f32 v133, v133
    v_pk_mul_f32 v[44:45], v[36:37], v[44:45]
    v_exp_f32 v134, v134
    v_exp_f32 v135, v135
    v_pk_mul_f32 v[46:47], v[38:39], v[46:47]
    v_pk_fma_f32 v[128:129], v[128:129], v[136:137], v[136:137]
    v_pk_fma_f32 v[130:131], v[130:131], v[136:137], v[136:137]
    v_pk_fma_f32 v[132:133], v[132:133], v[136:137], v[136:137]
    v_pk_fma_f32 v[134:135], v[134:135], v[136:137], v[136:137]
    v_rcp_f32 v128, v128
    v_rcp_f32 v129, v129
    v_rcp_f32 v130, v130
    v_rcp_f32 v131, v131
    v_rcp_f32 v132, v132
    v_rcp_f32 v133, v133
    v_rcp_f32 v134, v134
    v_rcp_f32 v135, v135
    v_pk_mul_f32 v[128:129], v[128:129], v[40:41]
    v_pk_mul_f32 v[130:131], v[130:131], v[42:43]
    v_pk_mul_f32 v[132:133], v[132:133], v[44:45]
    v_pk_mul_f32 v[134:135], v[134:135], v[46:47]
    v_cvt_pk_bf16_f32 v32, v128, v129
    v_cvt_pk_bf16_f32 v33, v130, v131
    v_cvt_pk_bf16_f32 v34, v132, v133
    v_cvt_pk_bf16_f32 v35, v134, v135
    s_add_u32 s50, s48, 0
    buffer_store_dwordx4 v[32:35], v2, s[32:35], s50 offen sc1
    s_waitcnt lgkmcnt(0)
    v_cmp_ne_u32 vcc, 626944, v0
    s_nop 0
    s_cbranch_vccz L_eBC7_ok_82
L_eBC7_sl_83:
    s_sleep 1
    ds_read_b32 v0, v7 offset:56
    s_waitcnt lgkmcnt(0)
    v_cmp_ne_u32 vcc, 626944, v0
    s_nop 0
    s_cbranch_vccnz L_eBC7_sl_83
L_eBC7_ok_82:
    ds_write_b128 v152, v[156:159] offset:33024
    s_lshl_b32 s66, s61, 3
    s_add_u32 s66, s66, s45
    s_lshl_b32 s66, s66, 5
    s_add_u32 s66, s66, s60
    s_lshl_b32 s66, s66, 10
    s_add_u32 s47, s66, 12058624
    buffer_store_dwordx4 v[192:195], v2, s[32:35], s47 offen sc1
    s_add_u32 s47, s66, 12189696
    buffer_store_dwordx4 v[192:195], v2, s[32:35], s47 offen sc1
    v_pk_mul_f32 v[128:129], v[48:49], v[48:49]
    s_add_u32 m0, s54, 82560
    s_xor_b32 s47, s64, 2121728
    buffer_load_dwordx4 v2, s[32:35], s47 offen sc1 lds
    v_pk_mul_f32 v[130:131], v[50:51], v[50:51]
    v_pk_mul_f32 v[132:133], v[52:53], v[52:53]
    v_pk_mul_f32 v[134:135], v[54:55], v[54:55]
    v_pk_fma_f32 v[128:129], v[128:129], v[140:141], v[138:139]
    v_pk_fma_f32 v[130:131], v[130:131], v[140:141], v[138:139]
    v_pk_fma_f32 v[132:133], v[132:133], v[140:141], v[138:139]
    v_pk_fma_f32 v[134:135], v[134:135], v[140:141], v[138:139]
    v_pk_mul_f32 v[128:129], v[128:129], v[48:49]
    s_add_u32 m0, s54, 83584
    s_xor_b32 s47, s64, 4218880
    buffer_load_dwordx4 v2, s[32:35], s47 offen sc1 lds
    v_pk_mul_f32 v[130:131], v[130:131], v[50:51]
    v_pk_mul_f32 v[132:133], v[132:133], v[52:53]
    v_pk_mul_f32 v[134:135], v[134:135], v[54:55]
    v_exp_f32 v128, v128
    v_exp_f32 v129, v129
    v_pk_mul_f32 v[56:57], v[48:49], v[56:57]
    v_exp_f32 v130, v130
    v_exp_f32 v131, v131
    s_add_u32 m0, s54, 90816
    s_xor_b32 s47, s64, 2125824
    buffer_load_dwordx4 v2, s[32:35], s47 offen sc1 lds
    v_pk_mul_f32 v[58:59], v[50:51], v[58:59]
    v_exp_f32 v132, v132
    v_exp_f32 v133, v133
    v_pk_mul_f32 v[60:61], v[52:53], v[60:61]
    v_exp_f32 v134, v134
    v_exp_f32 v135, v135
    v_pk_mul_f32 v[62:63], v[54:55], v[62:63]
    v_pk_fma_f32 v[128:129], v[128:129], v[136:137], v[136:137]
    s_add_u32 m0, s54, 91840
    s_xor_b32 s47, s64, 4222976
    buffer_load_dwordx4 v2, s[32:35], s47 offen sc1 lds
    v_pk_fma_f32 v[130:131], v[130:131], v[136:137], v[136:137]
    v_pk_fma_f32 v[132:133], v[132:133], v[136:137], v[136:137]
    v_pk_fma_f32 v[134:135], v[134:135], v[136:137], v[136:137]
    v_rcp_f32 v128, v128
    v_rcp_f32 v129, v129
    v_rcp_f32 v130, v130
    v_rcp_f32 v131, v131
    v_rcp_f32 v132, v132
    s_add_u32 m0, s54, 99072
    s_xor_b32 s47, s64, 2146304
    buffer_load_dwordx4 v2, s[32:35], s47 offen sc1 lds
    v_rcp_f32 v133, v133
    v_rcp_f32 v134, v134
    v_rcp_f32 v135, v135
    v_pk_mul_f32 v[128:129], v[128:129], v[56:57]
    v_pk_mul_f32 v[130:131], v[130:131], v[58:59]
    v_pk_mul_f32 v[132:133], v[132:133], v[60:61]
    v_pk_mul_f32 v[134:135], v[134:135], v[62:63]
    v_cvt_pk_bf16_f32 v48, v128, v129
    s_add_u32 m0, s54, 100096
    s_xor_b32 s47, s64, 4243456
    buffer_load_dwordx4 v2, s[32:35], s47 offen sc1 lds
    v_cvt_pk_bf16_f32 v49, v130, v131
    v_cvt_pk_bf16_f32 v50, v132, v133
    v_cvt_pk_bf16_f32 v51, v134, v135
    s_add_u32 s50, s48, 1024
    buffer_store_dwordx4 v[48:51], v2, s[32:35], s50 offen sc1
    v_pk_mul_f32 v[128:129], v[64:65], v[64:65]
    v_pk_mul_f32 v[130:131], v[66:67], v[66:67]
    v_pk_mul_f32 v[132:133], v[68:69], v[68:69]
    v_pk_mul_f32 v[134:135], v[70:71], v[70:71]
    s_add_u32 m0, s54, 107328
    s_xor_b32 s47, s64, 2150400
    buffer_load_dwordx4 v2, s[32:35], s47 offen sc1 lds
    v_pk_fma_f32 v[128:129], v[128:129], v[140:141], v[138:139]
    v_pk_fma_f32 v[130:131], v[130:131], v[140:141], v[138:139]
    v_pk_fma_f32 v[132:133], v[132:133], v[140:141], v[138:139]
    v_pk_fma_f32 v[134:135], v[134:135], v[140:141], v[138:139]
    v_pk_mul_f32 v[128:129], v[128:129], v[64:65]
    v_pk_mul_f32 v[130:131], v[130:131], v[66:67]
    v_pk_mul_f32 v[132:133], v[132:133], v[68:69]
    v_pk_mul_f32 v[134:135], v[134:135], v[70:71]
    s_add_u32 m0, s54, 108352
    s_xor_b32 s47, s64, 4247552
    buffer_load_dwordx4 v2, s[32:35], s47 offen sc1 lds
    v_exp_f32 v128, v128
    v_exp_f32 v129, v129
    v_pk_mul_f32 v[72:73], v[64:65], v[72:73]
    v_exp_f32 v130, v130
    v_exp_f32 v131, v131
    v_pk_mul_f32 v[74:75], v[66:67], v[74:75]
    v_exp_f32 v132, v132
    v_exp_f32 v133, v133
    s_add_u32 m0, s54, 115584
    s_xor_b32 s47, s64, 2154496
    buffer_load_dwordx4 v2, s[32:35], s47 offen sc1 lds
    v_pk_mul_f32 v[76:77], v[68:69], v[76:77]
    v_exp_f32 v134, v134
    v_exp_f32 v135, v135
    v_pk_mul_f32 v[78:79], v[70:71], v[78:79]
    v_pk_fma_f32 v[128:129], v[128:129], v[136:137], v[136:137]
    v_pk_fma_f32 v[130:131], v[130:131], v[136:137], v[136:137]
    v_pk_fma_f32 v[132:133], v[132:133], v[136:137], v[136:137]
    v_pk_fma_f32 v[134:135], v[134:135], v[136:137], v[136:137]
    s_add_u32 m0, s54, 116608
    s_xor_b32 s47, s64, 4251648
    buffer_load_dwordx4 v2, s[32:35], s47 offen sc1 lds
    v_rcp_f32 v128, v128
    v_rcp_f32 v129, v129
    v_rcp_f32 v130, v130
    v_rcp_f32 v131, v131
    v_rcp_f32 v132, v132
    v_rcp_f32 v133, v133
    v_rcp_f32 v134, v134
    v_rcp_f32 v135, v135
    s_add_u32 m0, s54, 123840
    s_xor_b32 s47, s64, 2158592
    buffer_load_dwordx4 v2, s[32:35], s47 offen sc1 lds
    v_pk_mul_f32 v[128:129], v[128:129], v[72:73]
    v_pk_mul_f32 v[130:131], v[130:131], v[74:75]
    v_pk_mul_f32 v[132:133], v[132:133], v[76:77]
    v_pk_mul_f32 v[134:135], v[134:135], v[78:79]
    v_cvt_pk_bf16_f32 v64, v128, v129
    v_cvt_pk_bf16_f32 v65, v130, v131
    v_cvt_pk_bf16_f32 v66, v132, v133
    v_cvt_pk_bf16_f32 v67, v134, v135
    s_add_u32 m0, s54, 124864
    s_xor_b32 s47, s64, 4255744
    buffer_load_dwordx4 v2, s[32:35], s47 offen sc1 lds
    s_add_u32 s50, s48, 2048
    buffer_store_dwordx4 v[64:67], v2, s[32:35], s50 offen sc1
    v_pk_mul_f32 v[128:129], v[80:81], v[80:81]
    v_pk_mul_f32 v[130:131], v[82:83], v[82:83]
    v_pk_mul_f32 v[132:133], v[84:85], v[84:85]
    v_pk_mul_f32 v[134:135], v[86:87], v[86:87]
    v_pk_fma_f32 v[128:129], v[128:129], v[140:141], v[138:139]
    v_pk_fma_f32 v[130:131], v[130:131], v[140:141], v[138:139]
    v_pk_fma_f32 v[132:133], v[132:133], v[140:141], v[138:139]
    v_pk_fma_f32 v[134:135], v[134:135], v[140:141], v[138:139]
    v_pk_mul_f32 v[128:129], v[128:129], v[80:81]
    v_pk_mul_f32 v[130:131], v[130:131], v[82:83]
    v_pk_mul_f32 v[132:133], v[132:133], v[84:85]
    v_pk_mul_f32 v[134:135], v[134:135], v[86:87]
    v_exp_f32 v128, v128
    v_exp_f32 v129, v129
    v_pk_mul_f32 v[88:89], v[80:81], v[88:89]
    v_exp_f32 v130, v130
    v_exp_f32 v131, v131
    v_pk_mul_f32 v[90:91], v[82:83], v[90:91]
    v_exp_f32 v132, v132
    v_exp_f32 v133, v133
    v_pk_mul_f32 v[92:93], v[84:85], v[92:93]
    v_exp_f32 v134, v134
    v_exp_f32 v135, v135
    v_pk_mul_f32 v[94:95], v[86:87], v[94:95]
    v_pk_fma_f32 v[128:129], v[128:129], v[136:137], v[136:137]
    v_pk_fma_f32 v[130:131], v[130:131], v[136:137], v[136:137]
    v_pk_fma_f32 v[132:133], v[132:133], v[136:137], v[136:137]
    v_pk_fma_f32 v[134:135], v[134:135], v[136:137], v[136:137]
    v_rcp_f32 v128, v128
    v_rcp_f32 v129, v129
    v_rcp_f32 v130, v130
    v_rcp_f32 v131, v131
    v_rcp_f32 v132, v132
    v_rcp_f32 v133, v133
    v_rcp_f32 v134, v134
    v_rcp_f32 v135, v135
    v_pk_mul_f32 v[128:129], v[128:129], v[88:89]
    v_pk_mul_f32 v[130:131], v[130:131], v[90:91]
    v_pk_mul_f32 v[132:133], v[132:133], v[92:93]
    v_pk_mul_f32 v[134:135], v[134:135], v[94:95]
    v_cvt_pk_bf16_f32 v80, v128, v129
    v_cvt_pk_bf16_f32 v81, v130, v131
    v_cvt_pk_bf16_f32 v82, v132, v133
    v_cvt_pk_bf16_f32 v83, v134, v135
    s_add_u32 s50, s48, 3072
    buffer_store_dwordx4 v[80:83], v2, s[32:35], s50 offen sc1
    v_pk_mul_f32 v[128:129], v[96:97], v[96:97]
    v_pk_mul_f32 v[130:131], v[98:99], v[98:99]
    v_pk_mul_f32 v[132:133], v[100:101], v[100:101]
    v_pk_mul_f32 v[134:135], v[102:103], v[102:103]
    v_pk_fma_f32 v[128:129], v[128:129], v[140:141], v[138:139]
    v_pk_fma_f32 v[130:131], v[130:131], v[140:141], v[138:139]
    v_pk_fma_f32 v[132:133], v[132:133], v[140:141], v[138:139]
    v_pk_fma_f32 v[134:135], v[134:135], v[140:141], v[138:139]
    v_pk_mul_f32 v[128:129], v[128:129], v[96:97]
    v_pk_mul_f32 v[130:131], v[130:131], v[98:99]
    v_pk_mul_f32 v[132:133], v[132:133], v[100:101]
    v_pk_mul_f32 v[134:135], v[134:135], v[102:103]
    v_exp_f32 v128, v128
    v_exp_f32 v129, v129
    v_pk_mul_f32 v[104:105], v[96:97], v[104:105]
    v_exp_f32 v130, v130
    v_exp_f32 v131, v131
    v_pk_mul_f32 v[106:107], v[98:99], v[106:107]
    v_exp_f32 v132, v132
    v_exp_f32 v133, v133
    v_pk_mul_f32 v[108:109], v[100:101], v[108:109]
    v_exp_f32 v134, v134
    v_exp_f32 v135, v135
    v_pk_mul_f32 v[110:111], v[102:103], v[110:111]
    v_pk_fma_f32 v[128:129], v[128:129], v[136:137], v[136:137]
    v_pk_fma_f32 v[130:131], v[130:131], v[136:137], v[136:137]
    v_pk_fma_f32 v[132:133], v[132:133], v[136:137], v[136:137]
    v_pk_fma_f32 v[134:135], v[134:135], v[136:137], v[136:137]
    v_rcp_f32 v128, v128
    v_rcp_f32 v129, v129
    v_rcp_f32 v130, v130
    v_rcp_f32 v131, v131
    v_rcp_f32 v132, v132
    v_rcp_f32 v133, v133
    v_rcp_f32 v134, v134
    v_rcp_f32 v135, v135
    v_pk_mul_f32 v[128:129], v[128:129], v[104:105]
    v_pk_mul_f32 v[130:131], v[130:131], v[106:107]
    v_pk_mul_f32 v[132:133], v[132:133], v[108:109]
    v_pk_mul_f32 v[134:135], v[134:135], v[110:111]
    v_cvt_pk_bf16_f32 v96, v128, v129
    v_cvt_pk_bf16_f32 v97, v130, v131
    v_cvt_pk_bf16_f32 v98, v132, v133
    v_cvt_pk_bf16_f32 v99, v134, v135
    s_add_u32 s50, s48, 4096
    buffer_store_dwordx4 v[96:99], v2, s[32:35], s50 offen sc1
    v_pk_mul_f32 v[128:129], v[112:113], v[112:113]
    v_pk_mul_f32 v[130:131], v[114:115], v[114:115]
    v_pk_mul_f32 v[132:133], v[116:117], v[116:117]
    v_pk_mul_f32 v[134:135], v[118:119], v[118:119]
    v_pk_fma_f32 v[128:129], v[128:129], v[140:141], v[138:139]
    v_pk_fma_f32 v[130:131], v[130:131], v[140:141], v[138:139]
    v_pk_fma_f32 v[132:133], v[132:133], v[140:141], v[138:139]
    v_pk_fma_f32 v[134:135], v[134:135], v[140:141], v[138:139]
    v_pk_mul_f32 v[128:129], v[128:129], v[112:113]
    v_pk_mul_f32 v[130:131], v[130:131], v[114:115]
    v_pk_mul_f32 v[132:133], v[132:133], v[116:117]
    v_pk_mul_f32 v[134:135], v[134:135], v[118:119]
    v_exp_f32 v128, v128
    v_exp_f32 v129, v129
    v_pk_mul_f32 v[120:121], v[112:113], v[120:121]
    v_exp_f32 v130, v130
    v_exp_f32 v131, v131
    v_pk_mul_f32 v[122:123], v[114:115], v[122:123]
    v_exp_f32 v132, v132
    v_exp_f32 v133, v133
    v_pk_mul_f32 v[124:125], v[116:117], v[124:125]
    v_exp_f32 v134, v134
    v_exp_f32 v135, v135
    v_pk_mul_f32 v[126:127], v[118:119], v[126:127]
    v_pk_fma_f32 v[128:129], v[128:129], v[136:137], v[136:137]
    v_pk_fma_f32 v[130:131], v[130:131], v[136:137], v[136:137]
    v_pk_fma_f32 v[132:133], v[132:133], v[136:137], v[136:137]
    v_pk_fma_f32 v[134:135], v[134:135], v[136:137], v[136:137]
    v_rcp_f32 v128, v128
    v_rcp_f32 v129, v129
    v_rcp_f32 v130, v130
    v_rcp_f32 v131, v131
    v_rcp_f32 v132, v132
    v_rcp_f32 v133, v133
    v_rcp_f32 v134, v134
    v_rcp_f32 v135, v135
    v_pk_mul_f32 v[128:129], v[128:129], v[120:121]
    v_pk_mul_f32 v[130:131], v[130:131], v[122:123]
    v_pk_mul_f32 v[132:133], v[132:133], v[124:125]
    v_pk_mul_f32 v[134:135], v[134:135], v[126:127]
    v_cvt_pk_bf16_f32 v112, v128, v129
    v_cvt_pk_bf16_f32 v113, v130, v131
    v_cvt_pk_bf16_f32 v114, v132, v133
    v_cvt_pk_bf16_f32 v115, v134, v135
    s_add_u32 s50, s48, 5120
    buffer_store_dwordx4 v[112:115], v2, s[32:35], s50 offen sc1
    s_setprio 3
L_G_d:
    s_lshr_b32 s47, s43, 1
    s_lshl_b32 s47, s47, 2
    s_add_u32 s47, s47, s45
    s_lshl_b32 s47, s47, 2
    s_and_b32 s48, s43, 1
    s_add_u32 s47, s47, s48
    s_lshl_b32 s47, s47, 3
    s_add_u32 s47, s47, s44
    s_lshl_b32 s47, s47, 1
    s_add_u32 s47, s47, s46
    s_lshl_b32 s47, s47, 7
    s_add_u32 s47, s47, 14487552
    v_mov_b32 v20, 1073741824
    v_writelane_b32 v20, s47, 0
    s_lshl_b32 s48, s61, 2
    s_add_u32 s48, s48, s45
    s_lshl_b32 s48, s48, 6
    s_add_u32 s48, s48, s60
    s_lshl_b32 s48, s48, 7
    s_add_u32 s48, s48, 14749696
    v_writelane_b32 v20, s48, 1
    v_mov_b32 v21, s58
    s_lshr_b32 s65, s42, 2
    s_lshl_b32 s65, s65, 7
    s_lshl_b32 s55, s45, 11
    s_lshl_b32 s47, s45, 14
    v_add_u32 v9, s47, v146
    s_and_b32 s47, s41, 1
    s_xor_b32 s47, s47, 1
    s_lshl_b32 s47, s47, 2
    s_lshr_b32 s41, s41, 1
    s_add_u32 s41, s41, s47
    s_lshl_b32 s47, s41, 2
    s_and_b32 s48, s42, 3
    s_add_u32 s47, s47, s48
    s_mul_i32 s47, s47, 8192
    s_add_u32 s47, s47, 14487552
    v_add_u32 v11, s47, v147
    s_lshl_b32 s59, s41, 3
    s_add_u32 s59, s59, s48
    s_and_b32 s47, s45, 2
    s_lshl_b32 s47, s47, 1
    s_add_u32 s59, s59, s47
    s_and_b32 s49, s45, 1
    s_lshl_b32 s48, s49, 12
    s_mul_i32 s57, s59, 90112
    s_add_u32 s57, s57, s48
    s_add_u32 s57, s57, 6291456
    s_lshl_b32 s59, s59, 15
    s_add_u32 s66, s59, s48
    s_add_u32 s66, s66, 12058624
    s_lshl_b32 s48, s49, 6
    s_add_u32 s47, s48, s65
    s_add_u32 s47, s47, s59
    v_add_u32 v10, s47, v148
    s_waitcnt vmcnt(0)
    buffer_store_dword v21, v20, s[32:35], 0 offen sc1
    s_mov_b64 exec, 1
    ds_add_u32 v7, v7 offset:32
    s_mov_b64 exec, -1
    buffer_load_dwordx4 v[240:243], v10, s[8:11], 0 offen offset:0
    buffer_load_dwordx4 v[244:247], v10, s[8:11], 0 offen offset:32
    s_add_u32 m0, s55, 132096
    s_add_u32 s47, s65, 0
    buffer_load_dwordx4 v9, s[24:27], s47 offen lds
    s_add_u32 m0, s55, 133120
    s_add_u32 s47, s65, 8192
    buffer_load_dwordx4 v9, s[24:27], s47 offen lds
    s_add_u32 m0, s55, 140288
    s_add_u32 s47, s65, 65536
    buffer_load_dwordx4 v9, s[24:27], s47 offen lds
    s_add_u32 m0, s55, 141312
    s_add_u32 s47, s65, 73728
    buffer_load_dwordx4 v9, s[24:27], s47 offen lds
    s_mul_i32 s47, s49, 8256
    v_xor_b32 v3, s47, v149
    v_xor_b32 v4, 64, v3
    v_add_u32 v5, 132096, v3
    v_add_u32 v6, 132096, v4
    v_add_u32 v28, 66048, v3
    v_add_u32 v29, 66048, v4
    s_mov_b64 exec, 0
    s_cmp_eq_u32 s45, 0
    s_cbranch_scc1 L_tp8800
    s_cmp_eq_u32 s45, 1
    s_cbranch_scc1 L_tp9686
    s_cmp_eq_u32 s45, 2
    s_cbranch_scc1 L_tp10568
    s_branch L_ret_d
L_ret_d:
    s_mov_b64 exec, -1
    s_mov_b64 exec, 0
    s_cmp_eq_u32 s45, 0
    s_cbranch_scc1 L_ret_d2
    s_cmp_eq_u32 s45, 1
    s_cbranch_scc1 L_ret_d2
    s_cmp_eq_u32 s45, 2
    s_cbranch_scc1 L_ret_d2
    s_branch L_ret_d2
L_ret_d2:
    s_mov_b64 exec, -1
    ds_read_b32 v0, v7 offset:36
    s_waitcnt lgkmcnt(0)
    v_cmp_ne_u32 vcc, 626944, v0
    s_nop 0
    s_cbranch_vccz L_eTP1_ok_85
L_eTP1_sl_86:
    s_sleep 8
    ds_read_b32 v0, v7 offset:36
    s_waitcnt lgkmcnt(0)
    v_cmp_ne_u32 vcc, 626944, v0
    s_nop 0
    s_cbranch_vccnz L_eTP1_sl_86
L_eTP1_ok_85:
    s_add_u32 m0, s55, 0
    s_add_u32 s47, s65, 131072
    buffer_load_dwordx4 v9, s[24:27], s47 offen lds
    s_add_u32 m0, s55, 1024
    s_add_u32 s47, s65, 139264
    buffer_load_dwordx4 v9, s[24:27], s47 offen lds
    s_add_u32 m0, s55, 8192
    s_add_u32 s47, s65, 196608
    buffer_load_dwordx4 v9, s[24:27], s47 offen lds
    s_add_u32 m0, s55, 9216
    s_add_u32 s47, s65, 204800
    buffer_load_dwordx4 v9, s[24:27], s47 offen lds
    s_add_u32 m0, s55, 16384
    s_add_u32 s47, s65, 262144
    buffer_load_dwordx4 v9, s[24:27], s47 offen lds
    s_add_u32 m0, s55, 17408
    s_add_u32 s47, s65, 270336
    buffer_load_dwordx4 v9, s[24:27], s47 offen lds
    s_add_u32 m0, s55, 24576
    s_add_u32 s47, s65, 327680
    buffer_load_dwordx4 v9, s[24:27], s47 offen lds
    s_add_u32 m0, s55, 25600
    s_add_u32 s47, s65, 335872
    buffer_load_dwordx4 v9, s[24:27], s47 offen lds
    s_waitcnt vmcnt(12)
    v_lshlrev_b32 v32, 16, v240
    v_and_b32 v33, 0xffff0000, v240
    v_lshlrev_b32 v34, 16, v241
    v_and_b32 v35, 0xffff0000, v241
    v_lshlrev_b32 v36, 16, v242
    v_and_b32 v37, 0xffff0000, v242
    v_lshlrev_b32 v38, 16, v243
    v_and_b32 v39, 0xffff0000, v243
    v_lshlrev_b32 v40, 16, v244
    v_and_b32 v41, 0xffff0000, v244
    v_lshlrev_b32 v42, 16, v245
    v_and_b32 v43, 0xffff0000, v245
    v_lshlrev_b32 v44, 16, v246
    v_and_b32 v45, 0xffff0000, v246
    v_lshlrev_b32 v46, 16, v247
    v_and_b32 v47, 0xffff0000, v247
    ds_read_b32 v0, v7 offset:40
    s_waitcnt lgkmcnt(0)
    v_cmp_ne_u32 vcc, 626944, v0
    s_nop 0
    s_cbranch_vccz L_eTP2_ok_88
L_eTP2_sl_89:
    s_sleep 8
    ds_read_b32 v0, v7 offset:40
    s_waitcnt lgkmcnt(0)
    v_cmp_ne_u32 vcc, 626944, v0
    s_nop 0
    s_cbranch_vccnz L_eTP2_sl_89
L_eTP2_ok_88:
    buffer_load_dword v8, v11, s[32:35], 0 offen sc1
    s_add_u32 m0, s55, 32768
    s_add_u32 s47, s65, 393216
    buffer_load_dwordx4 v9, s[24:27], s47 offen lds
    s_add_u32 m0, s55, 33792
    s_add_u32 s47, s65, 401408
    buffer_load_dwordx4 v9, s[24:27], s47 offen lds
    s_add_u32 m0, s55, 40960
    s_add_u32 s47, s65, 458752
    buffer_load_dwordx4 v9, s[24:27], s47 offen lds
    s_add_u32 m0, s55, 41984
    s_add_u32 s47, s65, 466944
    buffer_load_dwordx4 v9, s[24:27], s47 offen lds
    s_add_u32 m0, s55, 49152
    s_add_u32 s47, s65, 524288
    buffer_load_dwordx4 v9, s[24:27], s47 offen lds
    s_add_u32 m0, s55, 50176
    s_add_u32 s47, s65, 532480
    buffer_load_dwordx4 v9, s[24:27], s47 offen lds
    s_add_u32 m0, s55, 57344
    s_add_u32 s47, s65, 589824
    buffer_load_dwordx4 v9, s[24:27], s47 offen lds
    s_add_u32 m0, s55, 58368
    s_add_u32 s47, s65, 598016
    buffer_load_dwordx4 v9, s[24:27], s47 offen lds
    s_waitcnt vmcnt(8)
    v_cmp_ne_u32 vcc, s58, v8
    s_nop 0
    s_cbranch_vccz L_fb_ok_91
L_fb_sl_92:
    s_mov_b32 s62, 65536
    s_nop 15
L_fb_lp_93:
    s_sleep 8
    buffer_load_dword v8, v11, s[32:35], 0 offen sc1
    s_sub_u32 s62, s62, 1
    s_waitcnt vmcnt(0)
    s_cbranch_scc1 L_fb_ok_91
    v_cmp_ne_u32 vcc, s58, v8
    s_nop 0
    s_cbranch_vccnz L_fb_lp_93
L_fb_ok_91:
    buffer_load_dwordx4 v[64:67], v2, s[32:35], s57 offen offset:0 sc1
    buffer_load_dwordx4 v[68:71], v2, s[32:35], s57 offen offset:1024 sc1
    buffer_load_dwordx4 v[72:75], v2, s[32:35], s57 offen offset:2048 sc1
    buffer_load_dwordx4 v[76:79], v2, s[32:35], s57 offen offset:3072 sc1
    s_add_u32 s57, s57, 8192
    buffer_load_dwordx4 v[80:83], v2, s[32:35], s57 offen offset:0 sc1
    buffer_load_dwordx4 v[84:87], v2, s[32:35], s57 offen offset:1024 sc1
    buffer_load_dwordx4 v[88:91], v2, s[32:35], s57 offen offset:2048 sc1
    buffer_load_dwordx4 v[92:95], v2, s[32:35], s57 offen offset:3072 sc1
    s_add_u32 s57, s57, 8192
    buffer_load_dwordx4 v[96:99], v2, s[32:35], s57 offen offset:0 sc1
    buffer_load_dwordx4 v[100:103], v2, s[32:35], s57 offen offset:1024 sc1
    buffer_load_dwordx4 v[104:107], v2, s[32:35], s57 offen offset:2048 sc1
    buffer_load_dwordx4 v[108:111], v2, s[32:35], s57 offen offset:3072 sc1
    s_add_u32 s57, s57, 8192
    s_lshl_b32 s49, s49, 2
    s_lshl_b32 vcc_lo, 0x0f0f0f0f, s49
    s_mov_b32 vcc_hi, 0
    v_mov_b32 v8, 1073741824
    v_cndmask_b32 v11, v8, v11, vcc
    s_mov_b64 exec, 1
    ds_add_u32 v7, v7 offset:100
    s_mov_b64 exec, -1
    ds_read_b32 v0, v7 offset:100
    s_waitcnt lgkmcnt(0)
    v_cmp_ne_u32 vcc, 626944, v0
    s_nop 0
    s_cbranch_vccz L_eDE0_ok_94
L_eDE0_sl_95:
    s_sleep 1
    ds_read_b32 v0, v7 offset:100
    s_waitcnt lgkmcnt(0)
    v_cmp_ne_u32 vcc, 626944, v0
    s_nop 0
    s_cbranch_vccnz L_eDE0_sl_95
L_eDE0_ok_94:
    ds_read_b64_tr_b16 v[12:13], v5 offset:0
    ds_read_b64_tr_b16 v[14:15], v5 offset:1024
    ds_read_b64_tr_b16 v[16:17], v6 offset:0
    ds_read_b64_tr_b16 v[18:19], v6 offset:1024
    s_setprio 0
    s_waitcnt vmcnt(8)
    s_waitcnt lgkmcnt(0)
    v_mfma_f32_32x32x16_bf16 v[32:47], v[12:15], v[64:67], v[32:47]
    ds_read_b64_tr_b16 v[20:21], v5 offset:2048
    ds_read_b64_tr_b16 v[22:23], v5 offset:3072
    ds_read_b64_tr_b16 v[24:25], v6 offset:2048
    ds_read_b64_tr_b16 v[26:27], v6 offset:3072
    v_mfma_f32_32x32x16_bf16 v[48:63], v[16:19], v[64:67], 0
    buffer_load_dwordx4 v[112:115], v2, s[32:35], s57 offen offset:0 sc1
    buffer_load_dwordx4 v[116:119], v2, s[32:35], s57 offen offset:1024 sc1
    s_waitcnt lgkmcnt(0)
    v_mfma_f32_32x32x16_bf16 v[32:47], v[20:23], v[68:71], v[32:47]
    ds_read_b64_tr_b16 v[240:241], v5 offset:4096
    ds_read_b64_tr_b16 v[242:243], v5 offset:5120
    ds_read_b64_tr_b16 v[244:245], v6 offset:4096
    ds_read_b64_tr_b16 v[246:247], v6 offset:5120
    buffer_load_dwordx4 v[120:123], v2, s[32:35], s57 offen offset:2048 sc1
    buffer_load_dwordx4 v[124:127], v2, s[32:35], s57 offen offset:3072 sc1
    s_add_u32 s57, s57, 8192
    v_mfma_f32_32x32x16_bf16 v[48:63], v[24:27], v[68:71], v[48:63]
    s_waitcnt lgkmcnt(0)
    v_mfma_f32_32x32x16_bf16 v[32:47], v[240:243], v[72:75], v[32:47]
    ds_read_b64_tr_b16 v[248:249], v5 offset:6144
    ds_read_b64_tr_b16 v[250:251], v5 offset:7168
    ds_read_b64_tr_b16 v[252:253], v6 offset:6144
    ds_read_b64_tr_b16 v[254:255], v6 offset:7168
    v_mfma_f32_32x32x16_bf16 v[48:63], v[244:247], v[72:75], v[48:63]
    s_waitcnt lgkmcnt(0)
    v_mfma_f32_32x32x16_bf16 v[32:47], v[248:251], v[76:79], v[32:47]
    ds_read_b64_tr_b16 v[12:13], v3 offset:0
    ds_read_b64_tr_b16 v[14:15], v3 offset:1024
    ds_read_b64_tr_b16 v[16:17], v4 offset:0
    ds_read_b64_tr_b16 v[18:19], v4 offset:1024
    v_mfma_f32_32x32x16_bf16 v[48:63], v[252:255], v[76:79], v[48:63]
    s_waitcnt vmcnt(8)
    s_waitcnt lgkmcnt(0)
    v_mfma_f32_32x32x16_bf16 v[32:47], v[12:15], v[80:83], v[32:47]
    s_mov_b64 exec, 1
    ds_add_u32 v7, v7 offset:104
    s_mov_b64 exec, -1
    ds_read_b64_tr_b16 v[20:21], v3 offset:2048
    ds_read_b64_tr_b16 v[22:23], v3 offset:3072
    ds_read_b64_tr_b16 v[24:25], v4 offset:2048
    ds_read_b64_tr_b16 v[26:27], v4 offset:3072
    v_mfma_f32_32x32x16_bf16 v[48:63], v[16:19], v[80:83], v[48:63]
    buffer_load_dwordx4 v[128:131], v2, s[32:35], s57 offen offset:0 sc1
    buffer_load_dwordx4 v[132:135], v2, s[32:35], s57 offen offset:1024 sc1
    s_waitcnt lgkmcnt(0)
    v_mfma_f32_32x32x16_bf16 v[32:47], v[20:23], v[84:87], v[32:47]
    ds_read_b64_tr_b16 v[240:241], v3 offset:4096
    ds_read_b64_tr_b16 v[242:243], v3 offset:5120
    ds_read_b64_tr_b16 v[244:245], v4 offset:4096
    ds_read_b64_tr_b16 v[246:247], v4 offset:5120
    buffer_load_dwordx4 v[136:139], v2, s[32:35], s57 offen offset:2048 sc1
    buffer_load_dwordx4 v[140:143], v2, s[32:35], s57 offen offset:3072 sc1
    s_add_u32 s57, s57, 8192
    v_mfma_f32_32x32x16_bf16 v[48:63], v[24:27], v[84:87], v[48:63]
    s_waitcnt lgkmcnt(0)
    v_mfma_f32_32x32x16_bf16 v[32:47], v[240:243], v[88:91], v[32:47]
    ds_read_b32 v0, v7 offset:104
    ds_read_b64_tr_b16 v[248:249], v3 offset:6144
    ds_read_b64_tr_b16 v[250:251], v3 offset:7168
    ds_read_b64_tr_b16 v[252:253], v4 offset:6144
    ds_read_b64_tr_b16 v[254:255], v4 offset:7168
    v_mfma_f32_32x32x16_bf16 v[48:63], v[244:247], v[88:91], v[48:63]
    s_waitcnt lgkmcnt(0)
    v_mfma_f32_32x32x16_bf16 v[32:47], v[248:251], v[92:95], v[32:47]
    s_setprio 2
    v_cmp_ne_u32 vcc, 626944, v0
    s_setprio 0
    s_cbranch_vccz L_eDE1_ok_97
L_eDE1_sl_98:
    s_sleep 1
    ds_read_b32 v0, v7 offset:104
    s_waitcnt lgkmcnt(0)
    s_setprio 2
    v_cmp_ne_u32 vcc, 626944, v0
    s_setprio 0
    s_cbranch_vccnz L_eDE1_sl_98
L_eDE1_ok_97:
    ds_read_b64_tr_b16 v[12:13], v3 offset:16384
    ds_read_b64_tr_b16 v[14:15], v3 offset:17408
    ds_read_b64_tr_b16 v[16:17], v4 offset:16384
    ds_read_b64_tr_b16 v[18:19], v4 offset:17408
    s_add_u32 m0, s55, 132096
    s_add_u32 s47, s65, 655360
    buffer_load_dwordx4 v9, s[24:27], s47 offen lds
    s_add_u32 m0, s55, 133120
    s_add_u32 s47, s65, 663552
    buffer_load_dwordx4 v9, s[24:27], s47 offen lds
    v_mfma_f32_32x32x16_bf16 v[48:63], v[252:255], v[92:95], v[48:63]
    s_add_u32 m0, s55, 140288
    s_add_u32 s47, s65, 720896
    buffer_load_dwordx4 v9, s[24:27], s47 offen lds
    s_add_u32 m0, s55, 141312
    s_add_u32 s47, s65, 729088
    buffer_load_dwordx4 v9, s[24:27], s47 offen lds
    s_waitcnt vmcnt(12)
    s_waitcnt lgkmcnt(0)
    v_mfma_f32_32x32x16_bf16 v[32:47], v[12:15], v[96:99], v[32:47]
    s_mov_b64 exec, 1
    ds_add_u32 v7, v7 offset:108
    s_mov_b64 exec, -1
    ds_read_b64_tr_b16 v[20:21], v3 offset:18432
    ds_read_b64_tr_b16 v[22:23], v3 offset:19456
    ds_read_b64_tr_b16 v[24:25], v4 offset:18432
    ds_read_b64_tr_b16 v[26:27], v4 offset:19456
    v_mfma_f32_32x32x16_bf16 v[48:63], v[16:19], v[96:99], v[48:63]
    buffer_load_dwordx4 v[144:147], v2, s[32:35], s57 offen offset:0 sc1
    buffer_load_dwordx4 v[148:151], v2, s[32:35], s57 offen offset:1024 sc1
    s_waitcnt lgkmcnt(0)
    v_mfma_f32_32x32x16_bf16 v[32:47], v[20:23], v[100:103], v[32:47]
    ds_read_b64_tr_b16 v[240:241], v3 offset:20480
    ds_read_b64_tr_b16 v[242:243], v3 offset:21504
    ds_read_b64_tr_b16 v[244:245], v4 offset:20480
    ds_read_b64_tr_b16 v[246:247], v4 offset:21504
    buffer_load_dwordx4 v[152:155], v2, s[32:35], s57 offen offset:2048 sc1
    buffer_load_dwordx4 v[156:159], v2, s[32:35], s57 offen offset:3072 sc1
    s_add_u32 s57, s57, 8192
    v_mfma_f32_32x32x16_bf16 v[48:63], v[24:27], v[100:103], v[48:63]
    s_waitcnt lgkmcnt(0)
    v_mfma_f32_32x32x16_bf16 v[32:47], v[240:243], v[104:107], v[32:47]
    ds_read_b32 v0, v7 offset:108
    ds_read_b64_tr_b16 v[248:249], v3 offset:22528
    ds_read_b64_tr_b16 v[250:251], v3 offset:23552
    ds_read_b64_tr_b16 v[252:253], v4 offset:22528
    ds_read_b64_tr_b16 v[254:255], v4 offset:23552
    v_mfma_f32_32x32x16_bf16 v[48:63], v[244:247], v[104:107], v[48:63]
    s_waitcnt lgkmcnt(0)
    v_mfma_f32_32x32x16_bf16 v[32:47], v[248:251], v[108:111], v[32:47]
    s_setprio 2
    v_cmp_ne_u32 vcc, 626944, v0
    s_setprio 0
    s_cbranch_vccz L_eDE2_ok_100
L_eDE2_sl_101:
    s_sleep 1
    ds_read_b32 v0, v7 offset:108
    s_waitcnt lgkmcnt(0)
    s_setprio 2
    v_cmp_ne_u32 vcc, 626944, v0
    s_setprio 0
    s_cbranch_vccnz L_eDE2_sl_101
L_eDE2_ok_100:
    ds_read_b64_tr_b16 v[12:13], v3 offset:32768
    ds_read_b64_tr_b16 v[14:15], v3 offset:33792
    ds_read_b64_tr_b16 v[16:17], v4 offset:32768
    ds_read_b64_tr_b16 v[18:19], v4 offset:33792
    s_add_u32 m0, s55, 0
    s_add_u32 s47, s65, 786432
    buffer_load_dwordx4 v9, s[24:27], s47 offen lds
    s_add_u32 m0, s55, 1024
    s_add_u32 s47, s65, 794624
    buffer_load_dwordx4 v9, s[24:27], s47 offen lds
    v_mfma_f32_32x32x16_bf16 v[48:63], v[252:255], v[108:111], v[48:63]
    s_add_u32 m0, s55, 8192
    s_add_u32 s47, s65, 851968
    buffer_load_dwordx4 v9, s[24:27], s47 offen lds
    s_add_u32 m0, s55, 9216
    s_add_u32 s47, s65, 860160
    buffer_load_dwordx4 v9, s[24:27], s47 offen lds
    s_waitcnt vmcnt(16)
    s_waitcnt lgkmcnt(0)
    v_mfma_f32_32x32x16_bf16 v[32:47], v[12:15], v[112:115], v[32:47]
    s_mov_b64 exec, 1
    ds_add_u32 v7, v7 offset:112
    s_mov_b64 exec, -1
    ds_read_b64_tr_b16 v[20:21], v3 offset:34816
    ds_read_b64_tr_b16 v[22:23], v3 offset:35840
    ds_read_b64_tr_b16 v[24:25], v4 offset:34816
    ds_read_b64_tr_b16 v[26:27], v4 offset:35840
    v_mfma_f32_32x32x16_bf16 v[48:63], v[16:19], v[112:115], v[48:63]
    buffer_load_dwordx4 v[160:163], v2, s[32:35], s57 offen offset:0 sc1
    buffer_load_dwordx4 v[164:167], v2, s[32:35], s57 offen offset:1024 sc1
    s_waitcnt lgkmcnt(0)
    v_mfma_f32_32x32x16_bf16 v[32:47], v[20:23], v[116:119], v[32:47]
    ds_read_b64_tr_b16 v[240:241], v3 offset:36864
    ds_read_b64_tr_b16 v[242:243], v3 offset:37888
    ds_read_b64_tr_b16 v[244:245], v4 offset:36864
    ds_read_b64_tr_b16 v[246:247], v4 offset:37888
    buffer_load_dwordx4 v[168:171], v2, s[32:35], s57 offen offset:2048 sc1
    buffer_load_dwordx4 v[172:175], v2, s[32:35], s57 offen offset:3072 sc1
    s_add_u32 s57, s57, 8192
    v_mfma_f32_32x32x16_bf16 v[48:63], v[24:27], v[116:119], v[48:63]
    s_waitcnt lgkmcnt(0)
    v_mfma_f32_32x32x16_bf16 v[32:47], v[240:243], v[120:123], v[32:47]
    ds_read_b32 v0, v7 offset:112
    ds_read_b64_tr_b16 v[248:249], v3 offset:38912
    ds_read_b64_tr_b16 v[250:251], v3 offset:39936
    ds_read_b64_tr_b16 v[252:253], v4 offset:38912
    ds_read_b64_tr_b16 v[254:255], v4 offset:39936
    v_mfma_f32_32x32x16_bf16 v[48:63], v[244:247], v[120:123], v[48:63]
    s_waitcnt lgkmcnt(0)
    v_mfma_f32_32x32x16_bf16 v[32:47], v[248:251], v[124:127], v[32:47]
    s_setprio 2
    v_cmp_ne_u32 vcc, 626944, v0
    s_setprio 0
    s_cbranch_vccz L_eDE3_ok_103
L_eDE3_sl_104:
    s_sleep 1
    ds_read_b32 v0, v7 offset:112
    s_waitcnt lgkmcnt(0)
    s_setprio 2
    v_cmp_ne_u32 vcc, 626944, v0
    s_setprio 0
    s_cbranch_vccnz L_eDE3_sl_104
L_eDE3_ok_103:
    ds_read_b64_tr_b16 v[12:13], v3 offset:49152
    ds_read_b64_tr_b16 v[14:15], v3 offset:50176
    ds_read_b64_tr_b16 v[16:17], v4 offset:49152
    ds_read_b64_tr_b16 v[18:19], v4 offset:50176
    s_add_u32 m0, s55, 16384
    s_add_u32 s47, s65, 917504
    buffer_load_dwordx4 v9, s[24:27], s47 offen lds
    s_add_u32 m0, s55, 17408
    s_add_u32 s47, s65, 925696
    buffer_load_dwordx4 v9, s[24:27], s47 offen lds
    v_mfma_f32_32x32x16_bf16 v[48:63], v[252:255], v[124:127], v[48:63]
    s_add_u32 m0, s55, 24576
    s_add_u32 s47, s65, 983040
    buffer_load_dwordx4 v9, s[24:27], s47 offen lds
    s_add_u32 m0, s55, 25600
    s_add_u32 s47, s65, 991232
    buffer_load_dwordx4 v9, s[24:27], s47 offen lds
    s_waitcnt vmcnt(20)
    s_waitcnt lgkmcnt(0)
    v_mfma_f32_32x32x16_bf16 v[32:47], v[12:15], v[128:131], v[32:47]
    s_waitcnt vmcnt(16)
    s_mov_b64 exec, 1
    ds_add_u32 v7, v7 offset:116
    s_mov_b64 exec, -1
    ds_read_b64_tr_b16 v[20:21], v3 offset:51200
    ds_read_b64_tr_b16 v[22:23], v3 offset:52224
    ds_read_b64_tr_b16 v[24:25], v4 offset:51200
    ds_read_b64_tr_b16 v[26:27], v4 offset:52224
    v_mfma_f32_32x32x16_bf16 v[48:63], v[16:19], v[128:131], v[48:63]
    buffer_load_dwordx4 v[176:179], v2, s[32:35], s57 offen offset:0 sc1
    buffer_load_dwordx4 v[180:183], v2, s[32:35], s57 offen offset:1024 sc1
    s_waitcnt lgkmcnt(0)
    v_mfma_f32_32x32x16_bf16 v[32:47], v[20:23], v[132:135], v[32:47]
    ds_read_b64_tr_b16 v[240:241], v3 offset:53248
    ds_read_b64_tr_b16 v[242:243], v3 offset:54272
    ds_read_b64_tr_b16 v[244:245], v4 offset:53248
    ds_read_b64_tr_b16 v[246:247], v4 offset:54272
    buffer_load_dwordx4 v[184:187], v2, s[32:35], s57 offen offset:2048 sc1
    buffer_load_dwordx4 v[188:191], v2, s[32:35], s57 offen offset:3072 sc1
    s_add_u32 s57, s57, 8192
    v_mfma_f32_32x32x16_bf16 v[48:63], v[24:27], v[132:135], v[48:63]
    s_waitcnt lgkmcnt(0)
    v_mfma_f32_32x32x16_bf16 v[32:47], v[240:243], v[136:139], v[32:47]
    ds_read_b32 v0, v7 offset:116
    ds_read_b64_tr_b16 v[248:249], v3 offset:55296
    ds_read_b64_tr_b16 v[250:251], v3 offset:56320
    ds_read_b64_tr_b16 v[252:253], v4 offset:55296
    ds_read_b64_tr_b16 v[254:255], v4 offset:56320
    v_mfma_f32_32x32x16_bf16 v[48:63], v[244:247], v[136:139], v[48:63]
    s_waitcnt lgkmcnt(0)
    v_mfma_f32_32x32x16_bf16 v[32:47], v[248:251], v[140:143], v[32:47]
    s_setprio 2
    v_cmp_ne_u32 vcc, 626944, v0
    s_setprio 0
    s_cbranch_vccz L_eDE4_ok_106
L_eDE4_sl_107:
    s_sleep 1
    ds_read_b32 v0, v7 offset:116
    s_waitcnt lgkmcnt(0)
    s_setprio 2
    v_cmp_ne_u32 vcc, 626944, v0
    s_setprio 0
    s_cbranch_vccnz L_eDE4_sl_107
L_eDE4_ok_106:
    s_add_u32 m0, s55, 32768
    s_add_u32 s47, s65, 1048576
    buffer_load_dwordx4 v9, s[24:27], s47 offen lds
    s_add_u32 m0, s55, 33792
    s_add_u32 s47, s65, 1056768
    buffer_load_dwordx4 v9, s[24:27], s47 offen lds
    s_add_u32 m0, s55, 40960
    s_add_u32 s47, s65, 1114112
    buffer_load_dwordx4 v9, s[24:27], s47 offen lds
    s_add_u32 m0, s55, 41984
    s_add_u32 s47, s65, 1122304
    buffer_load_dwordx4 v9, s[24:27], s47 offen lds
    s_setprio 2
    ds_read_b32 v0, v7 offset:48
    s_waitcnt lgkmcnt(0)
    v_cmp_ne_u32 vcc, 626944, v0
    s_nop 0
    s_cbranch_vccz L_eTPD_ok_109
L_eTPD_sl_110:
    s_sleep 8
    ds_read_b32 v0, v7 offset:48
    s_waitcnt lgkmcnt(0)
    v_cmp_ne_u32 vcc, 626944, v0
    s_nop 0
    s_cbranch_vccnz L_eTPD_sl_110
L_eTPD_ok_109:
    s_setprio 0
    ds_read_b64_tr_b16 v[12:13], v5 offset:0
    ds_read_b64_tr_b16 v[14:15], v5 offset:1024
    ds_read_b64_tr_b16 v[16:17], v6 offset:0
    ds_read_b64_tr_b16 v[18:19], v6 offset:1024
    s_add_u32 m0, s55, 66048
    s_add_u32 s47, s65, 1179648
    buffer_load_dwordx4 v9, s[24:27], s47 offen lds
    s_add_u32 m0, s55, 67072
    s_add_u32 s47, s65, 1187840
    buffer_load_dwordx4 v9, s[24:27], s47 offen lds
    v_mfma_f32_32x32x16_bf16 v[48:63], v[252:255], v[140:143], v[48:63]
    s_add_u32 m0, s55, 74240
    s_add_u32 s47, s65, 1245184
    buffer_load_dwordx4 v9, s[24:27], s47 offen lds
    s_add_u32 m0, s55, 75264
    s_add_u32 s47, s65, 1253376
    buffer_load_dwordx4 v9, s[24:27], s47 offen lds
    s_waitcnt vmcnt(24)
    s_waitcnt lgkmcnt(0)
    v_mfma_f32_32x32x16_bf16 v[32:47], v[12:15], v[144:147], v[32:47]
    s_add_u32 m0, s55, 82432
    s_add_u32 s47, s65, 1310720
    buffer_load_dwordx4 v9, s[24:27], s47 offen lds
    s_add_u32 m0, s55, 83456
    s_add_u32 s47, s65, 1318912
    buffer_load_dwordx4 v9, s[24:27], s47 offen lds
    s_add_u32 m0, s55, 90624
    s_add_u32 s47, s65, 1376256
    buffer_load_dwordx4 v9, s[24:27], s47 offen lds
    s_add_u32 m0, s55, 91648
    s_add_u32 s47, s65, 1384448
    buffer_load_dwordx4 v9, s[24:27], s47 offen lds
    s_waitcnt vmcnt(24)
    s_mov_b64 exec, 1
    ds_add_u32 v7, v7 offset:120
    s_mov_b64 exec, -1
    ds_read_b64_tr_b16 v[20:21], v5 offset:2048
    ds_read_b64_tr_b16 v[22:23], v5 offset:3072
    ds_read_b64_tr_b16 v[24:25], v6 offset:2048
    ds_read_b64_tr_b16 v[26:27], v6 offset:3072
    v_mfma_f32_32x32x16_bf16 v[48:63], v[16:19], v[144:147], v[48:63]
    buffer_load_dwordx4 v[192:195], v2, s[32:35], s57 offen offset:0 sc1
    buffer_load_dwordx4 v[196:199], v2, s[32:35], s57 offen offset:1024 sc1
    s_waitcnt lgkmcnt(0)
    v_mfma_f32_32x32x16_bf16 v[32:47], v[20:23], v[148:151], v[32:47]
    ds_read_b64_tr_b16 v[240:241], v5 offset:4096
    ds_read_b64_tr_b16 v[242:243], v5 offset:5120
    ds_read_b64_tr_b16 v[244:245], v6 offset:4096
    ds_read_b64_tr_b16 v[246:247], v6 offset:5120
    buffer_load_dwordx4 v[200:203], v2, s[32:35], s57 offen offset:2048 sc1
    buffer_load_dwordx4 v[204:207], v2, s[32:35], s57 offen offset:3072 sc1
    s_add_u32 s57, s57, 8192
    v_mfma_f32_32x32x16_bf16 v[48:63], v[24:27], v[148:151], v[48:63]
    s_waitcnt lgkmcnt(0)
    v_mfma_f32_32x32x16_bf16 v[32:47], v[240:243], v[152:155], v[32:47]
    ds_read_b32 v0, v7 offset:120
    ds_read_b64_tr_b16 v[248:249], v5 offset:6144
    ds_read_b64_tr_b16 v[250:251], v5 offset:7168
    ds_read_b64_tr_b16 v[252:253], v6 offset:6144
    ds_read_b64_tr_b16 v[254:255], v6 offset:7168
    v_mfma_f32_32x32x16_bf16 v[48:63], v[244:247], v[152:155], v[48:63]
    s_waitcnt lgkmcnt(0)
    v_mfma_f32_32x32x16_bf16 v[32:47], v[248:251], v[156:159], v[32:47]
    s_setprio 2
    v_cmp_ne_u32 vcc, 626944, v0
    s_setprio 0
    s_cbranch_vccz L_eDE5_ok_112
L_eDE5_sl_113:
    s_sleep 1
    ds_read_b32 v0, v7 offset:120
    s_waitcnt lgkmcnt(0)
    s_setprio 2
    v_cmp_ne_u32 vcc, 626944, v0
    s_setprio 0
    s_cbranch_vccnz L_eDE5_sl_113
L_eDE5_ok_112:
    ds_read_b64_tr_b16 v[12:13], v3 offset:0
    ds_read_b64_tr_b16 v[14:15], v3 offset:1024
    ds_read_b64_tr_b16 v[16:17], v4 offset:0
    ds_read_b64_tr_b16 v[18:19], v4 offset:1024
    s_add_u32 m0, s55, 49152
    s_add_u32 s47, s65, 0
    buffer_load_dwordx4 v9, s[28:31], s47 offen lds
    s_add_u32 m0, s55, 50176
    s_add_u32 s47, s65, 8192
    buffer_load_dwordx4 v9, s[28:31], s47 offen lds
    v_mfma_f32_32x32x16_bf16 v[48:63], v[252:255], v[156:159], v[48:63]
    s_add_u32 m0, s55, 57344
    s_add_u32 s47, s65, 65536
    buffer_load_dwordx4 v9, s[28:31], s47 offen lds
    s_add_u32 m0, s55, 58368
    s_add_u32 s47, s65, 73728
    buffer_load_dwordx4 v9, s[28:31], s47 offen lds
    s_waitcnt vmcnt(28)
    s_waitcnt lgkmcnt(0)
    v_mfma_f32_32x32x16_bf16 v[32:47], v[12:15], v[160:163], v[32:47]
    s_waitcnt vmcnt(24)
    s_mov_b64 exec, 1
    ds_add_u32 v7, v7 offset:124
    s_mov_b64 exec, -1
    ds_read_b64_tr_b16 v[20:21], v3 offset:2048
    ds_read_b64_tr_b16 v[22:23], v3 offset:3072
    ds_read_b64_tr_b16 v[24:25], v4 offset:2048
    ds_read_b64_tr_b16 v[26:27], v4 offset:3072
    v_mfma_f32_32x32x16_bf16 v[48:63], v[16:19], v[160:163], v[48:63]
    buffer_load_dwordx4 v[208:211], v2, s[32:35], s57 offen offset:0 sc1
    buffer_load_dwordx4 v[212:215], v2, s[32:35], s57 offen offset:1024 sc1
    s_waitcnt lgkmcnt(0)
    v_mfma_f32_32x32x16_bf16 v[32:47], v[20:23], v[164:167], v[32:47]
    ds_read_b64_tr_b16 v[240:241], v3 offset:4096
    ds_read_b64_tr_b16 v[242:243], v3 offset:5120
    ds_read_b64_tr_b16 v[244:245], v4 offset:4096
    ds_read_b64_tr_b16 v[246:247], v4 offset:5120
    buffer_load_dwordx4 v[216:219], v2, s[32:35], s57 offen offset:2048 sc1
    buffer_load_dwordx4 v[220:223], v2, s[32:35], s57 offen offset:3072 sc1
    s_add_u32 s57, s57, 8192
    v_mfma_f32_32x32x16_bf16 v[48:63], v[24:27], v[164:167], v[48:63]
    s_waitcnt lgkmcnt(0)
    v_mfma_f32_32x32x16_bf16 v[32:47], v[240:243], v[168:171], v[32:47]
    ds_read_b32 v0, v7 offset:124
    ds_read_b64_tr_b16 v[248:249], v3 offset:6144
    ds_read_b64_tr_b16 v[250:251], v3 offset:7168
    ds_read_b64_tr_b16 v[252:253], v4 offset:6144
    ds_read_b64_tr_b16 v[254:255], v4 offset:7168
    v_mfma_f32_32x32x16_bf16 v[48:63], v[244:247], v[168:171], v[48:63]
    s_waitcnt lgkmcnt(0)
    v_mfma_f32_32x32x16_bf16 v[32:47], v[248:251], v[172:175], v[32:47]
    s_setprio 2
    v_cmp_ne_u32 vcc, 626944, v0
    s_setprio 0
    s_cbranch_vccz L_eDE6_ok_115
L_eDE6_sl_116:
    s_sleep 1
    ds_read_b32 v0, v7 offset:124
    s_waitcnt lgkmcnt(0)
    s_setprio 2
    v_cmp_ne_u32 vcc, 626944, v0
    s_setprio 0
    s_cbranch_vccnz L_eDE6_sl_116
L_eDE6_ok_115:
    ds_read_b64_tr_b16 v[12:13], v3 offset:16384
    ds_read_b64_tr_b16 v[14:15], v3 offset:17408
    ds_read_b64_tr_b16 v[16:17], v4 offset:16384
    ds_read_b64_tr_b16 v[18:19], v4 offset:17408
    s_add_u32 m0, s55, 132096
    s_add_u32 s47, s65, 131072
    buffer_load_dwordx4 v9, s[28:31], s47 offen lds
    s_add_u32 m0, s55, 133120
    s_add_u32 s47, s65, 139264
    buffer_load_dwordx4 v9, s[28:31], s47 offen lds
    v_mfma_f32_32x32x16_bf16 v[48:63], v[252:255], v[172:175], v[48:63]
    s_add_u32 m0, s55, 140288
    s_add_u32 s47, s65, 196608
    buffer_load_dwordx4 v9, s[28:31], s47 offen lds
    s_add_u32 m0, s55, 141312
    s_add_u32 s47, s65, 204800
    buffer_load_dwordx4 v9, s[28:31], s47 offen lds
    s_setprio 2
    buffer_load_dwordx4 v[224:227], v2, s[32:35], s57 offen offset:0 sc1
    buffer_load_dwordx4 v[228:231], v2, s[32:35], s57 offen offset:1024 sc1
    s_cmp_eq_u32 s49, 0
    s_cselect_b32 s57, s57, 1073741824
    buffer_load_dwordx4 v[232:235], v2, s[32:35], s57 offen offset:2048 sc1
    buffer_load_dwordx4 v[236:239], v2, s[32:35], s57 offen offset:3072 sc1
    s_waitcnt vmcnt(12)
    s_mov_b64 exec, 1
    ds_add_u32 v7, v7 offset:128
    s_mov_b64 exec, -1
    s_lshl_b32 s47, s45, 12
    v_add_u32 v30, s47, v2
    v_xor_b32 v31, 4096, v30
    v_add_u32 v30, 16384, v30
    v_add_u32 v31, 16384, v31
    s_and_b32 s47, s45, 2
    s_lshl_b32 s47, s47, 1
    v_add_u32 v1, s47, v7
    s_mov_b32 s48, 524288
    s_mov_b32 s67, 0
    s_mov_b32 s51, 0
    ds_read_b32 v0, v7 offset:128
    s_waitcnt lgkmcnt(0)
    v_cmp_ne_u32 vcc, 626944, v0
    s_nop 0
    s_cbranch_vccz L_eDE7_ok_118
L_eDE7_sl_119:
    s_sleep 1
    ds_read_b32 v0, v7 offset:128
    s_waitcnt lgkmcnt(0)
    v_cmp_ne_u32 vcc, 626944, v0
    s_nop 0
    s_cbranch_vccnz L_eDE7_sl_119
L_eDE7_ok_118:
    ds_read_b32 v0, v7 offset:52
    s_add_u32 m0, s55, 0
    s_add_u32 s47, s65, 262144
    buffer_load_dwordx4 v9, s[28:31], s47 offen lds
    s_add_u32 m0, s55, 1024
    s_add_u32 s47, s65, 270336
    buffer_load_dwordx4 v9, s[28:31], s47 offen lds
    s_add_u32 m0, s55, 8192
    s_add_u32 s47, s65, 327680
    buffer_load_dwordx4 v9, s[28:31], s47 offen lds
    s_add_u32 m0, s55, 9216
    s_add_u32 s47, s65, 335872
    buffer_load_dwordx4 v9, s[28:31], s47 offen lds
    s_waitcnt lgkmcnt(0)
    v_cmp_ne_u32 vcc, 626944, v0
    s_nop 0
    s_cbranch_vccz L_eTP5_ok_121
L_eTP5_sl_122:
    s_sleep 8
    ds_read_b32 v0, v7 offset:52
    s_waitcnt lgkmcnt(0)
    v_cmp_ne_u32 vcc, 626944, v0
    s_nop 0
    s_cbranch_vccnz L_eTP5_sl_122
L_eTP5_ok_121:
    s_add_u32 m0, s55, 99072
    s_add_u32 s47, s65, 393216
    buffer_load_dwordx4 v9, s[28:31], s47 offen lds
    s_add_u32 m0, s55, 100096
    s_add_u32 s47, s65, 401408
    buffer_load_dwordx4 v9, s[28:31], s47 offen lds
    s_add_u32 m0, s55, 107264
    s_add_u32 s47, s65, 458752
    buffer_load_dwordx4 v9, s[28:31], s47 offen lds
    s_add_u32 m0, s55, 108288
    s_add_u32 s47, s65, 466944
    buffer_load_dwordx4 v9, s[28:31], s47 offen lds
    ds_read_b64_tr_b16 v[20:21], v3 offset:18432
    ds_read_b64_tr_b16 v[22:23], v3 offset:19456
    ds_read_b64_tr_b16 v[24:25], v4 offset:18432
    ds_read_b64_tr_b16 v[26:27], v4 offset:19456
    ds_read_b64_tr_b16 v[128:129], v3 offset:49152
    ds_read_b64_tr_b16 v[130:131], v3 offset:50176
    ds_read_b64_tr_b16 v[132:133], v4 offset:49152
    ds_read_b64_tr_b16 v[134:135], v4 offset:50176
    ds_read_b64_tr_b16 v[136:137], v3 offset:51200
    ds_read_b64_tr_b16 v[138:139], v3 offset:52224
    ds_read_b64_tr_b16 v[140:141], v4 offset:51200
    ds_read_b64_tr_b16 v[142:143], v4 offset:52224
    ds_read_b64_tr_b16 v[144:145], v3 offset:53248
    ds_read_b64_tr_b16 v[146:147], v3 offset:54272
    ds_read_b64_tr_b16 v[148:149], v4 offset:53248
    ds_read_b64_tr_b16 v[150:151], v4 offset:54272
    ds_read_b64_tr_b16 v[152:153], v3 offset:55296
    ds_read_b64_tr_b16 v[154:155], v3 offset:56320
    ds_read_b64_tr_b16 v[156:157], v4 offset:55296
    ds_read_b64_tr_b16 v[158:159], v4 offset:56320
    ds_read_b32 v0, v7 offset:44
    s_lshl2_add_u32 s50, s61, s45
    s_lshl_b32 s50, s50, 6
    s_add_u32 s50, s50, s60
    s_lshl_b32 s50, s50, 7
    s_add_u32 s50, s50, 15011840
    v_mov_b32 v64, s58
    s_waitcnt lgkmcnt(0)
    v_cmp_ne_u32 vcc, 626944, v0
    s_nop 0
    s_cbranch_vccz L_eTP3_ok_124
L_eTP3_sl_125:
    s_sleep 2
    ds_read_b32 v0, v7 offset:44
    s_waitcnt lgkmcnt(0)
    v_cmp_ne_u32 vcc, 626944, v0
    s_nop 0
    s_cbranch_vccnz L_eTP3_sl_125
L_eTP3_ok_124:
    buffer_load_dword v8, v11, s[32:35], s48 offen sc1
    s_mov_b64 exec, 1
    buffer_store_dword v64, off, s[32:35], s50 sc1
    s_mov_b64 exec, -1
    s_setprio 0
    v_mfma_f32_32x32x16_bf16 v[32:47], v[12:15], v[176:179], v[32:47]
    ds_read_b64_tr_b16 v[240:241], v3 offset:20480
    ds_read_b64_tr_b16 v[242:243], v3 offset:21504
    ds_read_b64_tr_b16 v[244:245], v4 offset:20480
    ds_read_b64_tr_b16 v[246:247], v4 offset:21504
    v_mfma_f32_32x32x16_bf16 v[48:63], v[16:19], v[176:179], v[48:63]
    v_mfma_f32_32x32x16_bf16 v[32:47], v[20:23], v[180:183], v[32:47]
    ds_read_b64_tr_b16 v[248:249], v3 offset:22528
    ds_read_b64_tr_b16 v[250:251], v3 offset:23552
    ds_read_b64_tr_b16 v[252:253], v4 offset:22528
    ds_read_b64_tr_b16 v[254:255], v4 offset:23552
    v_mfma_f32_32x32x16_bf16 v[48:63], v[24:27], v[180:183], v[48:63]
    s_waitcnt lgkmcnt(4)
    v_mfma_f32_32x32x16_bf16 v[32:47], v[240:243], v[184:187], v[32:47]
    ds_read_b64_tr_b16 v[12:13], v3 offset:32768
    ds_read_b64_tr_b16 v[14:15], v3 offset:33792
    ds_read_b64_tr_b16 v[16:17], v4 offset:32768
    ds_read_b64_tr_b16 v[18:19], v4 offset:33792
    v_mfma_f32_32x32x16_bf16 v[48:63], v[244:247], v[184:187], v[48:63]
    s_waitcnt lgkmcnt(4)
    v_mfma_f32_32x32x16_bf16 v[32:47], v[248:251], v[188:191], v[32:47]
    ds_read_b64_tr_b16 v[20:21], v3 offset:34816
    ds_read_b64_tr_b16 v[22:23], v3 offset:35840
    ds_read_b64_tr_b16 v[24:25], v4 offset:34816
    ds_read_b64_tr_b16 v[26:27], v4 offset:35840
    v_mfma_f32_32x32x16_bf16 v[48:63], v[252:255], v[188:191], v[48:63]
    s_waitcnt lgkmcnt(4)
    v_mfma_f32_32x32x16_bf16 v[32:47], v[12:15], v[192:195], v[32:47]
    ds_read_b64_tr_b16 v[240:241], v3 offset:36864
    ds_read_b64_tr_b16 v[242:243], v3 offset:37888
    ds_read_b64_tr_b16 v[244:245], v4 offset:36864
    ds_read_b64_tr_b16 v[246:247], v4 offset:37888
    v_mfma_f32_32x32x16_bf16 v[48:63], v[16:19], v[192:195], v[48:63]
    s_waitcnt lgkmcnt(4)
    v_mfma_f32_32x32x16_bf16 v[32:47], v[20:23], v[196:199], v[32:47]
    ds_read_b64_tr_b16 v[248:249], v3 offset:38912
    ds_read_b64_tr_b16 v[250:251], v3 offset:39936
    ds_read_b64_tr_b16 v[252:253], v4 offset:38912
    ds_read_b64_tr_b16 v[254:255], v4 offset:39936
    v_mfma_f32_32x32x16_bf16 v[48:63], v[24:27], v[196:199], v[48:63]
    s_waitcnt lgkmcnt(4)
    v_mfma_f32_32x32x16_bf16 v[32:47], v[240:243], v[200:203], v[32:47]
    ds_read_b64_tr_b16 v[12:13], v28 offset:0
    ds_read_b64_tr_b16 v[14:15], v28 offset:1024
    ds_read_b64_tr_b16 v[16:17], v29 offset:0
    ds_read_b64_tr_b16 v[18:19], v29 offset:1024
    v_mfma_f32_32x32x16_bf16 v[48:63], v[244:247], v[200:203], v[48:63]
    s_waitcnt lgkmcnt(4)
    v_mfma_f32_32x32x16_bf16 v[32:47], v[248:251], v[204:207], v[32:47]
    ds_read_b64_tr_b16 v[20:21], v28 offset:2048
    ds_read_b64_tr_b16 v[22:23], v28 offset:3072
    ds_read_b64_tr_b16 v[24:25], v29 offset:2048
    ds_read_b64_tr_b16 v[26:27], v29 offset:3072
    v_mfma_f32_32x32x16_bf16 v[48:63], v[252:255], v[204:207], v[48:63]
    s_waitcnt vmcnt(18)
    s_waitcnt lgkmcnt(4)
    v_mfma_f32_32x32x16_bf16 v[32:47], v[12:15], v[208:211], v[32:47]
    s_waitcnt vmcnt(14)
    s_waitcnt vmcnt(6)
    s_waitcnt vmcnt(2)
    s_mov_b64 exec, 1
    ds_add_u32 v7, v7 offset:136
    s_mov_b64 exec, -1
    s_waitcnt vmcnt(1)
    v_cmp_eq_u32 vcc, s58, v8
    ds_read_b64_tr_b16 v[240:241], v28 offset:4096
    ds_read_b64_tr_b16 v[242:243], v28 offset:5120
    ds_read_b64_tr_b16 v[244:245], v29 offset:4096
    ds_read_b64_tr_b16 v[246:247], v29 offset:5120
    v_mfma_f32_32x32x16_bf16 v[48:63], v[16:19], v[208:211], v[48:63]
    s_lshr_b32 s47, vcc_lo, s49
    s_lshr_b32 s51, s47, 1
    s_and_b32 s51, s51, s47
    s_lshr_b32 s47, s51, 2
    s_and_b32 s51, s51, s47
    s_and_b32 s51, s51, 0x01010101
    s_add_u32 s47, s66, 0
    s_bitcmp0_b32 s51, 0
    s_cbranch_scc1 L_os_127
    buffer_load_dwordx4 v[64:67], v2, s[32:35], s47 offen offset:0 sc1
    buffer_load_dwordx4 v[68:71], v2, s[32:35], s47 offen offset:1024 sc1
L_os_127:
    s_waitcnt lgkmcnt(5)
    v_mfma_f32_32x32x16_bf16 v[32:47], v[20:23], v[212:215], v[32:47]
    ds_read_b64_tr_b16 v[248:249], v28 offset:6144
    ds_read_b64_tr_b16 v[250:251], v28 offset:7168
    ds_read_b64_tr_b16 v[252:253], v29 offset:6144
    ds_read_b64_tr_b16 v[254:255], v29 offset:7168
    v_mfma_f32_32x32x16_bf16 v[48:63], v[24:27], v[212:215], v[48:63]
    ds_read_b32 v0, v7 offset:136
    s_add_u32 s47, s66, 0
    s_bitcmp0_b32 s51, 0
    s_cbranch_scc1 L_os_128
    buffer_load_dwordx4 v[72:75], v2, s[32:35], s47 offen offset:2048 sc1
    buffer_load_dwordx4 v[76:79], v2, s[32:35], s47 offen offset:3072 sc1
L_os_128:
    s_waitcnt lgkmcnt(5)
    v_mfma_f32_32x32x16_bf16 v[32:47], v[240:243], v[216:219], v[32:47]
    ds_read_b64_tr_b16 v[12:13], v28 offset:16384
    ds_read_b64_tr_b16 v[14:15], v28 offset:17408
    ds_read_b64_tr_b16 v[16:17], v29 offset:16384
    ds_read_b64_tr_b16 v[18:19], v29 offset:17408
    s_add_u32 s47, s66, 8192
    s_bitcmp0_b32 s51, 8
    s_cbranch_scc1 L_os_129
    buffer_load_dwordx4 v[80:83], v2, s[32:35], s47 offen offset:0 sc1
    buffer_load_dwordx4 v[84:87], v2, s[32:35], s47 offen offset:1024 sc1
L_os_129:
    v_mfma_f32_32x32x16_bf16 v[48:63], v[244:247], v[216:219], v[48:63]
    s_waitcnt lgkmcnt(4)
    s_setprio 2
    v_cmp_ne_u32 vcc, 626944, v0
    s_setprio 0
    s_cbranch_vccz L_eDE9_ok_135
L_eDE9_sl_136:
    ds_read_b32 v0, v7 offset:136
    s_waitcnt lgkmcnt(0)
    s_setprio 2
    v_cmp_ne_u32 vcc, 626944, v0
    s_setprio 0
    s_cbranch_vccnz L_eDE9_sl_136
L_eDE9_ok_135:
    ds_read_b64_tr_b16 v[160:161], v5 offset:0
    ds_read_b64_tr_b16 v[162:163], v5 offset:1024
    ds_read_b64_tr_b16 v[164:165], v6 offset:0
    ds_read_b64_tr_b16 v[166:167], v6 offset:1024
    s_add_u32 s47, s66, 8192
    s_bitcmp0_b32 s51, 8
    s_cbranch_scc1 L_os_130
    buffer_load_dwordx4 v[88:91], v2, s[32:35], s47 offen offset:2048 sc1
    buffer_load_dwordx4 v[92:95], v2, s[32:35], s47 offen offset:3072 sc1
L_os_130:
    v_mfma_f32_32x32x16_bf16 v[32:47], v[248:251], v[220:223], v[32:47]
    ds_read_b64_tr_b16 v[20:21], v28 offset:18432
    ds_read_b64_tr_b16 v[22:23], v28 offset:19456
    ds_read_b64_tr_b16 v[24:25], v29 offset:18432
    ds_read_b64_tr_b16 v[26:27], v29 offset:19456
    s_add_u32 s47, s66, 16384
    s_bitcmp0_b32 s51, 16
    s_cbranch_scc1 L_os_131
    buffer_load_dwordx4 v[96:99], v2, s[32:35], s47 offen offset:0 sc1
    buffer_load_dwordx4 v[100:103], v2, s[32:35], s47 offen offset:1024 sc1
L_os_131:
    v_mfma_f32_32x32x16_bf16 v[48:63], v[252:255], v[220:223], v[48:63]
    ds_read_b64_tr_b16 v[168:169], v5 offset:2048
    ds_read_b64_tr_b16 v[170:171], v5 offset:3072
    ds_read_b64_tr_b16 v[172:173], v6 offset:2048
    ds_read_b64_tr_b16 v[174:175], v6 offset:3072
    s_add_u32 s47, s66, 16384
    s_bitcmp0_b32 s51, 16
    s_cbranch_scc1 L_os_132
    buffer_load_dwordx4 v[104:107], v2, s[32:35], s47 offen offset:2048 sc1
    buffer_load_dwordx4 v[108:111], v2, s[32:35], s47 offen offset:3072 sc1
L_os_132:
    s_waitcnt lgkmcnt(12)
    v_mfma_f32_32x32x16_bf16 v[32:47], v[12:15], v[224:227], v[32:47]
    ds_read_b64_tr_b16 v[240:241], v28 offset:20480
    ds_read_b64_tr_b16 v[242:243], v28 offset:21504
    ds_read_b64_tr_b16 v[244:245], v29 offset:20480
    ds_read_b64_tr_b16 v[246:247], v29 offset:21504
    s_add_u32 s47, s66, 24576
    s_bitcmp0_b32 s51, 24
    s_cbranch_scc1 L_os_133
    buffer_load_dwordx4 v[112:115], v2, s[32:35], s47 offen offset:0 sc1
    buffer_load_dwordx4 v[116:119], v2, s[32:35], s47 offen offset:1024 sc1
L_os_133:
    v_mfma_f32_32x32x16_bf16 v[48:63], v[16:19], v[224:227], v[48:63]
    ds_read_b64_tr_b16 v[176:177], v5 offset:4096
    ds_read_b64_tr_b16 v[178:179], v5 offset:5120
    ds_read_b64_tr_b16 v[180:181], v6 offset:4096
    ds_read_b64_tr_b16 v[182:183], v6 offset:5120
    s_add_u32 s47, s66, 24576
    s_bitcmp0_b32 s51, 24
    s_cbranch_scc1 L_os_134
    buffer_load_dwordx4 v[120:123], v2, s[32:35], s47 offen offset:2048 sc1
    buffer_load_dwordx4 v[124:127], v2, s[32:35], s47 offen offset:3072 sc1
L_os_134:
    s_waitcnt lgkmcnt(12)
    v_mfma_f32_32x32x16_bf16 v[32:47], v[20:23], v[228:231], v[32:47]
    ds_read_b64_tr_b16 v[248:249], v28 offset:22528
    ds_read_b64_tr_b16 v[250:251], v28 offset:23552
    ds_read_b64_tr_b16 v[252:253], v29 offset:22528
    ds_read_b64_tr_b16 v[254:255], v29 offset:23552
    v_mfma_f32_32x32x16_bf16 v[48:63], v[24:27], v[228:231], v[48:63]
    ds_read_b64_tr_b16 v[184:185], v5 offset:6144
    ds_read_b64_tr_b16 v[186:187], v5 offset:7168
    ds_read_b64_tr_b16 v[188:189], v6 offset:6144
    ds_read_b64_tr_b16 v[190:191], v6 offset:7168
    s_waitcnt lgkmcnt(12)
    v_mfma_f32_32x32x16_bf16 v[32:47], v[240:243], v[232:235], v[32:47]
    v_mfma_f32_32x32x16_bf16 v[48:63], v[244:247], v[232:235], v[48:63]
    ds_read_b64_tr_b16 v[192:193], v3 offset:0
    ds_read_b64_tr_b16 v[194:195], v3 offset:1024
    ds_read_b64_tr_b16 v[196:197], v4 offset:0
    ds_read_b64_tr_b16 v[198:199], v4 offset:1024
    s_waitcnt lgkmcnt(8)
    v_mfma_f32_32x32x16_bf16 v[32:47], v[248:251], v[236:239], v[32:47]
    v_mfma_f32_32x32x16_bf16 v[48:63], v[252:255], v[236:239], v[48:63]
    ds_read_b64_tr_b16 v[200:201], v3 offset:2048
    ds_read_b64_tr_b16 v[202:203], v3 offset:3072
    ds_read_b64_tr_b16 v[204:205], v4 offset:2048
    ds_read_b64_tr_b16 v[206:207], v4 offset:3072
    s_setprio 2
    ds_read_b64_tr_b16 v[208:209], v3 offset:4096
    ds_read_b64_tr_b16 v[210:211], v3 offset:5120
    ds_read_b64_tr_b16 v[212:213], v4 offset:4096
    ds_read_b64_tr_b16 v[214:215], v4 offset:5120
    ds_read_b64_tr_b16 v[216:217], v3 offset:6144
    ds_read_b64_tr_b16 v[218:219], v3 offset:7168
    ds_read_b64_tr_b16 v[220:221], v4 offset:6144
    ds_read_b64_tr_b16 v[222:223], v4 offset:7168
    ds_read_b64_tr_b16 v[224:225], v28 offset:33024
    ds_read_b64_tr_b16 v[226:227], v28 offset:34048
    ds_read_b64_tr_b16 v[228:229], v29 offset:33024
    ds_read_b64_tr_b16 v[230:231], v29 offset:34048
    ds_read_b64_tr_b16 v[232:233], v28 offset:35072
    ds_read_b64_tr_b16 v[234:235], v28 offset:36096
    ds_read_b64_tr_b16 v[236:237], v29 offset:35072
    ds_read_b64_tr_b16 v[238:239], v29 offset:36096
    ds_read_b64_tr_b16 v[240:241], v28 offset:37120
    ds_read_b64_tr_b16 v[242:243], v28 offset:38144
    ds_read_b64_tr_b16 v[244:245], v29 offset:37120
    ds_read_b64_tr_b16 v[246:247], v29 offset:38144
    ds_read_b64_tr_b16 v[248:249], v28 offset:39168
    ds_read_b64_tr_b16 v[250:251], v28 offset:40192
    ds_read_b64_tr_b16 v[252:253], v29 offset:39168
    ds_read_b64_tr_b16 v[254:255], v29 offset:40192
    s_mov_b32 s62, 65536
    s_branch L_oproc
L_opoll:
    buffer_load_dword v8, v11, s[32:35], s48 offen sc1
L_oround:
    s_waitcnt vmcnt(0)
    v_cmp_eq_u32 vcc, s58, v8
    s_sub_u32 s62, s62, 1
    s_cbranch_scc1 L_odone
    s_nop 1
    s_lshr_b32 s47, vcc_lo, s49
    s_lshr_b32 s51, s47, 1
    s_and_b32 s51, s51, s47
    s_lshr_b32 s47, s51, 2
    s_and_b32 s51, s51, s47
    s_and_b32 s51, s51, 0x01010101
    s_andn2_b32 s51, s51, s67
    s_cbranch_scc1 L_ogo
    s_sleep 1
    s_branch L_opoll
L_ogo:
    s_add_u32 s47, s66, 0
    s_bitcmp0_b32 s51, 0
    s_cbranch_scc1 L_os_138
    buffer_load_dwordx4 v[64:67], v2, s[32:35], s47 offen offset:0 sc1
    buffer_load_dwordx4 v[68:71], v2, s[32:35], s47 offen offset:1024 sc1
    buffer_load_dwordx4 v[72:75], v2, s[32:35], s47 offen offset:2048 sc1
    buffer_load_dwordx4 v[76:79], v2, s[32:35], s47 offen offset:3072 sc1
L_os_138:
    s_add_u32 s47, s66, 8192
    s_bitcmp0_b32 s51, 8
    s_cbranch_scc1 L_os_139
    buffer_load_dwordx4 v[80:83], v2, s[32:35], s47 offen offset:0 sc1
    buffer_load_dwordx4 v[84:87], v2, s[32:35], s47 offen offset:1024 sc1
    buffer_load_dwordx4 v[88:91], v2, s[32:35], s47 offen offset:2048 sc1
    buffer_load_dwordx4 v[92:95], v2, s[32:35], s47 offen offset:3072 sc1
L_os_139:
    s_add_u32 s47, s66, 16384
    s_bitcmp0_b32 s51, 16
    s_cbranch_scc1 L_os_140
    buffer_load_dwordx4 v[96:99], v2, s[32:35], s47 offen offset:0 sc1
    buffer_load_dwordx4 v[100:103], v2, s[32:35], s47 offen offset:1024 sc1
    buffer_load_dwordx4 v[104:107], v2, s[32:35], s47 offen offset:2048 sc1
    buffer_load_dwordx4 v[108:111], v2, s[32:35], s47 offen offset:3072 sc1
L_os_140:
    s_add_u32 s47, s66, 24576
    s_bitcmp0_b32 s51, 24
    s_cbranch_scc1 L_os_141
    buffer_load_dwordx4 v[112:115], v2, s[32:35], s47 offen offset:0 sc1
    buffer_load_dwordx4 v[116:119], v2, s[32:35], s47 offen offset:1024 sc1
    buffer_load_dwordx4 v[120:123], v2, s[32:35], s47 offen offset:2048 sc1
    buffer_load_dwordx4 v[124:127], v2, s[32:35], s47 offen offset:3072 sc1
L_os_141:
L_oproc:
    buffer_load_dword v8, v11, s[32:35], s48 offen sc1
L_op2:
    s_bitcmp0_b32 s51, 0
    s_cbranch_scc1 L_om0
    s_lshr_b32 s47, s51, 8
    s_bcnt1_i32_b32 s47, s47
    s_cmp_ge_u32 s47, 3
    s_waitcnt vmcnt(13)
    s_cbranch_scc1 L_ow0
    s_cmp_ge_u32 s47, 2
    s_waitcnt vmcnt(9)
    s_cbranch_scc1 L_ow0
    s_cmp_ge_u32 s47, 1
    s_waitcnt vmcnt(5)
    s_cbranch_scc1 L_ow0
    s_waitcnt vmcnt(1)
L_ow0:
    v_mfma_f32_32x32x16_bf16 v[12:27], v[132:135], v[64:67], v[48:63]
    v_max3_u32 v28, v64, v65, v66
    v_max3_u32 v28, v28, v67, v68
    v_max3_u32 v28, v28, v69, v70
    v_max3_u32 v28, v28, v71, v72
    v_max3_u32 v28, v28, v73, v74
    v_max3_u32 v28, v28, v75, v76
    v_mfma_f32_32x32x16_bf16 v[12:27], v[140:143], v[68:71], v[12:27]
    v_max3_u32 v28, v28, v77, v78
    v_max_u32 v28, v28, v79
    v_cmp_eq_u32 vcc, -1, v28
    s_nop 0
    s_cbranch_vccnz L_om0
    s_bitset1_b32 s67, 0
    v_mfma_f32_32x32x16_bf16 v[48:63], v[148:151], v[72:75], v[12:27]
    v_mfma_f32_32x32x16_bf16 v[48:63], v[156:159], v[76:79], v[48:63]
    s_cmp_eq_u32 s67, 0x01010101
    v_mfma_f32_32x32x16_bf16 v[32:47], v[128:131], v[64:67], v[32:47]
    s_cbranch_scc0 L_on0
    s_nop 8
    ds_write_b128 v30, v[48:51] offset:0
    ds_write_b128 v30, v[52:55] offset:1024
    ds_write_b128 v30, v[56:59] offset:2048
    ds_write_b128 v30, v[60:63] offset:3072
    s_mov_b64 exec, 1
    ds_add_u32 v1, v7 offset:4
    s_mov_b64 exec, -1
    ds_read_b32 v0, v1 offset:4
    ds_read_b128 v[12:15], v31 offset:0
    ds_read_b128 v[16:19], v31 offset:1024
    ds_read_b128 v[20:23], v31 offset:2048
    ds_read_b128 v[24:27], v31 offset:3072
L_on0:
    v_mfma_f32_32x32x16_bf16 v[32:47], v[136:139], v[68:71], v[32:47]
    v_mfma_f32_32x32x16_bf16 v[32:47], v[144:147], v[72:75], v[32:47]
    v_mfma_f32_32x32x16_bf16 v[32:47], v[152:155], v[76:79], v[32:47]
L_om0:
    s_bitcmp0_b32 s51, 8
    s_cbranch_scc1 L_om1
    s_lshr_b32 s47, s51, 16
    s_bcnt1_i32_b32 s47, s47
    s_cmp_ge_u32 s47, 2
    s_waitcnt vmcnt(9)
    s_cbranch_scc1 L_ow1
    s_cmp_ge_u32 s47, 1
    s_waitcnt vmcnt(5)
    s_cbranch_scc1 L_ow1
    s_waitcnt vmcnt(1)
L_ow1:
    s_waitcnt lgkmcnt(15)
    v_mfma_f32_32x32x16_bf16 v[12:27], v[164:167], v[80:83], v[48:63]
    v_max3_u32 v28, v80, v81, v82
    v_max3_u32 v28, v28, v83, v84
    v_max3_u32 v28, v28, v85, v86
    v_max3_u32 v28, v28, v87, v88
    v_max3_u32 v28, v28, v89, v90
    v_max3_u32 v28, v28, v91, v92
    v_mfma_f32_32x32x16_bf16 v[12:27], v[172:175], v[84:87], v[12:27]
    v_max3_u32 v28, v28, v93, v94
    v_max_u32 v28, v28, v95
    v_cmp_eq_u32 vcc, -1, v28
    s_nop 0
    s_cbranch_vccnz L_om1
    s_bitset1_b32 s67, 8
    v_mfma_f32_32x32x16_bf16 v[48:63], v[180:183], v[88:91], v[12:27]
    v_mfma_f32_32x32x16_bf16 v[48:63], v[188:191], v[92:95], v[48:63]
    s_cmp_eq_u32 s67, 0x01010101
    v_mfma_f32_32x32x16_bf16 v[32:47], v[160:163], v[80:83], v[32:47]
    s_cbranch_scc0 L_on1
    s_nop 8
    ds_write_b128 v30, v[48:51] offset:0
    ds_write_b128 v30, v[52:55] offset:1024
    ds_write_b128 v30, v[56:59] offset:2048
    ds_write_b128 v30, v[60:63] offset:3072
    s_mov_b64 exec, 1
    ds_add_u32 v1, v7 offset:4
    s_mov_b64 exec, -1
    ds_read_b32 v0, v1 offset:4
    ds_read_b128 v[12:15], v31 offset:0
    ds_read_b128 v[16:19], v31 offset:1024
    ds_read_b128 v[20:23], v31 offset:2048
    ds_read_b128 v[24:27], v31 offset:3072
L_on1:
    v_mfma_f32_32x32x16_bf16 v[32:47], v[168:171], v[84:87], v[32:47]
    v_mfma_f32_32x32x16_bf16 v[32:47], v[176:179], v[88:91], v[32:47]
    v_mfma_f32_32x32x16_bf16 v[32:47], v[184:187], v[92:95], v[32:47]
L_om1:
    s_bitcmp0_b32 s51, 16
    s_cbranch_scc1 L_om2
    s_lshr_b32 s47, s51, 24
    s_bcnt1_i32_b32 s47, s47
    s_cmp_ge_u32 s47, 1
    s_waitcnt vmcnt(5)
    s_cbranch_scc1 L_ow2
    s_waitcnt vmcnt(1)
L_ow2:
    s_waitcnt lgkmcnt(15)
    v_mfma_f32_32x32x16_bf16 v[12:27], v[196:199], v[96:99], v[48:63]
    v_max3_u32 v28, v96, v97, v98
    v_max3_u32 v28, v28, v99, v100
    v_max3_u32 v28, v28, v101, v102
    v_max3_u32 v28, v28, v103, v104
    v_max3_u32 v28, v28, v105, v106
    v_max3_u32 v28, v28, v107, v108
    v_mfma_f32_32x32x16_bf16 v[12:27], v[204:207], v[100:103], v[12:27]
    v_max3_u32 v28, v28, v109, v110
    v_max_u32 v28, v28, v111
    v_cmp_eq_u32 vcc, -1, v28
    s_nop 0
    s_cbranch_vccnz L_om2
    s_bitset1_b32 s67, 16
    v_mfma_f32_32x32x16_bf16 v[48:63], v[212:215], v[104:107], v[12:27]
    v_mfma_f32_32x32x16_bf16 v[48:63], v[220:223], v[108:111], v[48:63]
    s_cmp_eq_u32 s67, 0x01010101
    v_mfma_f32_32x32x16_bf16 v[32:47], v[192:195], v[96:99], v[32:47]
    s_cbranch_scc0 L_on2
    s_nop 8
    ds_write_b128 v30, v[48:51] offset:0
    ds_write_b128 v30, v[52:55] offset:1024
    ds_write_b128 v30, v[56:59] offset:2048
    ds_write_b128 v30, v[60:63] offset:3072
    s_mov_b64 exec, 1
    ds_add_u32 v1, v7 offset:4
    s_mov_b64 exec, -1
    ds_read_b32 v0, v1 offset:4
    ds_read_b128 v[12:15], v31 offset:0
    ds_read_b128 v[16:19], v31 offset:1024
    ds_read_b128 v[20:23], v31 offset:2048
    ds_read_b128 v[24:27], v31 offset:3072
L_on2:
    v_mfma_f32_32x32x16_bf16 v[32:47], v[200:203], v[100:103], v[32:47]
    v_mfma_f32_32x32x16_bf16 v[32:47], v[208:211], v[104:107], v[32:47]
    v_mfma_f32_32x32x16_bf16 v[32:47], v[216:219], v[108:111], v[32:47]
L_om2:
    s_bitcmp0_b32 s51, 24
    s_cbranch_scc1 L_om3
    s_waitcnt vmcnt(1)
L_ow3:
    s_waitcnt lgkmcnt(0)
    s_nop 0
    v_mfma_f32_32x32x16_bf16 v[12:27], v[228:231], v[112:115], v[48:63]
    v_max3_u32 v28, v112, v113, v114
    v_max3_u32 v28, v28, v115, v116
    v_max3_u32 v28, v28, v117, v118
    v_max3_u32 v28, v28, v119, v120
    v_max3_u32 v28, v28, v121, v122
    v_max3_u32 v28, v28, v123, v124
    v_mfma_f32_32x32x16_bf16 v[12:27], v[236:239], v[116:119], v[12:27]
    v_max3_u32 v28, v28, v125, v126
    v_max_u32 v28, v28, v127
    v_cmp_eq_u32 vcc, -1, v28
    s_nop 0
    s_cbranch_vccnz L_om3
    s_bitset1_b32 s67, 24
    v_mfma_f32_32x32x16_bf16 v[48:63], v[244:247], v[120:123], v[12:27]
    v_mfma_f32_32x32x16_bf16 v[48:63], v[252:255], v[124:127], v[48:63]
    s_cmp_eq_u32 s67, 0x01010101
    v_mfma_f32_32x32x16_bf16 v[32:47], v[224:227], v[112:115], v[32:47]
    s_cbranch_scc0 L_on3
    s_nop 8
    ds_write_b128 v30, v[48:51] offset:0
    ds_write_b128 v30, v[52:55] offset:1024
    ds_write_b128 v30, v[56:59] offset:2048
    ds_write_b128 v30, v[60:63] offset:3072
    s_mov_b64 exec, 1
    ds_add_u32 v1, v7 offset:4
    s_mov_b64 exec, -1
    ds_read_b32 v0, v1 offset:4
    ds_read_b128 v[12:15], v31 offset:0
    ds_read_b128 v[16:19], v31 offset:1024
    ds_read_b128 v[20:23], v31 offset:2048
    ds_read_b128 v[24:27], v31 offset:3072
L_on3:
    v_mfma_f32_32x32x16_bf16 v[32:47], v[232:235], v[116:119], v[32:47]
    v_mfma_f32_32x32x16_bf16 v[32:47], v[240:243], v[120:123], v[32:47]
    v_mfma_f32_32x32x16_bf16 v[32:47], v[248:251], v[124:127], v[32:47]
L_om3:
    s_cmp_eq_u32 s67, 0x01010101
    s_cbranch_scc1 L_oxt
    s_branch L_oround
L_odone:
    s_nop 15
    ds_write_b128 v30, v[48:51] offset:0
    ds_write_b128 v30, v[52:55] offset:1024
    ds_write_b128 v30, v[56:59] offset:2048
    ds_write_b128 v30, v[60:63] offset:3072
    s_mov_b64 exec, 1
    ds_add_u32 v1, v7 offset:4
    s_mov_b64 exec, -1
    ds_read_b32 v0, v1 offset:4
    ds_read_b128 v[12:15], v31 offset:0
    ds_read_b128 v[16:19], v31 offset:1024
    ds_read_b128 v[20:23], v31 offset:2048
    ds_read_b128 v[24:27], v31 offset:3072
L_oxt:
    s_nop 5
    s_waitcnt lgkmcnt(0)
    v_cmp_ne_u32 vcc, 313472, v0
    s_nop 0
    s_cbranch_vccz L_ox_ok_142
L_ox_sl_143:
    ds_read_b32 v0, v1 offset:4
    ds_read_b128 v[12:15], v31 offset:0
    ds_read_b128 v[16:19], v31 offset:1024
    ds_read_b128 v[20:23], v31 offset:2048
    ds_read_b128 v[24:27], v31 offset:3072
    s_waitcnt lgkmcnt(0)
    v_cmp_ne_u32 vcc, 313472, v0
    s_nop 0
    s_cbranch_vccnz L_ox_sl_143
L_ox_ok_142:
    v_pk_add_f32 v[32:33], v[32:33], v[12:13]
    v_pk_add_f32 v[34:35], v[34:35], v[14:15]
    v_pk_add_f32 v[36:37], v[36:37], v[16:17]
    v_pk_add_f32 v[38:39], v[38:39], v[18:19]
    v_cvt_pk_bf16_f32 v48, v32, v33
    v_cvt_pk_bf16_f32 v49, v34, v35
    v_cvt_pk_bf16_f32 v50, v36, v37
    v_cvt_pk_bf16_f32 v51, v38, v39
    buffer_store_dwordx4 v[48:51], v10, s[36:39], 0 offen offset:0
    v_pk_add_f32 v[40:41], v[40:41], v[20:21]
    v_pk_add_f32 v[42:43], v[42:43], v[22:23]
    v_pk_add_f32 v[44:45], v[44:45], v[24:25]
    v_pk_add_f32 v[46:47], v[46:47], v[26:27]
    v_cvt_pk_bf16_f32 v52, v40, v41
    v_cvt_pk_bf16_f32 v53, v42, v43
    v_cvt_pk_bf16_f32 v54, v44, v45
    v_cvt_pk_bf16_f32 v55, v46, v47
    buffer_store_dwordx4 v[52:55], v10, s[36:39], 0 offen offset:32
    s_or_b32 s47, s2, s45
    s_cselect_b32 s47, 1073741824, 0
    v_mov_b32 v64, 14221312
    v_mov_b32 v65, s58
    buffer_store_dword v65, v64, s[32:35], s47 offen sc1
    s_endpgm
L_T:
    v_mov_b32 v11, 14221312
    v_mov_b32 v144, 156736
    v_lshl_add_u32 v96, v1, 2, v144
    v_mov_b32 v97, 0
    ds_write_b32 v96, v97
    v_and_b32 v98, 31, v1
    s_lshl_b32 s47, s45, 5
    v_add_u32 v98, s47, v98
    v_lshrrev_b32 v99, 1, v98
    v_lshrrev_b32 v100, 5, v1
    v_xor_b32 v99, v99, v100
    v_and_b32 v99, 7, v99
    v_lshlrev_b32 v99, 4, v99
    v_lshl_add_u32 v3, v98, 7, v99
    v_xor_b32 v4, 32, v3
    v_xor_b32 v5, 64, v3
    v_xor_b32 v6, 96, v3
    v_mov_b32 v18, 0
    v_mov_b32 v19, 0
    v_mov_b32 v28, 0
    v_mov_b32 v29, 0
    v_mov_b32 v154, -1
    v_mov_b32 v155, -1
    v_mov_b32 v156, -1
    v_mov_b32 v157, -1
    s_waitcnt lgkmcnt(0)
    s_mov_b64 s[8:9], s[68:69]
    s_mov_b64 s[32:33], s[86:87]
    buffer_load_dword v11, v11, s[32:35], 0 offen sc1
    s_lshl_b32 s47, s44, 2
    s_add_u32 s47, s47, s45
    s_lshl_b32 s47, s47, 6
    s_lshl_b32 s48, s46, 4
    s_add_u32 s47, s47, s48
    s_add_u32 s47, s47, s43
    s_lshl_b32 s47, s47, 7
    s_add_u32 s47, s47, 14225408
    s_lshl_b32 s48, s61, 2
    s_add_u32 s48, s48, s45
    s_lshl_b32 s48, s48, 6
    s_add_u32 s48, s48, s60
    s_lshl_b32 s48, s48, 7
    s_add_u32 s48, s48, 14749696
    v_mov_b32 v146, 1073741824
    v_mov_b32 v149, 1073741824
    v_writelane_b32 v146, s47, 0
    v_writelane_b32 v149, s48, 0
    s_lshl_b32 s66, s61, 3
    s_add_u32 s66, s66, s45
    s_lshl_b32 s66, s66, 5
    s_add_u32 s66, s66, s60
    s_lshl_b32 s66, s66, 10
    s_add_u32 s66, s66, 12058624
    s_lshl_b32 s63, s44, 8
    s_lshl_b32 s50, s43, 2
    s_add_u32 s63, s63, s50
    s_add_u32 s63, s63, s45
    s_lshl_b32 s63, s63, 10
    s_and_b32 s47, s44, 4
    s_add_u32 s16, s44, s47
    s_lshl2_add_u32 s16, s46, s16
    s_lshl_b32 s16, s16, 17
    s_and_b32 s47, s63, 0xffff
    s_add_u32 s16, s16, s47
    s_and_b32 s64, s60, 7
    s_lshl4_add_u32 s64, s60, s64
    s_lshl2_add_u32 s64, s64, s45
    s_lshl_b32 s64, s64, 10
    s_mul_i32 s54, s45, 2064
    s_cmp_eq_u32 s46, 1
    s_cbranch_scc1 L_T_v
    s_xor_b32 s59, s43, 0
    s_lshl_b32 s59, s59, 3
    s_add_u32 s59, s59, s44
    s_lshl_b32 s59, s59, 2
    s_add_u32 s59, s59, s45
    s_lshl_b32 s59, s59, 12
    v_lshrrev_b32 v96, 4, v1
    v_mul_u32_u24 v96, 768, v96
    v_add_u32 v132, v96, v2
    buffer_load_dwordx4 v[112:115], v132, s[8:11], s59 offen offset:0
    buffer_load_dwordx4 v[116:119], v132, s[8:11], s59 offen offset:256
    buffer_load_dwordx4 v[120:123], v132, s[8:11], s59 offen offset:512
    buffer_load_dwordx4 v[124:127], v132, s[8:11], s59 offen offset:768
    v_lshrrev_b32 v96, 5, v1
    v_lshlrev_b32 v96, 3, v96
    v_bfe_u32 v97, v1, 2, 2
    v_add_u32 v96, v96, v97
    v_bfe_u32 v98, v1, 4, 1
    v_and_b32 v99, 3, v1
    v_lshlrev_b32 v99, 3, v99
    v_mul_u32_u24 v7, 192, v96
    v_lshl_add_u32 v7, v98, 5, v7
    v_add_u32 v7, v7, v99
    v_add_u32 v7, 16384, v7
    v_and_b32 v96, 31, v1
    v_lshrrev_b32 v97, 5, v1
    s_lshl_b32 s50, s45, 7
    s_add_u32 s50, s50, 161088
    v_lshl_add_u32 v98, v96, 2, s50
    v_lshl_add_u32 v99, v97, 4, s50
    s_add_u32 s13, s63, 2097152
    s_lshr_b32 s50, s43, 2
    s_xor_b32 s50, s50, s44
    s_and_b32 s50, s50, 1
    s_cselect_b32 s12, 1073741824, s13
    s_cselect_b32 s13, s13, 1073741824
    s_cselect_b32 s15, 1073741824, 0
    s_cselect_b32 s36, 0, 1073741824
    s_mov_b32 s14, 65536
    v_lshlrev_b32 v148, 5, v1
    v_add_u32 v148, 156992, v148
    s_mov_b32 s47, 0x9e3779b1
    s_waitcnt vmcnt(4)
    v_mul_lo_u32 v158, v11, s47
    v_add_u32 v158, 0x7f4a7c15, v158
    s_nop 0
    v_readfirstlane_b32 s58, v158
    s_waitcnt lgkmcnt(0)
    s_barrier
    ds_read_b128 v[224:227], v3 offset:33024
    ds_read_b64_tr_b16 v[48:49], v7 offset:33024
    ds_read_b64_tr_b16 v[50:51], v7 offset:33792
    ds_read_b64_tr_b16 v[52:53], v7 offset:33088
    ds_read_b64_tr_b16 v[54:55], v7 offset:33856
    ds_read_b64_tr_b16 v[56:57], v7 offset:33152
    ds_read_b64_tr_b16 v[58:59], v7 offset:33920
    ds_read_b128 v[228:231], v4 offset:33024
    ds_read_b64_tr_b16 v[60:61], v7 offset:36096
    ds_read_b64_tr_b16 v[62:63], v7 offset:36864
    ds_read_b64_tr_b16 v[64:65], v7 offset:36160
    ds_read_b64_tr_b16 v[66:67], v7 offset:36928
    ds_read_b64_tr_b16 v[68:69], v7 offset:36224
    ds_read_b64_tr_b16 v[70:71], v7 offset:36992
    ds_read_b128 v[232:235], v5 offset:33024
    ds_read_b64_tr_b16 v[72:73], v7 offset:39168
    ds_read_b64_tr_b16 v[74:75], v7 offset:39936
    s_waitcnt lgkmcnt(14)
    v_mfma_f32_32x32x16_bf16 v[176:191], v[48:51], v[224:227], 0
    ds_read_b64_tr_b16 v[76:77], v7 offset:39232
    ds_read_b64_tr_b16 v[78:79], v7 offset:40000
    s_waitcnt lgkmcnt(14)
    v_mfma_f32_32x32x16_bf16 v[192:207], v[52:55], v[224:227], 0
    ds_read_b64_tr_b16 v[48:49], v7 offset:39296
    ds_read_b64_tr_b16 v[50:51], v7 offset:40064
    s_waitcnt lgkmcnt(14)
    v_mfma_f32_32x32x16_bf16 v[208:223], v[56:59], v[224:227], 0
    ds_read_b128 v[236:239], v6 offset:33024
    ds_read_b64_tr_b16 v[52:53], v7 offset:42240
    ds_read_b64_tr_b16 v[54:55], v7 offset:43008
    s_waitcnt lgkmcnt(14)
    v_mfma_f32_32x32x16_bf16 v[176:191], v[60:63], v[228:231], v[176:191]
    ds_read_b64_tr_b16 v[56:57], v7 offset:42304
    ds_read_b64_tr_b16 v[58:59], v7 offset:43072
    s_waitcnt lgkmcnt(14)
    v_mfma_f32_32x32x16_bf16 v[192:207], v[64:67], v[228:231], v[192:207]
    ds_read_b64_tr_b16 v[60:61], v7 offset:42368
    ds_read_b64_tr_b16 v[62:63], v7 offset:43136
    s_waitcnt lgkmcnt(14)
    v_mfma_f32_32x32x16_bf16 v[208:223], v[68:71], v[228:231], v[208:223]
    s_waitcnt lgkmcnt(11)
    v_mfma_f32_32x32x16_bf16 v[176:191], v[72:75], v[232:235], v[176:191]
    s_waitcnt lgkmcnt(9)
    v_mfma_f32_32x32x16_bf16 v[192:207], v[76:79], v[232:235], v[192:207]
    v_add_u32 v3, 66048, v3
    v_add_u32 v4, 66048, v4
    v_add_u32 v5, 66048, v5
    v_add_u32 v6, 66048, v6
    v_add_u32 v7, 66048, v7
    s_waitcnt lgkmcnt(0)
    s_barrier
    ds_read_b128 v[240:243], v3 offset:0
    ds_read_b64_tr_b16 v[64:65], v7 offset:0
    ds_read_b64_tr_b16 v[66:67], v7 offset:768
    ds_read_b64_tr_b16 v[68:69], v7 offset:64
    ds_read_b64_tr_b16 v[70:71], v7 offset:832
    ds_read_b64_tr_b16 v[72:73], v7 offset:128
    ds_read_b64_tr_b16 v[74:75], v7 offset:896
    v_mfma_f32_32x32x16_bf16 v[208:223], v[48:51], v[232:235], v[208:223]
    s_waitcnt vmcnt(0)
    s_mov_b32 s55, 0x3f803f80
    v_dot2_f32_bf16 v128, v112, s55, 0
    ds_read_b128 v[244:247], v4 offset:0
    ds_read_b64_tr_b16 v[76:77], v7 offset:3072
    ds_read_b64_tr_b16 v[78:79], v7 offset:3840
    v_mfma_f32_32x32x16_bf16 v[176:191], v[52:55], v[236:239], v[176:191]
    v_dot2_f32_bf16 v130, v112, v112, 0
    v_dot2_f32_bf16 v128, v113, s55, v128
    v_dot2_f32_bf16 v130, v113, v113, v130
    ds_read_b64_tr_b16 v[48:49], v7 offset:3136
    ds_read_b64_tr_b16 v[50:51], v7 offset:3904
    v_mfma_f32_32x32x16_bf16 v[192:207], v[56:59], v[236:239], v[192:207]
    v_dot2_f32_bf16 v128, v114, s55, v128
    v_dot2_f32_bf16 v130, v114, v114, v130
    v_dot2_f32_bf16 v128, v115, s55, v128
    ds_read_b64_tr_b16 v[52:53], v7 offset:3200
    ds_read_b64_tr_b16 v[54:55], v7 offset:3968
    v_mfma_f32_32x32x16_bf16 v[208:223], v[60:63], v[236:239], v[208:223]
    v_dot2_f32_bf16 v130, v115, v115, v130
    v_dot2_f32_bf16 v128, v116, s55, v128
    v_dot2_f32_bf16 v130, v116, v116, v130
    ds_read_b128 v[248:251], v5 offset:0
    ds_read_b64_tr_b16 v[56:57], v7 offset:6144
    ds_read_b64_tr_b16 v[58:59], v7 offset:6912
    s_waitcnt lgkmcnt(14)
    v_mfma_f32_32x32x16_bf16 v[176:191], v[64:67], v[240:243], v[176:191]
    v_dot2_f32_bf16 v128, v117, s55, v128
    v_dot2_f32_bf16 v130, v117, v117, v130
    v_dot2_f32_bf16 v128, v118, s55, v128
    ds_read_b64_tr_b16 v[60:61], v7 offset:6208
    ds_read_b64_tr_b16 v[62:63], v7 offset:6976
    s_waitcnt lgkmcnt(14)
    v_mfma_f32_32x32x16_bf16 v[192:207], v[68:71], v[240:243], v[192:207]
    v_dot2_f32_bf16 v130, v118, v118, v130
    v_dot2_f32_bf16 v128, v119, s55, v128
    v_dot2_f32_bf16 v130, v119, v119, v130
    ds_read_b64_tr_b16 v[64:65], v7 offset:6272
    ds_read_b64_tr_b16 v[66:67], v7 offset:7040
    s_waitcnt lgkmcnt(14)
    v_mfma_f32_32x32x16_bf16 v[208:223], v[72:75], v[240:243], v[208:223]
    v_dot2_f32_bf16 v128, v120, s55, v128
    v_dot2_f32_bf16 v130, v120, v120, v130
    v_dot2_f32_bf16 v128, v121, s55, v128
    ds_read_b128 v[252:255], v6 offset:0
    ds_read_b64_tr_b16 v[68:69], v7 offset:9216
    ds_read_b64_tr_b16 v[70:71], v7 offset:9984
    s_waitcnt lgkmcnt(14)
    v_mfma_f32_32x32x16_bf16 v[176:191], v[76:79], v[244:247], v[176:191]
    v_dot2_f32_bf16 v130, v121, v121, v130
    v_dot2_f32_bf16 v128, v122, s55, v128
    v_dot2_f32_bf16 v130, v122, v122, v130
    ds_read_b64_tr_b16 v[72:73], v7 offset:9280
    ds_read_b64_tr_b16 v[74:75], v7 offset:10048
    s_waitcnt lgkmcnt(14)
    v_mfma_f32_32x32x16_bf16 v[192:207], v[48:51], v[244:247], v[192:207]
    v_dot2_f32_bf16 v128, v123, s55, v128
    v_dot2_f32_bf16 v130, v123, v123, v130
    v_dot2_f32_bf16 v128, v124, s55, v128
    ds_read_b64_tr_b16 v[76:77], v7 offset:9344
    ds_read_b64_tr_b16 v[78:79], v7 offset:10112
    s_waitcnt lgkmcnt(14)
    v_mfma_f32_32x32x16_bf16 v[208:223], v[52:55], v[244:247], v[208:223]
    v_dot2_f32_bf16 v130, v124, v124, v130
    v_dot2_f32_bf16 v128, v125, s55, v128
    v_dot2_f32_bf16 v130, v125, v125, v130
    s_waitcnt lgkmcnt(11)
    v_mfma_f32_32x32x16_bf16 v[176:191], v[56:59], v[248:251], v[176:191]
    v_dot2_f32_bf16 v128, v126, s55, v128
    v_dot2_f32_bf16 v130, v126, v126, v130
    v_dot2_f32_bf16 v128, v127, s55, v128
    s_waitcnt lgkmcnt(9)
    v_mfma_f32_32x32x16_bf16 v[192:207], v[60:63], v[248:251], v[192:207]
    v_dot2_f32_bf16 v130, v127, v127, v130
    v_mov_b32 v129, v158
    v_mov_b32 v131, v158
    s_waitcnt lgkmcnt(0)
    s_barrier
    ds_read_b128 v[224:227], v3 offset:33024
    ds_read_b64_tr_b16 v[48:49], v7 offset:33024
    ds_read_b64_tr_b16 v[50:51], v7 offset:33792
    ds_read_b64_tr_b16 v[52:53], v7 offset:33088
    ds_read_b64_tr_b16 v[54:55], v7 offset:33856
    ds_read_b64_tr_b16 v[56:57], v7 offset:33152
    ds_read_b64_tr_b16 v[58:59], v7 offset:33920
    v_mfma_f32_32x32x16_bf16 v[208:223], v[64:67], v[248:251], v[208:223]
    v_and_b32 v112, 15, v1
    v_lshlrev_b32 v112, 26, v112
    v_add_f32_dpp v128, v128, v128 row_ror:8 row_mask:0xf bank_mask:0xf
    v_add_f32_dpp v130, v130, v130 row_ror:8 row_mask:0xf bank_mask:0xf
    s_nop 0
    ds_read_b128 v[228:231], v4 offset:33024
    ds_read_b64_tr_b16 v[60:61], v7 offset:36096
    ds_read_b64_tr_b16 v[62:63], v7 offset:36864
    v_mfma_f32_32x32x16_bf16 v[176:191], v[68:71], v[252:255], v[176:191]
    v_add_f32_dpp v128, v128, v128 row_ror:4 row_mask:0xf bank_mask:0xf
    v_add_f32_dpp v130, v130, v130 row_ror:4 row_mask:0xf bank_mask:0xf
    s_nop 0
    v_add_f32_dpp v128, v128, v128 row_ror:2 row_mask:0xf bank_mask:0xf
    v_add_f32_dpp v130, v130, v130 row_ror:2 row_mask:0xf bank_mask:0xf
    s_nop 0
    v_add_f32_dpp v128, v128, v128 row_ror:1 row_mask:0xf bank_mask:0xf
    v_add_f32_dpp v130, v130, v130 row_ror:1 row_mask:0xf bank_mask:0xf
    s_nop 0
    ds_read_b64_tr_b16 v[64:65], v7 offset:36160
    ds_read_b64_tr_b16 v[66:67], v7 offset:36928
    v_mfma_f32_32x32x16_bf16 v[192:207], v[72:75], v[252:255], v[192:207]
    s_lshr_b32 s55, s59, 5
    v_mul_f32 v128, 0xbb000000, v128
    v_mul_f32 v130, 0x3b000000, v130
    s_add_u32 s55, s55, 14155776
    v_fma_f32 v130, -v128, v128, v130
    ds_read_b64_tr_b16 v[68:69], v7 offset:36224
    ds_read_b64_tr_b16 v[70:71], v7 offset:36992
    v_mfma_f32_32x32x16_bf16 v[208:223], v[76:79], v[252:255], v[208:223]
    v_add_u32 v112, v112, v1
    v_max_f32 v130, 0, v130
    v_add_f32 v130, 0x3727c5ac, v130
    ds_read_b128 v[232:235], v5 offset:33024
    ds_read_b64_tr_b16 v[72:73], v7 offset:39168
    ds_read_b64_tr_b16 v[74:75], v7 offset:39936
    s_waitcnt lgkmcnt(14)
    v_mfma_f32_32x32x16_bf16 v[176:191], v[48:51], v[224:227], v[176:191]
    buffer_store_dwordx4 v[128:131], v112, s[32:35], s55 offen sc1
    ds_read_b64_tr_b16 v[76:77], v7 offset:39232
    ds_read_b64_tr_b16 v[78:79], v7 offset:40000
    s_waitcnt lgkmcnt(14)
    v_mfma_f32_32x32x16_bf16 v[192:207], v[52:55], v[224:227], v[192:207]
    ds_read_b64_tr_b16 v[48:49], v7 offset:39296
    ds_read_b64_tr_b16 v[50:51], v7 offset:40064
    s_waitcnt lgkmcnt(14)
    v_mfma_f32_32x32x16_bf16 v[208:223], v[56:59], v[224:227], v[208:223]
    ds_read_b128 v[236:239], v6 offset:33024
    ds_read_b64_tr_b16 v[52:53], v7 offset:42240
    ds_read_b64_tr_b16 v[54:55], v7 offset:43008
    s_waitcnt lgkmcnt(14)
    v_mfma_f32_32x32x16_bf16 v[176:191], v[60:63], v[228:231], v[176:191]
    ds_read_b64_tr_b16 v[56:57], v7 offset:42304
    ds_read_b64_tr_b16 v[58:59], v7 offset:43072
    s_waitcnt lgkmcnt(14)
    v_mfma_f32_32x32x16_bf16 v[192:207], v[64:67], v[228:231], v[192:207]
    ds_read_b64_tr_b16 v[60:61], v7 offset:42368
    ds_read_b64_tr_b16 v[62:63], v7 offset:43136
    s_waitcnt lgkmcnt(14)
    v_mfma_f32_32x32x16_bf16 v[208:223], v[68:71], v[228:231], v[208:223]
    s_waitcnt lgkmcnt(11)
    v_mfma_f32_32x32x16_bf16 v[176:191], v[72:75], v[232:235], v[176:191]
    s_waitcnt lgkmcnt(9)
    v_mfma_f32_32x32x16_bf16 v[192:207], v[76:79], v[232:235], v[192:207]
    v_subrev_u32 v3, 66048, v3
    v_subrev_u32 v4, 66048, v4
    v_subrev_u32 v5, 66048, v5
    v_subrev_u32 v6, 66048, v6
    v_subrev_u32 v7, 66048, v7
    s_waitcnt lgkmcnt(0)
    s_barrier
    ds_read_b128 v[240:243], v3 offset:0
    ds_read_b64_tr_b16 v[64:65], v7 offset:0
    ds_read_b64_tr_b16 v[66:67], v7 offset:768
    ds_read_b64_tr_b16 v[68:69], v7 offset:64
    ds_read_b64_tr_b16 v[70:71], v7 offset:832
    ds_read_b64_tr_b16 v[72:73], v7 offset:128
    ds_read_b64_tr_b16 v[74:75], v7 offset:896
    v_mfma_f32_32x32x16_bf16 v[208:223], v[48:51], v[232:235], v[208:223]
    ds_read_b128 v[244:247], v4 offset:0
    ds_read_b64_tr_b16 v[76:77], v7 offset:3072
    ds_read_b64_tr_b16 v[78:79], v7 offset:3840
    v_mfma_f32_32x32x16_bf16 v[176:191], v[52:55], v[236:239], v[176:191]
    ds_read_b64_tr_b16 v[48:49], v7 offset:3136
    ds_read_b64_tr_b16 v[50:51], v7 offset:3904
    v_mfma_f32_32x32x16_bf16 v[192:207], v[56:59], v[236:239], v[192:207]
    ds_read_b64_tr_b16 v[52:53], v7 offset:3200
    ds_read_b64_tr_b16 v[54:55], v7 offset:3968
    v_mfma_f32_32x32x16_bf16 v[208:223], v[60:63], v[236:239], v[208:223]
    ds_read_b128 v[248:251], v5 offset:0
    ds_read_b64_tr_b16 v[56:57], v7 offset:6144
    ds_read_b64_tr_b16 v[58:59], v7 offset:6912
    s_waitcnt lgkmcnt(14)
    v_mfma_f32_32x32x16_bf16 v[176:191], v[64:67], v[240:243], v[176:191]
    ds_read_b64_tr_b16 v[60:61], v7 offset:6208
    ds_read_b64_tr_b16 v[62:63], v7 offset:6976
    s_waitcnt lgkmcnt(14)
    v_mfma_f32_32x32x16_bf16 v[192:207], v[68:71], v[240:243], v[192:207]
    ds_read_b64_tr_b16 v[64:65], v7 offset:6272
    ds_read_b64_tr_b16 v[66:67], v7 offset:7040
    s_waitcnt lgkmcnt(14)
    v_mfma_f32_32x32x16_bf16 v[208:223], v[72:75], v[240:243], v[208:223]
    ds_read_b128 v[252:255], v6 offset:0
    ds_read_b64_tr_b16 v[68:69], v7 offset:9216
    ds_read_b64_tr_b16 v[70:71], v7 offset:9984
    s_waitcnt lgkmcnt(14)
    v_mfma_f32_32x32x16_bf16 v[176:191], v[76:79], v[244:247], v[176:191]
    ds_read_b64_tr_b16 v[72:73], v7 offset:9280
    ds_read_b64_tr_b16 v[74:75], v7 offset:10048
    s_waitcnt lgkmcnt(14)
    v_mfma_f32_32x32x16_bf16 v[192:207], v[48:51], v[244:247], v[192:207]
    ds_read_b64_tr_b16 v[76:77], v7 offset:9344
    ds_read_b64_tr_b16 v[78:79], v7 offset:10112
    s_waitcnt lgkmcnt(14)
    v_mfma_f32_32x32x16_bf16 v[208:223], v[52:55], v[244:247], v[208:223]
    s_waitcnt lgkmcnt(11)
    v_mfma_f32_32x32x16_bf16 v[176:191], v[56:59], v[248:251], v[176:191]
    s_waitcnt lgkmcnt(9)
    v_mfma_f32_32x32x16_bf16 v[192:207], v[60:63], v[248:251], v[192:207]
    s_waitcnt lgkmcnt(0)
    s_barrier
    ds_read_b128 v[224:227], v3 offset:33024
    ds_read_b64_tr_b16 v[48:49], v7 offset:33024
    ds_read_b64_tr_b16 v[50:51], v7 offset:33792
    ds_read_b64_tr_b16 v[52:53], v7 offset:33088
    ds_read_b64_tr_b16 v[54:55], v7 offset:33856
    ds_read_b64_tr_b16 v[56:57], v7 offset:33152
    ds_read_b64_tr_b16 v[58:59], v7 offset:33920
    v_mfma_f32_32x32x16_bf16 v[208:223], v[64:67], v[248:251], v[208:223]
    ds_read_b128 v[228:231], v4 offset:33024
    ds_read_b64_tr_b16 v[60:61], v7 offset:36096
    ds_read_b64_tr_b16 v[62:63], v7 offset:36864
    v_mfma_f32_32x32x16_bf16 v[176:191], v[68:71], v[252:255], v[176:191]
    ds_read_b64_tr_b16 v[64:65], v7 offset:36160
    ds_read_b64_tr_b16 v[66:67], v7 offset:36928
    v_mfma_f32_32x32x16_bf16 v[192:207], v[72:75], v[252:255], v[192:207]
    ds_read_b64_tr_b16 v[68:69], v7 offset:36224
    ds_read_b64_tr_b16 v[70:71], v7 offset:36992
    v_mfma_f32_32x32x16_bf16 v[208:223], v[76:79], v[252:255], v[208:223]
    ds_read_b128 v[232:235], v5 offset:33024
    ds_read_b64_tr_b16 v[72:73], v7 offset:39168
    ds_read_b64_tr_b16 v[74:75], v7 offset:39936
    s_waitcnt lgkmcnt(14)
    v_mfma_f32_32x32x16_bf16 v[176:191], v[48:51], v[224:227], v[176:191]
    ds_read_b64_tr_b16 v[76:77], v7 offset:39232
    ds_read_b64_tr_b16 v[78:79], v7 offset:40000
    s_waitcnt lgkmcnt(14)
    v_mfma_f32_32x32x16_bf16 v[192:207], v[52:55], v[224:227], v[192:207]
    ds_read_b64_tr_b16 v[48:49], v7 offset:39296
    ds_read_b64_tr_b16 v[50:51], v7 offset:40064
    s_waitcnt lgkmcnt(14)
    v_mfma_f32_32x32x16_bf16 v[208:223], v[56:59], v[224:227], v[208:223]
    ds_read_b128 v[236:239], v6 offset:33024
    ds_read_b64_tr_b16 v[52:53], v7 offset:42240
    ds_read_b64_tr_b16 v[54:55], v7 offset:43008
    s_waitcnt lgkmcnt(14)
    v_mfma_f32_32x32x16_bf16 v[176:191], v[60:63], v[228:231], v[176:191]
    ds_read_b64_tr_b16 v[56:57], v7 offset:42304
    ds_read_b64_tr_b16 v[58:59], v7 offset:43072
    s_waitcnt lgkmcnt(14)
    v_mfma_f32_32x32x16_bf16 v[192:207], v[64:67], v[228:231], v[192:207]
    ds_read_b64_tr_b16 v[60:61], v7 offset:42368
    ds_read_b64_tr_b16 v[62:63], v7 offset:43136
    s_waitcnt lgkmcnt(14)
    v_mfma_f32_32x32x16_bf16 v[208:223], v[68:71], v[228:231], v[208:223]
    s_waitcnt lgkmcnt(11)
    v_mfma_f32_32x32x16_bf16 v[176:191], v[72:75], v[232:235], v[176:191]
    s_waitcnt lgkmcnt(9)
    v_mfma_f32_32x32x16_bf16 v[192:207], v[76:79], v[232:235], v[192:207]
    v_add_u32 v3, 66048, v3
    v_add_u32 v4, 66048, v4
    v_add_u32 v5, 66048, v5
    v_add_u32 v6, 66048, v6
    v_add_u32 v7, 66048, v7
    s_waitcnt lgkmcnt(0)
    s_barrier
    ds_read_b128 v[240:243], v3 offset:0
    ds_read_b64_tr_b16 v[64:65], v7 offset:0
    ds_read_b64_tr_b16 v[66:67], v7 offset:768
    ds_read_b64_tr_b16 v[68:69], v7 offset:64
    ds_read_b64_tr_b16 v[70:71], v7 offset:832
    ds_read_b64_tr_b16 v[72:73], v7 offset:128
    ds_read_b64_tr_b16 v[74:75], v7 offset:896
    v_mfma_f32_32x32x16_bf16 v[208:223], v[48:51], v[232:235], v[208:223]
    ds_read_b128 v[244:247], v4 offset:0
    ds_read_b64_tr_b16 v[76:77], v7 offset:3072
    ds_read_b64_tr_b16 v[78:79], v7 offset:3840
    v_mfma_f32_32x32x16_bf16 v[176:191], v[52:55], v[236:239], v[176:191]
    ds_read_b64_tr_b16 v[48:49], v7 offset:3136
    ds_read_b64_tr_b16 v[50:51], v7 offset:3904
    v_mfma_f32_32x32x16_bf16 v[192:207], v[56:59], v[236:239], v[192:207]
    ds_read_b64_tr_b16 v[52:53], v7 offset:3200
    ds_read_b64_tr_b16 v[54:55], v7 offset:3968
    v_mfma_f32_32x32x16_bf16 v[208:223], v[60:63], v[236:239], v[208:223]
    ds_read_b128 v[248:251], v5 offset:0
    ds_read_b64_tr_b16 v[56:57], v7 offset:6144
    ds_read_b64_tr_b16 v[58:59], v7 offset:6912
    s_waitcnt lgkmcnt(14)
    v_mfma_f32_32x32x16_bf16 v[176:191], v[64:67], v[240:243], v[176:191]
    ds_read_b64_tr_b16 v[60:61], v7 offset:6208
    ds_read_b64_tr_b16 v[62:63], v7 offset:6976
    s_waitcnt lgkmcnt(14)
    v_mfma_f32_32x32x16_bf16 v[192:207], v[68:71], v[240:243], v[192:207]
    ds_read_b64_tr_b16 v[64:65], v7 offset:6272
    ds_read_b64_tr_b16 v[66:67], v7 offset:7040
    s_waitcnt lgkmcnt(14)
    v_mfma_f32_32x32x16_bf16 v[208:223], v[72:75], v[240:243], v[208:223]
    ds_read_b128 v[252:255], v6 offset:0
    ds_read_b64_tr_b16 v[68:69], v7 offset:9216
    ds_read_b64_tr_b16 v[70:71], v7 offset:9984
    s_waitcnt lgkmcnt(14)
    v_mfma_f32_32x32x16_bf16 v[176:191], v[76:79], v[244:247], v[176:191]
    ds_read_b64_tr_b16 v[72:73], v7 offset:9280
    ds_read_b64_tr_b16 v[74:75], v7 offset:10048
    s_waitcnt lgkmcnt(14)
    v_mfma_f32_32x32x16_bf16 v[192:207], v[48:51], v[244:247], v[192:207]
    ds_read_b64_tr_b16 v[76:77], v7 offset:9344
    ds_read_b64_tr_b16 v[78:79], v7 offset:10112
    s_waitcnt lgkmcnt(14)
    v_mfma_f32_32x32x16_bf16 v[208:223], v[52:55], v[244:247], v[208:223]
    s_waitcnt lgkmcnt(11)
    v_mfma_f32_32x32x16_bf16 v[176:191], v[56:59], v[248:251], v[176:191]
    s_waitcnt lgkmcnt(9)
    v_mfma_f32_32x32x16_bf16 v[192:207], v[60:63], v[248:251], v[192:207]
    s_waitcnt lgkmcnt(0)
    s_barrier
    ds_read_b128 v[224:227], v3 offset:33024
    ds_read_b64_tr_b16 v[48:49], v7 offset:33024
    ds_read_b64_tr_b16 v[50:51], v7 offset:33792
    ds_read_b64_tr_b16 v[52:53], v7 offset:33088
    ds_read_b64_tr_b16 v[54:55], v7 offset:33856
    ds_read_b64_tr_b16 v[56:57], v7 offset:33152
    ds_read_b64_tr_b16 v[58:59], v7 offset:33920
    v_mfma_f32_32x32x16_bf16 v[208:223], v[64:67], v[248:251], v[208:223]
    ds_read_b128 v[228:231], v4 offset:33024
    ds_read_b64_tr_b16 v[60:61], v7 offset:36096
    ds_read_b64_tr_b16 v[62:63], v7 offset:36864
    v_mfma_f32_32x32x16_bf16 v[176:191], v[68:71], v[252:255], v[176:191]
    ds_read_b64_tr_b16 v[64:65], v7 offset:36160
    ds_read_b64_tr_b16 v[66:67], v7 offset:36928
    v_mfma_f32_32x32x16_bf16 v[192:207], v[72:75], v[252:255], v[192:207]
    ds_read_b64_tr_b16 v[68:69], v7 offset:36224
    ds_read_b64_tr_b16 v[70:71], v7 offset:36992
    v_mfma_f32_32x32x16_bf16 v[208:223], v[76:79], v[252:255], v[208:223]
    ds_read_b128 v[232:235], v5 offset:33024
    ds_read_b64_tr_b16 v[72:73], v7 offset:39168
    ds_read_b64_tr_b16 v[74:75], v7 offset:39936
    s_waitcnt lgkmcnt(14)
    v_mfma_f32_32x32x16_bf16 v[176:191], v[48:51], v[224:227], v[176:191]
    ds_read_b64_tr_b16 v[76:77], v7 offset:39232
    ds_read_b64_tr_b16 v[78:79], v7 offset:40000
    s_waitcnt lgkmcnt(14)
    v_mfma_f32_32x32x16_bf16 v[192:207], v[52:55], v[224:227], v[192:207]
    ds_read_b64_tr_b16 v[48:49], v7 offset:39296
    ds_read_b64_tr_b16 v[50:51], v7 offset:40064
    s_waitcnt lgkmcnt(14)
    v_mfma_f32_32x32x16_bf16 v[208:223], v[56:59], v[224:227], v[208:223]
    ds_read_b128 v[236:239], v6 offset:33024
    ds_read_b64_tr_b16 v[52:53], v7 offset:42240
    ds_read_b64_tr_b16 v[54:55], v7 offset:43008
    s_waitcnt lgkmcnt(14)
    v_mfma_f32_32x32x16_bf16 v[176:191], v[60:63], v[228:231], v[176:191]
    ds_read_b64_tr_b16 v[56:57], v7 offset:42304
    ds_read_b64_tr_b16 v[58:59], v7 offset:43072
    s_waitcnt lgkmcnt(14)
    v_mfma_f32_32x32x16_bf16 v[192:207], v[64:67], v[228:231], v[192:207]
    ds_read_b64_tr_b16 v[60:61], v7 offset:42368
    ds_read_b64_tr_b16 v[62:63], v7 offset:43136
    s_waitcnt lgkmcnt(14)
    v_mfma_f32_32x32x16_bf16 v[208:223], v[68:71], v[228:231], v[208:223]
    s_waitcnt lgkmcnt(11)
    v_mfma_f32_32x32x16_bf16 v[176:191], v[72:75], v[232:235], v[176:191]
    s_waitcnt lgkmcnt(9)
    v_mfma_f32_32x32x16_bf16 v[192:207], v[76:79], v[232:235], v[192:207]
    v_subrev_u32 v3, 66048, v3
    v_subrev_u32 v4, 66048, v4
    v_subrev_u32 v5, 66048, v5
    v_subrev_u32 v6, 66048, v6
    v_subrev_u32 v7, 66048, v7
    s_waitcnt lgkmcnt(0)
    s_barrier
    s_setprio 2
    ds_read_b128 v[240:243], v3 offset:0
    ds_read_b64_tr_b16 v[64:65], v7 offset:64
    ds_read_b64_tr_b16 v[66:67], v7 offset:832
    ds_read_b128 v[244:247], v4 offset:0
    ds_read_b64_tr_b16 v[68:69], v7 offset:3136
    ds_read_b64_tr_b16 v[70:71], v7 offset:3904
    ds_read_b128 v[248:251], v5 offset:0
    ds_read_b64_tr_b16 v[72:73], v7 offset:6208
    ds_read_b64_tr_b16 v[74:75], v7 offset:6976
    v_mfma_f32_32x32x16_bf16 v[208:223], v[48:51], v[232:235], v[208:223]
    ds_read_b128 v[252:255], v6 offset:0
    ds_read_b64_tr_b16 v[76:77], v7 offset:9280
    ds_read_b64_tr_b16 v[78:79], v7 offset:10048
    v_mfma_f32_32x32x16_bf16 v[176:191], v[52:55], v[236:239], v[176:191]
    ds_read_b64_tr_b16 v[48:49], v7 offset:128
    ds_read_b64_tr_b16 v[50:51], v7 offset:896
    v_mfma_f32_32x32x16_bf16 v[192:207], v[56:59], v[236:239], v[192:207]
    ds_read_b64_tr_b16 v[52:53], v7 offset:3200
    ds_read_b64_tr_b16 v[54:55], v7 offset:3968
    v_mfma_f32_32x32x16_bf16 v[208:223], v[60:63], v[236:239], v[208:223]
    ds_read_b64_tr_b16 v[56:57], v7 offset:6272
    ds_read_b64_tr_b16 v[58:59], v7 offset:7040
    s_waitcnt lgkmcnt(15)
    v_mfma_f32_32x32x16_bf16 v[192:207], v[64:67], v[240:243], v[192:207]
    ds_read_b64_tr_b16 v[60:61], v7 offset:9344
    ds_read_b64_tr_b16 v[62:63], v7 offset:10112
    s_waitcnt lgkmcnt(14)
    v_mfma_f32_32x32x16_bf16 v[192:207], v[68:71], v[244:247], v[192:207]
    ds_read_b64_tr_b16 v[64:65], v7 offset:0
    ds_read_b64_tr_b16 v[66:67], v7 offset:768
    s_waitcnt lgkmcnt(13)
    v_mfma_f32_32x32x16_bf16 v[192:207], v[72:75], v[248:251], v[192:207]
    ds_read_b64_tr_b16 v[68:69], v7 offset:3072
    ds_read_b64_tr_b16 v[70:71], v7 offset:3840
    s_waitcnt lgkmcnt(12)
    v_mfma_f32_32x32x16_bf16 v[192:207], v[76:79], v[252:255], v[192:207]
    ds_read_b64_tr_b16 v[72:73], v7 offset:6144
    ds_read_b64_tr_b16 v[74:75], v7 offset:6912
    s_waitcnt lgkmcnt(12)
    v_mfma_f32_32x32x16_bf16 v[208:223], v[48:51], v[240:243], v[208:223]
    ds_read_b64_tr_b16 v[76:77], v7 offset:9216
    ds_read_b64_tr_b16 v[78:79], v7 offset:9984
    s_waitcnt lgkmcnt(12)
    v_mfma_f32_32x32x16_bf16 v[208:223], v[52:55], v[244:247], v[208:223]
    s_waitcnt lgkmcnt(0)
    s_mov_b64 exec, 1
    ds_add_u32 v144, v144 offset:12
    s_mov_b64 exec, -1
    v_mfma_f32_32x32x16_bf16 v[208:223], v[56:59], v[248:251], v[208:223]
    v_mfma_f32_32x32x16_bf16 v[208:223], v[60:63], v[252:255], v[208:223]
    ds_read_b32 v145, v144 offset:0
    v_mfma_f32_32x32x16_bf16 v[176:191], v[64:67], v[240:243], v[176:191]
    s_waitcnt lgkmcnt(0)
    v_cmp_ne_u32 vcc, 626944, v145
    s_nop 0
    s_cbranch_vccz L_eST_ok_145
L_eST_sl_146:
    ds_read_b32 v145, v144 offset:0
    s_waitcnt lgkmcnt(0)
    v_cmp_ne_u32 vcc, 626944, v145
    s_nop 0
    s_cbranch_vccnz L_eST_sl_146
L_eST_ok_145:
    ds_read_b32 v12, v98 offset:512
    ds_read_b128 v[20:23], v148 offset:0
    ds_read_b128 v[24:27], v148 offset:16
    ds_read_b32 v31, v98
    s_setprio 2
    v_mfma_f32_32x32x16_bf16 v[176:191], v[68:71], v[244:247], v[176:191]
    v_mfma_f32_32x32x16_bf16 v[176:191], v[72:75], v[248:251], v[176:191]
    v_mfma_f32_32x32x16_bf16 v[176:191], v[76:79], v[252:255], v[176:191]
    s_waitcnt lgkmcnt(0)
    v_cvt_pk_bf16_f32 v96, v12, v12
    v_and_b32 v96, 0xffff0000, v96
    v_sub_f32 v96, v12, v96
    v_cvt_pk_bf16_f32 v16, v12, v96
    v_mov_b32 v17, v16
    v_mul_f32 v8, 0x3eb8aa3b, v31
    s_nop 0
    v_mfma_f32_32x32x16_bf16 v[192:207], v[22:25], v[16:19], v[192:207]
    v_mfma_f32_32x32x16_bf16 v[208:223], v[24:27], v[16:19], v[208:223]
    s_nop 10
    v_mul_f32 v192, v192, v31
    v_mul_f32 v193, v193, v31
    v_mul_f32 v194, v194, v31
    v_mul_f32 v195, v195, v31
    v_mfma_f32_32x32x16_bf16 v[176:191], v[20:23], v[16:19], v[176:191]
    v_mul_f32 v196, v196, v31
    v_mul_f32 v197, v197, v31
    v_mul_f32 v198, v198, v31
    v_mul_f32 v199, v199, v31
    v_cvt_pk_bf16_f32 v192, v192, v193
    v_cvt_pk_bf16_f32 v193, v194, v195
    v_cvt_pk_bf16_f32 v194, v196, v197
    v_cvt_pk_bf16_f32 v195, v198, v199
    s_add_u32 s47, s12, 0
    buffer_store_dwordx4 v[192:195], v2, s[32:35], s47 offen sc1
    v_mul_f32 v200, v200, v31
    v_mul_f32 v201, v201, v31
    v_mul_f32 v202, v202, v31
    v_mul_f32 v203, v203, v31
    v_mul_f32 v204, v204, v31
    v_mul_f32 v205, v205, v31
    v_mul_f32 v206, v206, v31
    v_mul_f32 v207, v207, v31
    v_cvt_pk_bf16_f32 v200, v200, v201
    v_cvt_pk_bf16_f32 v201, v202, v203
    v_cvt_pk_bf16_f32 v202, v204, v205
    v_cvt_pk_bf16_f32 v203, v206, v207
    s_add_u32 s47, s12, 65536
    buffer_store_dwordx4 v[200:203], v2, s[32:35], s47 offen sc1
    v_mul_f32 v208, v208, v31
    v_mul_f32 v209, v209, v31
    v_mul_f32 v210, v210, v31
    v_mul_f32 v211, v211, v31
    v_mul_f32 v212, v212, v31
    v_mul_f32 v213, v213, v31
    v_mul_f32 v214, v214, v31
    v_mul_f32 v215, v215, v31
    v_cvt_pk_bf16_f32 v208, v208, v209
    v_cvt_pk_bf16_f32 v209, v210, v211
    v_cvt_pk_bf16_f32 v210, v212, v213
    v_cvt_pk_bf16_f32 v211, v214, v215
    s_add_u32 s47, s12, 131072
    buffer_store_dwordx4 v[208:211], v2, s[32:35], s47 offen sc1
    v_mul_f32 v216, v216, v31
    v_mul_f32 v217, v217, v31
    v_mul_f32 v218, v218, v31
    v_mul_f32 v219, v219, v31
    v_mul_f32 v220, v220, v31
    v_mul_f32 v221, v221, v31
    v_mul_f32 v222, v222, v31
    v_mul_f32 v223, v223, v31
    v_cvt_pk_bf16_f32 v216, v216, v217
    v_cvt_pk_bf16_f32 v217, v218, v219
    v_cvt_pk_bf16_f32 v218, v220, v221
    v_cvt_pk_bf16_f32 v219, v222, v223
    s_add_u32 s47, s12, 196608
    buffer_store_dwordx4 v[216:219], v2, s[32:35], s47 offen sc1
    v_mul_f32 v176, v176, v8
    v_mul_f32 v177, v177, v8
    v_mul_f32 v178, v178, v8
    v_mul_f32 v179, v179, v8
    v_mul_f32 v180, v180, v8
    v_mul_f32 v181, v181, v8
    v_mul_f32 v182, v182, v8
    v_mul_f32 v183, v183, v8
    v_cvt_pk_bf16_f32 v176, v176, v177
    v_cvt_pk_bf16_f32 v177, v178, v179
    v_cvt_pk_bf16_f32 v178, v180, v181
    v_cvt_pk_bf16_f32 v179, v182, v183
    s_add_u32 s47, s16, 0
    buffer_store_dwordx4 v[176:179], v2, s[32:35], s47 offen sc1
    v_mul_f32 v184, v184, v8
    v_mul_f32 v185, v185, v8
    v_mul_f32 v186, v186, v8
    v_mul_f32 v187, v187, v8
    v_mul_f32 v188, v188, v8
    v_mul_f32 v189, v189, v8
    v_mul_f32 v190, v190, v8
    v_mul_f32 v191, v191, v8
    v_cvt_pk_bf16_f32 v184, v184, v185
    v_cvt_pk_bf16_f32 v185, v186, v187
    v_cvt_pk_bf16_f32 v186, v188, v189
    v_cvt_pk_bf16_f32 v187, v190, v191
    s_add_u32 s47, s16, 65536
    buffer_store_dwordx4 v[184:187], v2, s[32:35], s47 offen sc1
    v_mov_b32 v172, v2
    s_branch L_T_c
L_T_v:
    s_mov_b32 s65, s63
    s_and_b32 s47, s43, 3
    s_lshl_b32 s47, s47, 16
    s_add_u32 s52, s63, s47
    s_lshr_b32 s47, s43, 2
    s_xor_b32 s47, s47, s44
    s_bitcmp0_b32 s47, 0
    s_cselect_b32 s52, s52, 1073741824
    s_add_u32 s47, s52, 2097152
    buffer_store_dwordx4 v[154:157], v2, s[32:35], s47 offen sc1
    s_add_u32 s47, s52, 4194304
    buffer_store_dwordx4 v[154:157], v2, s[32:35], s47 offen sc1
    v_lshrrev_b32 v96, 5, v1
    v_lshlrev_b32 v96, 3, v96
    v_bfe_u32 v97, v1, 2, 2
    v_add_u32 v96, v96, v97
    v_bfe_u32 v98, v1, 4, 1
    v_and_b32 v99, 3, v1
    v_lshlrev_b32 v99, 3, v99
    v_mul_u32_u24 v7, 192, v96
    v_lshl_add_u32 v7, v98, 5, v7
    v_add_u32 v7, v7, v99
    v_add_u32 v7, 16384, v7
    v_and_b32 v96, 31, v1
    v_lshrrev_b32 v97, 5, v1
    s_lshl_b32 s50, s45, 7
    s_add_u32 s50, s50, 161088
    v_lshl_add_u32 v98, v96, 2, s50
    v_lshl_add_u32 v99, v97, 4, s50
    v_bfe_u32 v30, v1, 4, 1
    v_lshlrev_b32 v30, 16, v30
    v_lshl_add_u32 v30, v97, 8, v30
    v_and_b32 v97, 15, v1
    v_lshl_add_u32 v30, v97, 4, v30
    s_add_u32 s13, s63, 4194304
    s_lshr_b32 s50, s43, 2
    s_xor_b32 s50, s50, s44
    s_and_b32 s50, s50, 1
    s_cselect_b32 s12, 1073741824, s13
    s_cselect_b32 s13, s13, 1073741824
    s_cselect_b32 s15, 1073741824, 0
    s_cselect_b32 s36, 0, 1073741824
    s_mov_b32 s14, 512
    v_lshlrev_b32 v148, 5, v1
    v_add_u32 v148, 156992, v148
    s_mov_b32 s47, 0x9e3779b1
    s_waitcnt vmcnt(2)
    v_mul_lo_u32 v158, v11, s47
    v_add_u32 v158, 0x7f4a7c15, v158
    s_nop 0
    v_readfirstlane_b32 s58, v158
    s_waitcnt lgkmcnt(0)
    s_barrier
    ds_read_b128 v[224:227], v3 offset:33024
    ds_read_b64_tr_b16 v[48:49], v7 offset:33024
    ds_read_b64_tr_b16 v[50:51], v7 offset:33792
    ds_read_b64_tr_b16 v[52:53], v7 offset:33088
    ds_read_b64_tr_b16 v[54:55], v7 offset:33856
    ds_read_b64_tr_b16 v[56:57], v7 offset:33152
    ds_read_b64_tr_b16 v[58:59], v7 offset:33920
    ds_read_b128 v[228:231], v4 offset:33024
    ds_read_b64_tr_b16 v[60:61], v7 offset:36096
    ds_read_b64_tr_b16 v[62:63], v7 offset:36864
    ds_read_b64_tr_b16 v[64:65], v7 offset:36160
    ds_read_b64_tr_b16 v[66:67], v7 offset:36928
    ds_read_b64_tr_b16 v[68:69], v7 offset:36224
    ds_read_b64_tr_b16 v[70:71], v7 offset:36992
    ds_read_b128 v[232:235], v5 offset:33024
    ds_read_b64_tr_b16 v[72:73], v7 offset:39168
    ds_read_b64_tr_b16 v[74:75], v7 offset:39936
    s_waitcnt lgkmcnt(14)
    v_mfma_f32_32x32x16_bf16 v[176:191], v[48:51], v[224:227], 0
    s_add_u32 s47, s65, 0
    buffer_store_dwordx4 v[154:157], v2, s[32:35], s47 offen sc1
    ds_read_b64_tr_b16 v[76:77], v7 offset:39232
    ds_read_b64_tr_b16 v[78:79], v7 offset:40000
    s_waitcnt lgkmcnt(14)
    v_mfma_f32_32x32x16_bf16 v[192:207], v[224:227], v[52:55], 0
    s_add_u32 s47, s65, 65536
    buffer_store_dwordx4 v[154:157], v2, s[32:35], s47 offen sc1
    ds_read_b64_tr_b16 v[48:49], v7 offset:39296
    ds_read_b64_tr_b16 v[50:51], v7 offset:40064
    s_waitcnt lgkmcnt(14)
    v_mfma_f32_32x32x16_bf16 v[208:223], v[224:227], v[56:59], 0
    s_add_u32 s47, s65, 131072
    buffer_store_dwordx4 v[154:157], v2, s[32:35], s47 offen sc1
    ds_read_b128 v[236:239], v6 offset:33024
    ds_read_b64_tr_b16 v[52:53], v7 offset:42240
    ds_read_b64_tr_b16 v[54:55], v7 offset:43008
    s_waitcnt lgkmcnt(14)
    v_mfma_f32_32x32x16_bf16 v[176:191], v[60:63], v[228:231], v[176:191]
    s_add_u32 s47, s65, 196608
    buffer_store_dwordx4 v[154:157], v2, s[32:35], s47 offen sc1
    ds_read_b64_tr_b16 v[56:57], v7 offset:42304
    ds_read_b64_tr_b16 v[58:59], v7 offset:43072
    s_waitcnt lgkmcnt(14)
    v_mfma_f32_32x32x16_bf16 v[192:207], v[228:231], v[64:67], v[192:207]
    ds_read_b64_tr_b16 v[60:61], v7 offset:42368
    ds_read_b64_tr_b16 v[62:63], v7 offset:43136
    s_waitcnt lgkmcnt(14)
    v_mfma_f32_32x32x16_bf16 v[208:223], v[228:231], v[68:71], v[208:223]
    s_waitcnt lgkmcnt(11)
    v_mfma_f32_32x32x16_bf16 v[176:191], v[72:75], v[232:235], v[176:191]
    s_waitcnt lgkmcnt(9)
    v_mfma_f32_32x32x16_bf16 v[192:207], v[232:235], v[76:79], v[192:207]
    v_add_u32 v3, 66048, v3
    v_add_u32 v4, 66048, v4
    v_add_u32 v5, 66048, v5
    v_add_u32 v6, 66048, v6
    v_add_u32 v7, 66048, v7
    s_waitcnt lgkmcnt(0)
    s_barrier
    ds_read_b128 v[240:243], v3 offset:0
    ds_read_b64_tr_b16 v[64:65], v7 offset:0
    ds_read_b64_tr_b16 v[66:67], v7 offset:768
    ds_read_b64_tr_b16 v[68:69], v7 offset:64
    ds_read_b64_tr_b16 v[70:71], v7 offset:832
    ds_read_b64_tr_b16 v[72:73], v7 offset:128
    ds_read_b64_tr_b16 v[74:75], v7 offset:896
    v_mfma_f32_32x32x16_bf16 v[208:223], v[232:235], v[48:51], v[208:223]
    s_waitcnt vmcnt(0)
    buffer_store_dword v158, v146, s[32:35], 0 offen offset:2048 sc1
    ds_read_b128 v[244:247], v4 offset:0
    ds_read_b64_tr_b16 v[76:77], v7 offset:3072
    ds_read_b64_tr_b16 v[78:79], v7 offset:3840
    v_mfma_f32_32x32x16_bf16 v[176:191], v[52:55], v[236:239], v[176:191]
    ds_read_b64_tr_b16 v[48:49], v7 offset:3136
    ds_read_b64_tr_b16 v[50:51], v7 offset:3904
    v_mfma_f32_32x32x16_bf16 v[192:207], v[236:239], v[56:59], v[192:207]
    ds_read_b64_tr_b16 v[52:53], v7 offset:3200
    ds_read_b64_tr_b16 v[54:55], v7 offset:3968
    v_mfma_f32_32x32x16_bf16 v[208:223], v[236:239], v[60:63], v[208:223]
    ds_read_b128 v[248:251], v5 offset:0
    ds_read_b64_tr_b16 v[56:57], v7 offset:6144
    ds_read_b64_tr_b16 v[58:59], v7 offset:6912
    s_waitcnt lgkmcnt(14)
    v_mfma_f32_32x32x16_bf16 v[176:191], v[64:67], v[240:243], v[176:191]
    ds_read_b64_tr_b16 v[60:61], v7 offset:6208
    ds_read_b64_tr_b16 v[62:63], v7 offset:6976
    s_waitcnt lgkmcnt(14)
    v_mfma_f32_32x32x16_bf16 v[192:207], v[240:243], v[68:71], v[192:207]
    ds_read_b64_tr_b16 v[64:65], v7 offset:6272
    ds_read_b64_tr_b16 v[66:67], v7 offset:7040
    s_waitcnt lgkmcnt(14)
    v_mfma_f32_32x32x16_bf16 v[208:223], v[240:243], v[72:75], v[208:223]
    ds_read_b128 v[252:255], v6 offset:0
    ds_read_b64_tr_b16 v[68:69], v7 offset:9216
    ds_read_b64_tr_b16 v[70:71], v7 offset:9984
    s_waitcnt lgkmcnt(14)
    v_mfma_f32_32x32x16_bf16 v[176:191], v[76:79], v[244:247], v[176:191]
    ds_read_b64_tr_b16 v[72:73], v7 offset:9280
    ds_read_b64_tr_b16 v[74:75], v7 offset:10048
    s_waitcnt lgkmcnt(14)
    v_mfma_f32_32x32x16_bf16 v[192:207], v[244:247], v[48:51], v[192:207]
    ds_read_b64_tr_b16 v[76:77], v7 offset:9344
    ds_read_b64_tr_b16 v[78:79], v7 offset:10112
    s_waitcnt lgkmcnt(14)
    v_mfma_f32_32x32x16_bf16 v[208:223], v[244:247], v[52:55], v[208:223]
    s_waitcnt lgkmcnt(11)
    v_mfma_f32_32x32x16_bf16 v[176:191], v[56:59], v[248:251], v[176:191]
    s_waitcnt lgkmcnt(9)
    v_mfma_f32_32x32x16_bf16 v[192:207], v[248:251], v[60:63], v[192:207]
    s_waitcnt lgkmcnt(0)
    s_barrier
    ds_read_b128 v[224:227], v3 offset:33024
    ds_read_b64_tr_b16 v[48:49], v7 offset:33024
    ds_read_b64_tr_b16 v[50:51], v7 offset:33792
    ds_read_b64_tr_b16 v[52:53], v7 offset:33088
    ds_read_b64_tr_b16 v[54:55], v7 offset:33856
    ds_read_b64_tr_b16 v[56:57], v7 offset:33152
    ds_read_b64_tr_b16 v[58:59], v7 offset:33920
    v_mfma_f32_32x32x16_bf16 v[208:223], v[248:251], v[64:67], v[208:223]
    ds_read_b128 v[228:231], v4 offset:33024
    ds_read_b64_tr_b16 v[60:61], v7 offset:36096
    ds_read_b64_tr_b16 v[62:63], v7 offset:36864
    v_mfma_f32_32x32x16_bf16 v[176:191], v[68:71], v[252:255], v[176:191]
    ds_read_b64_tr_b16 v[64:65], v7 offset:36160
    ds_read_b64_tr_b16 v[66:67], v7 offset:36928
    v_mfma_f32_32x32x16_bf16 v[192:207], v[252:255], v[72:75], v[192:207]
    ds_read_b64_tr_b16 v[68:69], v7 offset:36224
    ds_read_b64_tr_b16 v[70:71], v7 offset:36992
    v_mfma_f32_32x32x16_bf16 v[208:223], v[252:255], v[76:79], v[208:223]
    ds_read_b128 v[232:235], v5 offset:33024
    ds_read_b64_tr_b16 v[72:73], v7 offset:39168
    ds_read_b64_tr_b16 v[74:75], v7 offset:39936
    s_waitcnt lgkmcnt(14)
    v_mfma_f32_32x32x16_bf16 v[176:191], v[48:51], v[224:227], v[176:191]
    ds_read_b64_tr_b16 v[76:77], v7 offset:39232
    ds_read_b64_tr_b16 v[78:79], v7 offset:40000
    s_waitcnt lgkmcnt(14)
    v_mfma_f32_32x32x16_bf16 v[192:207], v[224:227], v[52:55], v[192:207]
    ds_read_b64_tr_b16 v[48:49], v7 offset:39296
    ds_read_b64_tr_b16 v[50:51], v7 offset:40064
    s_waitcnt lgkmcnt(14)
    v_mfma_f32_32x32x16_bf16 v[208:223], v[224:227], v[56:59], v[208:223]
    ds_read_b128 v[236:239], v6 offset:33024
    ds_read_b64_tr_b16 v[52:53], v7 offset:42240
    ds_read_b64_tr_b16 v[54:55], v7 offset:43008
    s_waitcnt lgkmcnt(14)
    v_mfma_f32_32x32x16_bf16 v[176:191], v[60:63], v[228:231], v[176:191]
    ds_read_b64_tr_b16 v[56:57], v7 offset:42304
    ds_read_b64_tr_b16 v[58:59], v7 offset:43072
    s_waitcnt lgkmcnt(14)
    v_mfma_f32_32x32x16_bf16 v[192:207], v[228:231], v[64:67], v[192:207]
    ds_read_b64_tr_b16 v[60:61], v7 offset:42368
    ds_read_b64_tr_b16 v[62:63], v7 offset:43136
    s_waitcnt lgkmcnt(14)
    v_mfma_f32_32x32x16_bf16 v[208:223], v[228:231], v[68:71], v[208:223]
    s_waitcnt lgkmcnt(11)
    v_mfma_f32_32x32x16_bf16 v[176:191], v[72:75], v[232:235], v[176:191]
    s_waitcnt lgkmcnt(9)
    v_mfma_f32_32x32x16_bf16 v[192:207], v[232:235], v[76:79], v[192:207]
    v_subrev_u32 v3, 66048, v3
    v_subrev_u32 v4, 66048, v4
    v_subrev_u32 v5, 66048, v5
    v_subrev_u32 v6, 66048, v6
    v_subrev_u32 v7, 66048, v7
    s_waitcnt lgkmcnt(0)
    s_barrier
    ds_read_b128 v[240:243], v3 offset:0
    ds_read_b64_tr_b16 v[64:65], v7 offset:0
    ds_read_b64_tr_b16 v[66:67], v7 offset:768
    ds_read_b64_tr_b16 v[68:69], v7 offset:64
    ds_read_b64_tr_b16 v[70:71], v7 offset:832
    ds_read_b64_tr_b16 v[72:73], v7 offset:128
    ds_read_b64_tr_b16 v[74:75], v7 offset:896
    v_mfma_f32_32x32x16_bf16 v[208:223], v[232:235], v[48:51], v[208:223]
    ds_read_b128 v[244:247], v4 offset:0
    ds_read_b64_tr_b16 v[76:77], v7 offset:3072
    ds_read_b64_tr_b16 v[78:79], v7 offset:3840
    v_mfma_f32_32x32x16_bf16 v[176:191], v[52:55], v[236:239], v[176:191]
    ds_read_b64_tr_b16 v[48:49], v7 offset:3136
    ds_read_b64_tr_b16 v[50:51], v7 offset:3904
    v_mfma_f32_32x32x16_bf16 v[192:207], v[236:239], v[56:59], v[192:207]
    ds_read_b64_tr_b16 v[52:53], v7 offset:3200
    ds_read_b64_tr_b16 v[54:55], v7 offset:3968
    v_mfma_f32_32x32x16_bf16 v[208:223], v[236:239], v[60:63], v[208:223]
    ds_read_b128 v[248:251], v5 offset:0
    ds_read_b64_tr_b16 v[56:57], v7 offset:6144
    ds_read_b64_tr_b16 v[58:59], v7 offset:6912
    s_waitcnt lgkmcnt(14)
    v_mfma_f32_32x32x16_bf16 v[176:191], v[64:67], v[240:243], v[176:191]
    ds_read_b64_tr_b16 v[60:61], v7 offset:6208
    ds_read_b64_tr_b16 v[62:63], v7 offset:6976
    s_waitcnt lgkmcnt(14)
    v_mfma_f32_32x32x16_bf16 v[192:207], v[240:243], v[68:71], v[192:207]
    ds_read_b64_tr_b16 v[64:65], v7 offset:6272
    ds_read_b64_tr_b16 v[66:67], v7 offset:7040
    s_waitcnt lgkmcnt(14)
    v_mfma_f32_32x32x16_bf16 v[208:223], v[240:243], v[72:75], v[208:223]
    ds_read_b128 v[252:255], v6 offset:0
    ds_read_b64_tr_b16 v[68:69], v7 offset:9216
    ds_read_b64_tr_b16 v[70:71], v7 offset:9984
    s_waitcnt lgkmcnt(14)
    v_mfma_f32_32x32x16_bf16 v[176:191], v[76:79], v[244:247], v[176:191]
    ds_read_b64_tr_b16 v[72:73], v7 offset:9280
    ds_read_b64_tr_b16 v[74:75], v7 offset:10048
    s_waitcnt lgkmcnt(14)
    v_mfma_f32_32x32x16_bf16 v[192:207], v[244:247], v[48:51], v[192:207]
    ds_read_b64_tr_b16 v[76:77], v7 offset:9344
    ds_read_b64_tr_b16 v[78:79], v7 offset:10112
    s_waitcnt lgkmcnt(14)
    v_mfma_f32_32x32x16_bf16 v[208:223], v[244:247], v[52:55], v[208:223]
    s_waitcnt lgkmcnt(11)
    v_mfma_f32_32x32x16_bf16 v[176:191], v[56:59], v[248:251], v[176:191]
    s_waitcnt lgkmcnt(9)
    v_mfma_f32_32x32x16_bf16 v[192:207], v[248:251], v[60:63], v[192:207]
    s_waitcnt lgkmcnt(0)
    s_barrier
    ds_read_b128 v[224:227], v3 offset:33024
    ds_read_b64_tr_b16 v[48:49], v7 offset:33024
    ds_read_b64_tr_b16 v[50:51], v7 offset:33792
    ds_read_b64_tr_b16 v[52:53], v7 offset:33088
    ds_read_b64_tr_b16 v[54:55], v7 offset:33856
    ds_read_b64_tr_b16 v[56:57], v7 offset:33152
    ds_read_b64_tr_b16 v[58:59], v7 offset:33920
    v_mfma_f32_32x32x16_bf16 v[208:223], v[248:251], v[64:67], v[208:223]
    ds_read_b128 v[228:231], v4 offset:33024
    ds_read_b64_tr_b16 v[60:61], v7 offset:36096
    ds_read_b64_tr_b16 v[62:63], v7 offset:36864
    v_mfma_f32_32x32x16_bf16 v[176:191], v[68:71], v[252:255], v[176:191]
    ds_read_b64_tr_b16 v[64:65], v7 offset:36160
    ds_read_b64_tr_b16 v[66:67], v7 offset:36928
    v_mfma_f32_32x32x16_bf16 v[192:207], v[252:255], v[72:75], v[192:207]
    ds_read_b64_tr_b16 v[68:69], v7 offset:36224
    ds_read_b64_tr_b16 v[70:71], v7 offset:36992
    v_mfma_f32_32x32x16_bf16 v[208:223], v[252:255], v[76:79], v[208:223]
    ds_read_b128 v[232:235], v5 offset:33024
    ds_read_b64_tr_b16 v[72:73], v7 offset:39168
    ds_read_b64_tr_b16 v[74:75], v7 offset:39936
    s_waitcnt lgkmcnt(14)
    v_mfma_f32_32x32x16_bf16 v[176:191], v[48:51], v[224:227], v[176:191]
    ds_read_b64_tr_b16 v[76:77], v7 offset:39232
    ds_read_b64_tr_b16 v[78:79], v7 offset:40000
    s_waitcnt lgkmcnt(14)
    v_mfma_f32_32x32x16_bf16 v[192:207], v[224:227], v[52:55], v[192:207]
    ds_read_b64_tr_b16 v[48:49], v7 offset:39296
    ds_read_b64_tr_b16 v[50:51], v7 offset:40064
    s_waitcnt lgkmcnt(14)
    v_mfma_f32_32x32x16_bf16 v[208:223], v[224:227], v[56:59], v[208:223]
    ds_read_b128 v[236:239], v6 offset:33024
    ds_read_b64_tr_b16 v[52:53], v7 offset:42240
    ds_read_b64_tr_b16 v[54:55], v7 offset:43008
    s_waitcnt lgkmcnt(14)
    v_mfma_f32_32x32x16_bf16 v[176:191], v[60:63], v[228:231], v[176:191]
    ds_read_b64_tr_b16 v[56:57], v7 offset:42304
    ds_read_b64_tr_b16 v[58:59], v7 offset:43072
    s_waitcnt lgkmcnt(14)
    v_mfma_f32_32x32x16_bf16 v[192:207], v[228:231], v[64:67], v[192:207]
    ds_read_b64_tr_b16 v[60:61], v7 offset:42368
    ds_read_b64_tr_b16 v[62:63], v7 offset:43136
    s_waitcnt lgkmcnt(14)
    v_mfma_f32_32x32x16_bf16 v[208:223], v[228:231], v[68:71], v[208:223]
    s_waitcnt lgkmcnt(11)
    v_mfma_f32_32x32x16_bf16 v[176:191], v[72:75], v[232:235], v[176:191]
    s_waitcnt lgkmcnt(9)
    v_mfma_f32_32x32x16_bf16 v[192:207], v[232:235], v[76:79], v[192:207]
    v_add_u32 v3, 66048, v3
    v_add_u32 v4, 66048, v4
    v_add_u32 v5, 66048, v5
    v_add_u32 v6, 66048, v6
    v_add_u32 v7, 66048, v7
    s_waitcnt lgkmcnt(0)
    s_barrier
    ds_read_b128 v[240:243], v3 offset:0
    ds_read_b64_tr_b16 v[64:65], v7 offset:0
    ds_read_b64_tr_b16 v[66:67], v7 offset:768
    ds_read_b64_tr_b16 v[68:69], v7 offset:64
    ds_read_b64_tr_b16 v[70:71], v7 offset:832
    ds_read_b64_tr_b16 v[72:73], v7 offset:128
    ds_read_b64_tr_b16 v[74:75], v7 offset:896
    v_mfma_f32_32x32x16_bf16 v[208:223], v[232:235], v[48:51], v[208:223]
    ds_read_b128 v[244:247], v4 offset:0
    ds_read_b64_tr_b16 v[76:77], v7 offset:3072
    ds_read_b64_tr_b16 v[78:79], v7 offset:3840
    v_mfma_f32_32x32x16_bf16 v[176:191], v[52:55], v[236:239], v[176:191]
    ds_read_b64_tr_b16 v[48:49], v7 offset:3136
    ds_read_b64_tr_b16 v[50:51], v7 offset:3904
    v_mfma_f32_32x32x16_bf16 v[192:207], v[236:239], v[56:59], v[192:207]
    ds_read_b64_tr_b16 v[52:53], v7 offset:3200
    ds_read_b64_tr_b16 v[54:55], v7 offset:3968
    v_mfma_f32_32x32x16_bf16 v[208:223], v[236:239], v[60:63], v[208:223]
    ds_read_b128 v[248:251], v5 offset:0
    ds_read_b64_tr_b16 v[56:57], v7 offset:6144
    ds_read_b64_tr_b16 v[58:59], v7 offset:6912
    s_waitcnt lgkmcnt(14)
    v_mfma_f32_32x32x16_bf16 v[176:191], v[64:67], v[240:243], v[176:191]
    ds_read_b64_tr_b16 v[60:61], v7 offset:6208
    ds_read_b64_tr_b16 v[62:63], v7 offset:6976
    s_waitcnt lgkmcnt(14)
    v_mfma_f32_32x32x16_bf16 v[192:207], v[240:243], v[68:71], v[192:207]
    ds_read_b64_tr_b16 v[64:65], v7 offset:6272
    ds_read_b64_tr_b16 v[66:67], v7 offset:7040
    s_waitcnt lgkmcnt(14)
    v_mfma_f32_32x32x16_bf16 v[208:223], v[240:243], v[72:75], v[208:223]
    ds_read_b128 v[252:255], v6 offset:0
    ds_read_b64_tr_b16 v[68:69], v7 offset:9216
    ds_read_b64_tr_b16 v[70:71], v7 offset:9984
    s_waitcnt lgkmcnt(14)
    v_mfma_f32_32x32x16_bf16 v[176:191], v[76:79], v[244:247], v[176:191]
    ds_read_b64_tr_b16 v[72:73], v7 offset:9280
    ds_read_b64_tr_b16 v[74:75], v7 offset:10048
    s_waitcnt lgkmcnt(14)
    v_mfma_f32_32x32x16_bf16 v[192:207], v[244:247], v[48:51], v[192:207]
    ds_read_b64_tr_b16 v[76:77], v7 offset:9344
    ds_read_b64_tr_b16 v[78:79], v7 offset:10112
    s_waitcnt lgkmcnt(14)
    v_mfma_f32_32x32x16_bf16 v[208:223], v[244:247], v[52:55], v[208:223]
    s_waitcnt lgkmcnt(11)
    v_mfma_f32_32x32x16_bf16 v[176:191], v[56:59], v[248:251], v[176:191]
    s_waitcnt lgkmcnt(9)
    v_mfma_f32_32x32x16_bf16 v[192:207], v[248:251], v[60:63], v[192:207]
    s_waitcnt lgkmcnt(0)
    s_barrier
    ds_read_b128 v[224:227], v3 offset:33024
    ds_read_b64_tr_b16 v[48:49], v7 offset:33024
    ds_read_b64_tr_b16 v[50:51], v7 offset:33792
    ds_read_b64_tr_b16 v[52:53], v7 offset:33088
    ds_read_b64_tr_b16 v[54:55], v7 offset:33856
    ds_read_b64_tr_b16 v[56:57], v7 offset:33152
    ds_read_b64_tr_b16 v[58:59], v7 offset:33920
    v_mfma_f32_32x32x16_bf16 v[208:223], v[248:251], v[64:67], v[208:223]
    ds_read_b128 v[228:231], v4 offset:33024
    ds_read_b64_tr_b16 v[60:61], v7 offset:36096
    ds_read_b64_tr_b16 v[62:63], v7 offset:36864
    v_mfma_f32_32x32x16_bf16 v[176:191], v[68:71], v[252:255], v[176:191]
    ds_read_b64_tr_b16 v[64:65], v7 offset:36160
    ds_read_b64_tr_b16 v[66:67], v7 offset:36928
    v_mfma_f32_32x32x16_bf16 v[192:207], v[252:255], v[72:75], v[192:207]
    ds_read_b64_tr_b16 v[68:69], v7 offset:36224
    ds_read_b64_tr_b16 v[70:71], v7 offset:36992
    v_mfma_f32_32x32x16_bf16 v[208:223], v[252:255], v[76:79], v[208:223]
    ds_read_b128 v[232:235], v5 offset:33024
    ds_read_b64_tr_b16 v[72:73], v7 offset:39168
    ds_read_b64_tr_b16 v[74:75], v7 offset:39936
    s_waitcnt lgkmcnt(14)
    v_mfma_f32_32x32x16_bf16 v[176:191], v[48:51], v[224:227], v[176:191]
    ds_read_b64_tr_b16 v[76:77], v7 offset:39232
    ds_read_b64_tr_b16 v[78:79], v7 offset:40000
    s_waitcnt lgkmcnt(14)
    v_mfma_f32_32x32x16_bf16 v[192:207], v[224:227], v[52:55], v[192:207]
    ds_read_b64_tr_b16 v[48:49], v7 offset:39296
    ds_read_b64_tr_b16 v[50:51], v7 offset:40064
    s_waitcnt lgkmcnt(14)
    v_mfma_f32_32x32x16_bf16 v[208:223], v[224:227], v[56:59], v[208:223]
    ds_read_b128 v[236:239], v6 offset:33024
    ds_read_b64_tr_b16 v[52:53], v7 offset:42240
    ds_read_b64_tr_b16 v[54:55], v7 offset:43008
    s_waitcnt lgkmcnt(14)
    v_mfma_f32_32x32x16_bf16 v[176:191], v[60:63], v[228:231], v[176:191]
    ds_read_b64_tr_b16 v[56:57], v7 offset:42304
    ds_read_b64_tr_b16 v[58:59], v7 offset:43072
    s_waitcnt lgkmcnt(14)
    v_mfma_f32_32x32x16_bf16 v[192:207], v[228:231], v[64:67], v[192:207]
    ds_read_b64_tr_b16 v[60:61], v7 offset:42368
    ds_read_b64_tr_b16 v[62:63], v7 offset:43136
    s_waitcnt lgkmcnt(14)
    v_mfma_f32_32x32x16_bf16 v[208:223], v[228:231], v[68:71], v[208:223]
    s_waitcnt lgkmcnt(11)
    v_mfma_f32_32x32x16_bf16 v[176:191], v[72:75], v[232:235], v[176:191]
    s_waitcnt lgkmcnt(9)
    v_mfma_f32_32x32x16_bf16 v[192:207], v[232:235], v[76:79], v[192:207]
    v_subrev_u32 v3, 66048, v3
    v_subrev_u32 v4, 66048, v4
    v_subrev_u32 v5, 66048, v5
    v_subrev_u32 v6, 66048, v6
    v_subrev_u32 v7, 66048, v7
    s_waitcnt lgkmcnt(0)
    s_barrier
    s_setprio 2
    ds_read_b128 v[240:243], v3 offset:0
    ds_read_b64_tr_b16 v[64:65], v7 offset:64
    ds_read_b64_tr_b16 v[66:67], v7 offset:832
    ds_read_b128 v[244:247], v4 offset:0
    ds_read_b64_tr_b16 v[68:69], v7 offset:3136
    ds_read_b64_tr_b16 v[70:71], v7 offset:3904
    ds_read_b128 v[248:251], v5 offset:0
    ds_read_b64_tr_b16 v[72:73], v7 offset:6208
    ds_read_b64_tr_b16 v[74:75], v7 offset:6976
    v_mfma_f32_32x32x16_bf16 v[208:223], v[232:235], v[48:51], v[208:223]
    ds_read_b128 v[252:255], v6 offset:0
    ds_read_b64_tr_b16 v[76:77], v7 offset:9280
    ds_read_b64_tr_b16 v[78:79], v7 offset:10048
    v_mfma_f32_32x32x16_bf16 v[176:191], v[52:55], v[236:239], v[176:191]
    ds_read_b64_tr_b16 v[48:49], v7 offset:128
    ds_read_b64_tr_b16 v[50:51], v7 offset:896
    v_mfma_f32_32x32x16_bf16 v[192:207], v[236:239], v[56:59], v[192:207]
    ds_read_b64_tr_b16 v[52:53], v7 offset:3200
    ds_read_b64_tr_b16 v[54:55], v7 offset:3968
    v_mfma_f32_32x32x16_bf16 v[208:223], v[236:239], v[60:63], v[208:223]
    ds_read_b64_tr_b16 v[56:57], v7 offset:6272
    ds_read_b64_tr_b16 v[58:59], v7 offset:7040
    s_waitcnt lgkmcnt(15)
    v_mfma_f32_32x32x16_bf16 v[192:207], v[240:243], v[64:67], v[192:207]
    ds_read_b64_tr_b16 v[60:61], v7 offset:9344
    ds_read_b64_tr_b16 v[62:63], v7 offset:10112
    s_waitcnt lgkmcnt(14)
    v_mfma_f32_32x32x16_bf16 v[192:207], v[244:247], v[68:71], v[192:207]
    ds_read_b64_tr_b16 v[64:65], v7 offset:0
    ds_read_b64_tr_b16 v[66:67], v7 offset:768
    s_waitcnt lgkmcnt(13)
    v_mfma_f32_32x32x16_bf16 v[192:207], v[248:251], v[72:75], v[192:207]
    ds_read_b64_tr_b16 v[68:69], v7 offset:3072
    ds_read_b64_tr_b16 v[70:71], v7 offset:3840
    s_waitcnt lgkmcnt(12)
    v_mfma_f32_32x32x16_bf16 v[192:207], v[252:255], v[76:79], v[192:207]
    ds_read_b64_tr_b16 v[72:73], v7 offset:6144
    ds_read_b64_tr_b16 v[74:75], v7 offset:6912
    s_waitcnt lgkmcnt(12)
    v_mfma_f32_32x32x16_bf16 v[208:223], v[240:243], v[48:51], v[208:223]
    ds_read_b64_tr_b16 v[76:77], v7 offset:9216
    ds_read_b64_tr_b16 v[78:79], v7 offset:9984
    s_waitcnt lgkmcnt(12)
    v_mfma_f32_32x32x16_bf16 v[208:223], v[244:247], v[52:55], v[208:223]
    s_waitcnt lgkmcnt(0)
    s_mov_b64 exec, 1
    ds_add_u32 v144, v144 offset:12
    s_mov_b64 exec, -1
    v_mfma_f32_32x32x16_bf16 v[208:223], v[248:251], v[56:59], v[208:223]
    v_mfma_f32_32x32x16_bf16 v[208:223], v[252:255], v[60:63], v[208:223]
    ds_read_b32 v145, v144 offset:0
    v_mfma_f32_32x32x16_bf16 v[176:191], v[64:67], v[240:243], v[176:191]
    s_waitcnt lgkmcnt(0)
    v_cmp_ne_u32 vcc, 626944, v145
    s_nop 0
    s_cbranch_vccz L_eST_ok_148
L_eST_sl_149:
    ds_read_b32 v145, v144 offset:0
    s_waitcnt lgkmcnt(0)
    v_cmp_ne_u32 vcc, 626944, v145
    s_nop 0
    s_cbranch_vccnz L_eST_sl_149
L_eST_ok_148:
    ds_read_b32 v12, v98 offset:512
    ds_read_b128 v[20:23], v148 offset:0
    ds_read_b128 v[24:27], v148 offset:16
    ds_read_b32 v31, v98
    ds_read_b128 v[80:83], v99 offset:0
    ds_read_b128 v[84:87], v99 offset:32
    ds_read_b128 v[88:91], v99 offset:64
    ds_read_b128 v[92:95], v99 offset:96
    s_setprio 2
    v_mfma_f32_32x32x16_bf16 v[176:191], v[68:71], v[244:247], v[176:191]
    v_mfma_f32_32x32x16_bf16 v[176:191], v[72:75], v[248:251], v[176:191]
    v_mfma_f32_32x32x16_bf16 v[176:191], v[76:79], v[252:255], v[176:191]
    s_waitcnt lgkmcnt(0)
    v_cvt_pk_bf16_f32 v96, v12, v12
    v_and_b32 v96, 0xffff0000, v96
    v_sub_f32 v96, v12, v96
    v_cvt_pk_bf16_f32 v16, v12, v96
    v_mov_b32 v17, v16
    v_mul_f32 v8, 0x30b8aa3b, v31
    s_nop 0
    v_mfma_f32_32x32x16_bf16 v[192:207], v[16:19], v[22:25], v[192:207]
    v_mfma_f32_32x32x16_bf16 v[208:223], v[16:19], v[24:27], v[208:223]
    s_nop 10
    v_mul_f32 v192, v192, v80
    v_mul_f32 v193, v193, v81
    v_mul_f32 v194, v194, v82
    v_mul_f32 v195, v195, v83
    v_mfma_f32_32x32x16_bf16 v[176:191], v[20:23], v[16:19], v[176:191]
    v_mul_f32 v196, v196, v84
    v_mul_f32 v197, v197, v85
    v_mul_f32 v198, v198, v86
    v_mul_f32 v199, v199, v87
    v_cvt_pk_bf16_f32 v192, v192, v193
    v_cvt_pk_bf16_f32 v193, v194, v195
    v_cvt_pk_bf16_f32 v194, v196, v197
    v_cvt_pk_bf16_f32 v195, v198, v199
    s_add_u32 s47, s12, 0
    buffer_store_dwordx4 v[192:195], v30, s[32:35], s47 offen offset:0 sc1
    v_mul_f32 v200, v200, v88
    v_mul_f32 v201, v201, v89
    v_mul_f32 v202, v202, v90
    v_mul_f32 v203, v203, v91
    v_mul_f32 v204, v204, v92
    v_mul_f32 v205, v205, v93
    v_mul_f32 v206, v206, v94
    v_mul_f32 v207, v207, v95
    v_cvt_pk_bf16_f32 v200, v200, v201
    v_cvt_pk_bf16_f32 v201, v202, v203
    v_cvt_pk_bf16_f32 v202, v204, v205
    v_cvt_pk_bf16_f32 v203, v206, v207
    s_add_u32 s47, s12, 0
    buffer_store_dwordx4 v[200:203], v30, s[32:35], s47 offen offset:512 sc1
    v_mul_f32 v208, v208, v80
    v_mul_f32 v209, v209, v81
    v_mul_f32 v210, v210, v82
    v_mul_f32 v211, v211, v83
    v_mul_f32 v212, v212, v84
    v_mul_f32 v213, v213, v85
    v_mul_f32 v214, v214, v86
    v_mul_f32 v215, v215, v87
    v_cvt_pk_bf16_f32 v208, v208, v209
    v_cvt_pk_bf16_f32 v209, v210, v211
    v_cvt_pk_bf16_f32 v210, v212, v213
    v_cvt_pk_bf16_f32 v211, v214, v215
    s_add_u32 s47, s12, 131072
    buffer_store_dwordx4 v[208:211], v30, s[32:35], s47 offen offset:0 sc1
    v_mul_f32 v216, v216, v88
    v_mul_f32 v217, v217, v89
    v_mul_f32 v218, v218, v90
    v_mul_f32 v219, v219, v91
    v_mul_f32 v220, v220, v92
    v_mul_f32 v221, v221, v93
    v_mul_f32 v222, v222, v94
    v_mul_f32 v223, v223, v95
    v_cvt_pk_bf16_f32 v216, v216, v217
    v_cvt_pk_bf16_f32 v217, v218, v219
    v_cvt_pk_bf16_f32 v218, v220, v221
    v_cvt_pk_bf16_f32 v219, v222, v223
    s_add_u32 s47, s12, 131072
    buffer_store_dwordx4 v[216:219], v30, s[32:35], s47 offen offset:512 sc1
    v_mul_f32 v176, v176, v8
    v_mul_f32 v177, v177, v8
    v_mul_f32 v178, v178, v8
    v_mul_f32 v179, v179, v8
    v_mul_f32 v180, v180, v8
    v_mul_f32 v181, v181, v8
    v_mul_f32 v182, v182, v8
    v_mul_f32 v183, v183, v8
    v_cvt_pk_bf16_f32 v176, v176, v177
    v_cvt_pk_bf16_f32 v177, v178, v179
    v_cvt_pk_bf16_f32 v178, v180, v181
    v_cvt_pk_bf16_f32 v179, v182, v183
    s_add_u32 s47, s16, 0
    buffer_store_dwordx4 v[176:179], v2, s[32:35], s47 offen sc1
    v_mul_f32 v184, v184, v8
    v_mul_f32 v185, v185, v8
    v_mul_f32 v186, v186, v8
    v_mul_f32 v187, v187, v8
    v_mul_f32 v188, v188, v8
    v_mul_f32 v189, v189, v8
    v_mul_f32 v190, v190, v8
    v_mul_f32 v191, v191, v8
    v_cvt_pk_bf16_f32 v184, v184, v185
    v_cvt_pk_bf16_f32 v185, v186, v187
    v_cvt_pk_bf16_f32 v186, v188, v189
    v_cvt_pk_bf16_f32 v187, v190, v191
    s_add_u32 s47, s16, 65536
    buffer_store_dwordx4 v[184:187], v2, s[32:35], s47 offen sc1
    v_mov_b32 v172, v30
L_T_c:
    ds_read_b32 v145, v144 offset:12
    v_lshrrev_b32 v150, 1, v1
    v_xor_b32 v150, v150, v1
    v_and_b32 v150, 4, v150
    v_mul_u32_u24 v150, 48, v150
    v_xor_b32 v3, v150, v2
    v_mov_b32 v7, 0xdddddddd
    v_mov_b32 v112, 0
    v_mov_b32 v113, 0
    v_mov_b32 v114, 0
    v_mov_b32 v115, 0
    v_mov_b32 v116, 0
    v_mov_b32 v117, 0
    v_mov_b32 v118, 0
    v_mov_b32 v119, 0
    v_mov_b32 v120, 0
    v_mov_b32 v121, 0
    v_mov_b32 v122, 0
    v_mov_b32 v123, 0
    v_mov_b32 v124, 0
    v_mov_b32 v125, 0
    v_mov_b32 v126, 0
    v_mov_b32 v127, 0
    v_mov_b32 v128, 0
    v_mov_b32 v129, 0
    v_mov_b32 v130, 0
    v_mov_b32 v131, 0
    v_mov_b32 v132, 0
    v_mov_b32 v133, 0
    v_mov_b32 v134, 0
    v_mov_b32 v135, 0
    v_mov_b32 v136, 0
    v_mov_b32 v137, 0
    v_mov_b32 v138, 0
    v_mov_b32 v139, 0
    v_mov_b32 v140, 0
    v_mov_b32 v141, 0
    v_mov_b32 v142, 0
    v_mov_b32 v143, 0
    v_lshrrev_b32 v150, 5, v1
    v_lshlrev_b32 v150, 8, v150
    v_and_b32 v151, 15, v1
    v_lshl_add_u32 v150, v151, 4, v150
    v_and_b32 v151, 16, v1
    v_cmp_eq_u32 vcc, 0, v151
    v_add_u32 v151, 1024, v150
    v_add_u32 v152, 1536, v150
    v_mov_b32 v153, 2048
    v_and_b32 v32, 11, v1
    v_min_u32 v32, 1, v32
    v_lshl_add_u32 v153, v32, 18, v153
    v_cndmask_b32 v4, v153, v151, vcc
    v_cndmask_b32 v5, v153, v152, vcc
    v_cmp_gt_u32 vcc, 32, v1
    v_mov_b32 v150, 0x3f803f80
    s_nop 0
    v_cndmask_b32 v32, 0, v150, vcc
    v_xor_b32 v24, v32, v150
    v_and_b32 v150, 15, v1
    v_mul_u32_u24 v6, 2064, v150
    v_mov_b32 v33, 0
    v_mov_b32 v34, 0
    v_mov_b32 v35, 0
    v_mov_b32 v37, 0
    v_mov_b32 v38, 0
    v_mov_b32 v39, 0
    v_mov_b32 v25, 0
    v_mov_b32 v26, 0
    v_mov_b32 v27, 0
    v_mov_b32 v229, 0
    v_mov_b32 v230, 0
    v_mov_b32 v231, 0
    v_mov_b32 v233, 0
    v_mov_b32 v234, 0
    v_mov_b32 v235, 0
    v_mov_b32 v228, v32
    v_mov_b32 v224, 0x4d804d80
    v_mov_b32 v225, 0x4d804d80
    v_mov_b32 v226, 0x4d804d80
    v_mov_b32 v227, 0x4d804d80
    s_add_u32 s47, s45, 0
    s_and_b32 s47, s47, 3
    s_mul_i32 s47, s47, 2064
    v_add_u32 v240, s47, v3
    v_add_u32 v241, s47, v4
    v_add_u32 v242, s47, v5
    s_add_u32 s47, s45, 1
    s_and_b32 s47, s47, 3
    s_mul_i32 s47, s47, 2064
    v_add_u32 v243, s47, v3
    v_add_u32 v244, s47, v4
    v_add_u32 v245, s47, v5
    s_add_u32 s47, s45, 2
    s_and_b32 s47, s47, 3
    s_mul_i32 s47, s47, 2064
    v_add_u32 v246, s47, v3
    v_add_u32 v247, s47, v4
    v_add_u32 v248, s47, v5
    s_add_u32 s47, s45, 3
    s_and_b32 s47, s47, 3
    s_mul_i32 s47, s47, 2064
    v_add_u32 v249, s47, v3
    v_add_u32 v250, s47, v4
    v_add_u32 v251, s47, v5
    s_waitcnt lgkmcnt(0)
    v_cmp_ne_u32 vcc, 1253888, v145
    s_nop 0
    s_cbranch_vccnz L_eAD_sl_152
L_eAD_ok_151:
    ds_write_b128 v6, v[224:227] offset:2048
    s_andn2_b32 s52, s64, 0xf000
    s_lshl_b32 s53, s61, 13
    s_add_u32 s52, s52, s53
    s_add_u32 s53, s52, 4096
    s_mov_b64 exec, 0
    s_cmp_eq_u32 s45, 0
    s_cbranch_scc1 L_tp7946
    s_cmp_eq_u32 s45, 1
    s_cbranch_scc1 L_ret_h
    s_cmp_eq_u32 s45, 2
    s_cbranch_scc1 L_ret_h
    s_branch L_ret_h
L_ret_h:
    s_mov_b64 exec, -1
    s_waitcnt vmcnt(2)
    buffer_store_dword v158, v146, s[32:35], s15 offen sc1
    s_add_u32 m0, s54, 0
    s_xor_b32 s47, s64, 2097152
    buffer_load_dwordx4 v2, s[32:35], s47 offen sc1 lds
    buffer_load_dwordx4 v[40:43], v2, s[32:35], s52 offen sc1
    buffer_load_dwordx4 v[44:47], v2, s[32:35], s53 offen sc1
    s_add_u32 m0, s54, 1024
    s_xor_b32 s47, s64, 4194304
    buffer_load_dwordx4 v2, s[32:35], s47 offen sc1 lds
    s_add_u32 m0, s54, 8256
    s_xor_b32 s47, s64, 2129920
    buffer_load_dwordx4 v2, s[32:35], s47 offen sc1 lds
    s_add_u32 m0, s54, 9280
    s_xor_b32 s47, s64, 4227072
    buffer_load_dwordx4 v2, s[32:35], s47 offen sc1 lds
    v_mov_b32 v6, 0x207
    v_add_u32 v3, 66048, v3
    v_add_u32 v4, 66048, v4
    v_add_u32 v5, 66048, v5
    s_waitcnt vmcnt(3)
    ds_read_b128 v[8:11], v240 offset:0
    s_waitcnt lgkmcnt(0)
    v_max3_u32 v150, v40, v41, v42
    v_max3_u32 v151, v46, v47, v8
    v_max3_u32 v150, v150, v43, v44
    v_max3_u32 v151, v151, v9, v10
    v_max3_u32 v150, v150, v45, v11
    v_max_u32 v150, v150, v151
    v_cmp_eq_u32 vcc, -1, v150
    s_nop 0
    s_cbranch_vccz L_q_ok_154
L_q_sl_155:
    s_mov_b32 s62, 65536
L_q_lp_156:
    s_add_u32 m0, s54, 0
    s_xor_b32 s47, s64, 2097152
    buffer_load_dwordx4 v2, s[32:35], s47 offen sc1 lds
    buffer_load_dwordx4 v[40:43], v2, s[32:35], s52 offen sc1
    buffer_load_dwordx4 v[44:47], v2, s[32:35], s53 offen sc1
    s_add_u32 m0, s54, 1024
    s_xor_b32 s47, s64, 4194304
    buffer_load_dwordx4 v2, s[32:35], s47 offen sc1 lds
    s_add_u32 m0, s54, 8256
    s_xor_b32 s47, s64, 2129920
    buffer_load_dwordx4 v2, s[32:35], s47 offen sc1 lds
    s_add_u32 m0, s54, 9280
    s_xor_b32 s47, s64, 4227072
    buffer_load_dwordx4 v2, s[32:35], s47 offen sc1 lds
    s_waitcnt vmcnt(3)
    ds_read_b128 v[8:11], v240 offset:0
    s_sub_u32 s62, s62, 1
    s_waitcnt lgkmcnt(0)
    s_cbranch_scc1 L_q_ok_154
    v_max3_u32 v150, v40, v41, v42
    v_max3_u32 v151, v46, v47, v8
    v_max3_u32 v150, v150, v43, v44
    v_max3_u32 v151, v151, v9, v10
    v_max3_u32 v150, v150, v45, v11
    v_max_u32 v150, v150, v151
    v_cmp_eq_u32 vcc, -1, v150
    s_nop 0
    s_cbranch_vccnz L_q_lp_156
L_q_ok_154:
    v_mfma_f32_32x32x16_bf16 v[80:95], v[8:11], v[40:43], 0
    v_mfma_f32_32x32x16_bf16 v[96:111], v[8:11], v[44:47], 0
    s_waitcnt vmcnt(0)
    ds_read_b128 v[12:15], v240 offset:8256
    ds_read_b128 v[160:163], v240 offset:1024
    ds_read_b128 v[164:167], v240 offset:9280
    ds_read_b128 v[16:19], v241 offset:0
    ds_read_b128 v[20:23], v242 offset:0
    s_waitcnt lgkmcnt(2)
    v_max3_u32 v168, v160, v161, v162
    v_max3_u32 v169, v166, v167, v12
    v_max3_u32 v168, v168, v163, v164
    v_max3_u32 v169, v169, v13, v14
    v_max3_u32 v168, v168, v165, v15
    v_max_u32 v168, v168, v169
    v_cmp_eq_u32 vcc, -1, v168
    s_nop 0
    s_cbranch_vccz L_v_ok_157
L_v_sl_158:
    s_mov_b32 s62, 65536
L_v_lp_159:
    s_add_u32 m0, s54, 1024
    s_xor_b32 s47, s64, 4194304
    buffer_load_dwordx4 v2, s[32:35], s47 offen sc1 lds
    s_add_u32 m0, s54, 8256
    s_xor_b32 s47, s64, 2129920
    buffer_load_dwordx4 v2, s[32:35], s47 offen sc1 lds
    s_add_u32 m0, s54, 9280
    s_xor_b32 s47, s64, 4227072
    buffer_load_dwordx4 v2, s[32:35], s47 offen sc1 lds
    s_waitcnt vmcnt(0)
    ds_read_b128 v[12:15], v240 offset:8256
    ds_read_b128 v[160:163], v240 offset:1024
    ds_read_b128 v[164:167], v240 offset:9280
    ds_read_b128 v[16:19], v241 offset:0
    ds_read_b128 v[20:23], v242 offset:0
    s_sub_u32 s62, s62, 1
    s_waitcnt lgkmcnt(0)
    s_cbranch_scc1 L_v_ok_157
    v_max3_u32 v168, v160, v161, v162
    v_max3_u32 v169, v166, v167, v12
    v_max3_u32 v168, v168, v163, v164
    v_max3_u32 v169, v169, v13, v14
    v_max3_u32 v168, v168, v165, v15
    v_max_u32 v168, v168, v169
    v_cmp_eq_u32 vcc, -1, v168
    s_nop 0
    s_cbranch_vccnz L_v_lp_159
L_v_ok_157:
    s_mov_b64 exec, 1
    ds_add_u32 v144, v144 offset:16
    s_mov_b64 exec, -1
    v_max3_f32 v150, v80, v81, v82
    v_max3_f32 v150, v150, v83, v84
    v_max3_f32 v150, v150, v85, v86
    v_max3_f32 v150, v150, v87, v88
    v_max3_f32 v150, v150, v89, v90
    v_max3_f32 v150, v150, v91, v92
    v_max3_f32 v150, v150, v93, v94
    v_max_f32 v150, v150, v95
    v_max3_f32 v151, v96, v97, v98
    v_max3_f32 v151, v151, v99, v100
    v_max3_f32 v151, v151, v101, v102
    v_max3_f32 v151, v151, v103, v104
    v_max3_f32 v151, v151, v105, v106
    v_max3_f32 v151, v151, v107, v108
    v_max3_f32 v151, v151, v109, v110
    v_max_f32 v151, v151, v111
    s_nop 1
    v_permlane32_swap_b32 v150, v151
    v_max_f32 v150, v150, v151
    v_sub_f32 v150, 0xc2c80000, v150
    v_cvt_pk_bf16_f32 v151, v150, v150
    v_and_b32 v151, 0xffff0000, v151
    v_sub_f32 v151, v150, v151
    v_cvt_pk_bf16_f32 v36, v150, v151
    s_nop 1
    v_mfma_f32_32x32x16_bf16 v[48:63], v[32:35], v[36:39], 0
    v_mfma_f32_32x32x16_bf16 v[64:79], v[24:27], v[36:39], 0
    v_mfma_f32_32x32x16_bf16 v[80:95], v[8:11], v[40:43], v[48:63]
    s_setprio 0
    v_mfma_f32_32x32x16_bf16 v[96:111], v[8:11], v[44:47], v[64:79]
    s_nop 9
    v_exp_f32 v80, v80
    v_exp_f32 v81, v81
    v_exp_f32 v82, v82
    v_exp_f32 v83, v83
    v_exp_f32 v84, v84
    v_exp_f32 v85, v85
    s_waitcnt lgkmcnt(0)
    ds_read_b128 v[24:27], v241 offset:8256
    ds_read_b128 v[28:31], v242 offset:8256
    v_exp_f32 v86, v86
    v_exp_f32 v87, v87
    v_exp_f32 v88, v88
    v_exp_f32 v89, v89
    v_exp_f32 v90, v90
    v_exp_f32 v91, v91
    v_exp_f32 v92, v92
    v_exp_f32 v93, v93
    v_exp_f32 v94, v94
    v_exp_f32 v95, v95
    v_mfma_f32_32x32x16_bf16 v[176:191], v[12:15], v[40:43], v[48:63]
    v_exp_f32 v96, v96
    v_exp_f32 v97, v97
    v_exp_f32 v98, v98
    v_smfmac_f32_32x32x32_bf16 v[112:127], v[16:19], v[80:87], v7
    v_exp_f32 v99, v99
    v_exp_f32 v100, v100
    v_exp_f32 v101, v101
    v_smfmac_f32_32x32x32_bf16 v[112:127], v[20:23], v[88:95], v7
    s_add_u32 s47, s13, 0
    buffer_store_dwordx4 v[192:195], v172, s[32:35], s47 offen sc1
    ds_read_b32 v145, v144 offset:16
    v_exp_f32 v102, v102
    v_exp_f32 v103, v103
    v_exp_f32 v104, v104
    v_exp_f32 v105, v105
    s_add_u32 s47, s13, s14
    buffer_store_dwordx4 v[200:203], v172, s[32:35], s47 offen sc1
    s_add_u32 s13, s13, 131072
    v_exp_f32 v106, v106
    v_exp_f32 v107, v107
    v_exp_f32 v108, v108
    v_exp_f32 v109, v109
    v_exp_f32 v110, v110
    v_exp_f32 v111, v111
    v_mfma_f32_32x32x16_bf16 v[80:95], v[12:15], v[44:47], v[64:79]
    v_exp_f32 v176, v176
    v_exp_f32 v177, v177
    v_exp_f32 v178, v178
    v_smfmac_f32_32x32x32_bf16 v[128:143], v[16:19], v[96:103], v7
    v_exp_f32 v179, v179
    v_exp_f32 v180, v180
    v_exp_f32 v181, v181
    v_smfmac_f32_32x32x32_bf16 v[128:143], v[20:23], v[104:111], v7
    s_waitcnt lgkmcnt(0)
    v_cmp_ne_u32 vcc, 626944, v145
    s_nop 0
    s_cbranch_vccz L_eKV0_ok_160
L_eKV0_sl_161:
    s_sleep 1
    ds_read_b32 v145, v144 offset:16
    s_waitcnt lgkmcnt(0)
    v_cmp_ne_u32 vcc, 626944, v145
    s_nop 0
    s_cbranch_vccnz L_eKV0_sl_161
L_eKV0_ok_160:
    ds_read_b128 v[8:11], v243 offset:0
    ds_read_b128 v[12:15], v243 offset:8256
    ds_read_b128 v[16:19], v244 offset:0
    ds_read_b128 v[20:23], v245 offset:0
    v_exp_f32 v182, v182
    v_exp_f32 v183, v183
    v_exp_f32 v184, v184
    v_exp_f32 v185, v185
    v_exp_f32 v186, v186
    v_exp_f32 v187, v187
    v_exp_f32 v188, v188
    v_exp_f32 v189, v189
    v_exp_f32 v190, v190
    v_exp_f32 v191, v191
    s_waitcnt lgkmcnt(3)
    v_mfma_f32_32x32x16_bf16 v[96:111], v[8:11], v[40:43], v[48:63]
    v_exp_f32 v80, v80
    v_exp_f32 v81, v81
    v_exp_f32 v82, v82
    v_smfmac_f32_32x32x32_bf16 v[112:127], v[24:27], v[176:183], v7
    v_exp_f32 v83, v83
    v_exp_f32 v84, v84
    v_exp_f32 v85, v85
    v_smfmac_f32_32x32x32_bf16 v[112:127], v[28:31], v[184:191], v7
    s_add_u32 s47, s13, 0
    buffer_store_dwordx4 v[208:211], v172, s[32:35], s47 offen sc1
    s_add_u32 s47, s13, s14
    buffer_store_dwordx4 v[216:219], v172, s[32:35], s47 offen sc1
    v_exp_f32 v86, v86
    v_exp_f32 v87, v87
    v_exp_f32 v88, v88
    v_exp_f32 v89, v89
    v_exp_f32 v90, v90
    v_exp_f32 v91, v91
    v_exp_f32 v92, v92
    v_exp_f32 v93, v93
    v_exp_f32 v94, v94
    v_exp_f32 v95, v95
    v_mfma_f32_32x32x16_bf16 v[176:191], v[8:11], v[44:47], v[64:79]
    v_exp_f32 v96, v96
    v_exp_f32 v97, v97
    v_exp_f32 v98, v98
    v_smfmac_f32_32x32x32_bf16 v[128:143], v[24:27], v[80:87], v7
    v_exp_f32 v99, v99
    v_exp_f32 v100, v100
    v_exp_f32 v101, v101
    v_smfmac_f32_32x32x32_bf16 v[128:143], v[28:31], v[88:95], v7
    s_waitcnt lgkmcnt(0)
    ds_read_b128 v[8:11], v246 offset:0
    ds_read_b128 v[24:27], v244 offset:8256
    ds_read_b128 v[28:31], v245 offset:8256
    v_exp_f32 v102, v102
    v_exp_f32 v103, v103
    v_exp_f32 v104, v104
    v_exp_f32 v105, v105
    v_exp_f32 v106, v106
    v_exp_f32 v107, v107
    v_exp_f32 v108, v108
    v_exp_f32 v109, v109
    v_exp_f32 v110, v110
    v_exp_f32 v111, v111
    v_mfma_f32_32x32x16_bf16 v[80:95], v[12:15], v[40:43], v[48:63]
    v_exp_f32 v176, v176
    v_exp_f32 v177, v177
    v_exp_f32 v178, v178
    v_smfmac_f32_32x32x32_bf16 v[112:127], v[16:19], v[96:103], v7
    v_exp_f32 v179, v179
    v_exp_f32 v180, v180
    v_exp_f32 v181, v181
    v_smfmac_f32_32x32x32_bf16 v[112:127], v[20:23], v[104:111], v7
    v_exp_f32 v182, v182
    v_exp_f32 v183, v183
    v_exp_f32 v184, v184
    v_exp_f32 v185, v185
    v_exp_f32 v186, v186
    v_exp_f32 v187, v187
    v_exp_f32 v188, v188
    v_exp_f32 v189, v189
    v_exp_f32 v190, v190
    v_exp_f32 v191, v191
    v_mfma_f32_32x32x16_bf16 v[96:111], v[12:15], v[44:47], v[64:79]
    v_exp_f32 v80, v80
    v_exp_f32 v81, v81
    v_exp_f32 v82, v82
    v_smfmac_f32_32x32x32_bf16 v[128:143], v[16:19], v[176:183], v7
    v_exp_f32 v83, v83
    v_exp_f32 v84, v84
    v_exp_f32 v85, v85
    v_smfmac_f32_32x32x32_bf16 v[128:143], v[20:23], v[184:191], v7
    s_waitcnt lgkmcnt(0)
    ds_read_b128 v[12:15], v246 offset:8256
    ds_read_b128 v[16:19], v247 offset:0
    ds_read_b128 v[20:23], v248 offset:0
    v_exp_f32 v86, v86
    v_exp_f32 v87, v87
    v_exp_f32 v88, v88
    v_exp_f32 v89, v89
    v_exp_f32 v90, v90
    v_exp_f32 v91, v91
    v_exp_f32 v92, v92
    v_exp_f32 v93, v93
    v_exp_f32 v94, v94
    v_exp_f32 v95, v95
    v_mfma_f32_32x32x16_bf16 v[176:191], v[8:11], v[40:43], v[48:63]
    v_exp_f32 v96, v96
    v_exp_f32 v97, v97
    v_exp_f32 v98, v98
    v_smfmac_f32_32x32x32_bf16 v[112:127], v[24:27], v[80:87], v7
    v_exp_f32 v99, v99
    v_exp_f32 v100, v100
    v_exp_f32 v101, v101
    v_smfmac_f32_32x32x32_bf16 v[112:127], v[28:31], v[88:95], v7
    v_exp_f32 v102, v102
    v_exp_f32 v103, v103
    v_exp_f32 v104, v104
    v_exp_f32 v105, v105
    v_exp_f32 v106, v106
    v_exp_f32 v107, v107
    v_exp_f32 v108, v108
    s_nop 4
    v_frexp_exp_i32_f32 v236, v120
    v_sub_u32 v236, -71, v236
    v_exp_f32 v109, v109
    v_cvt_f32_i32 v232, v236
    v_cvt_pk_bf16_f32 v232, v232, 0
    v_exp_f32 v110, v110
    s_nop 0
    v_mfma_f32_32x32x16_bf16 v[48:63], v[228:231], v[232:235], v[48:63]
    v_exp_f32 v111, v111
    v_mfma_f32_32x32x16_bf16 v[80:95], v[8:11], v[44:47], v[64:79]
    v_exp_f32 v176, v176
    v_exp_f32 v177, v177
    v_exp_f32 v178, v178
    v_smfmac_f32_32x32x32_bf16 v[128:143], v[24:27], v[96:103], v7
    v_exp_f32 v179, v179
    v_exp_f32 v180, v180
    v_exp_f32 v181, v181
    v_smfmac_f32_32x32x32_bf16 v[128:143], v[28:31], v[104:111], v7
    s_waitcnt lgkmcnt(0)
    ds_read_b128 v[8:11], v249 offset:0
    ds_read_b128 v[24:27], v247 offset:8256
    ds_read_b128 v[28:31], v248 offset:8256
    v_exp_f32 v182, v182
    v_exp_f32 v183, v183
    v_exp_f32 v184, v184
    v_exp_f32 v185, v185
    v_exp_f32 v186, v186
    v_exp_f32 v187, v187
    v_exp_f32 v188, v188
    s_nop 0
    v_frexp_exp_i32_f32 v237, v136
    v_sub_u32 v237, -71, v237
    v_exp_f32 v189, v189
    v_cvt_f32_i32 v232, v237
    v_cvt_pk_bf16_f32 v232, v232, 0
    v_exp_f32 v190, v190
L_tp7946:
    s_cbranch_execz L_ret_h
    s_nop 0
    v_mfma_f32_32x32x16_bf16 v[64:79], v[228:231], v[232:235], v[64:79]
    v_exp_f32 v191, v191
    v_mfma_f32_32x32x16_bf16 v[96:111], v[12:15], v[40:43], v[48:63]
    v_exp_f32 v80, v80
    v_exp_f32 v81, v81
    v_exp_f32 v82, v82
    v_smfmac_f32_32x32x32_bf16 v[112:127], v[16:19], v[176:183], v7
    v_exp_f32 v83, v83
    v_exp_f32 v84, v84
    v_exp_f32 v85, v85
    v_smfmac_f32_32x32x32_bf16 v[112:127], v[20:23], v[184:191], v7
    v_exp_f32 v86, v86
    v_exp_f32 v87, v87
    v_exp_f32 v88, v88
    v_exp_f32 v89, v89
    v_exp_f32 v90, v90
    v_exp_f32 v91, v91
    v_exp_f32 v92, v92
    v_exp_f32 v93, v93
    v_exp_f32 v94, v94
    v_exp_f32 v95, v95
    s_nop 1
    v_ldexp_f32 v112, v112, v236
    v_ldexp_f32 v113, v113, v236
    v_ldexp_f32 v114, v114, v236
    v_ldexp_f32 v115, v115, v236
    v_ldexp_f32 v116, v116, v236
    v_ldexp_f32 v117, v117, v236
    v_ldexp_f32 v118, v118, v236
    v_ldexp_f32 v119, v119, v236
    v_ldexp_f32 v120, v120, v236
    v_mfma_f32_32x32x16_bf16 v[176:191], v[12:15], v[44:47], v[64:79]
    v_exp_f32 v96, v96
    v_exp_f32 v97, v97
    v_exp_f32 v98, v98
    v_smfmac_f32_32x32x32_bf16 v[128:143], v[16:19], v[80:87], v7
    v_exp_f32 v99, v99
    v_exp_f32 v100, v100
    v_exp_f32 v101, v101
    v_smfmac_f32_32x32x32_bf16 v[128:143], v[20:23], v[88:95], v7
    s_waitcnt lgkmcnt(0)
    ds_read_b128 v[12:15], v249 offset:8256
    ds_read_b128 v[16:19], v250 offset:0
    ds_read_b128 v[20:23], v251 offset:0
    v_exp_f32 v102, v102
    v_exp_f32 v103, v103
    v_exp_f32 v104, v104
    v_exp_f32 v105, v105
    v_exp_f32 v106, v106
    v_exp_f32 v107, v107
    v_exp_f32 v108, v108
    v_exp_f32 v109, v109
    v_exp_f32 v110, v110
    v_exp_f32 v111, v111
    v_ldexp_f32 v128, v128, v237
    v_ldexp_f32 v129, v129, v237
    v_ldexp_f32 v130, v130, v237
    v_ldexp_f32 v131, v131, v237
    v_ldexp_f32 v132, v132, v237
    v_ldexp_f32 v133, v133, v237
    v_ldexp_f32 v134, v134, v237
    v_ldexp_f32 v135, v135, v237
    v_ldexp_f32 v136, v136, v237
    v_mfma_f32_32x32x16_bf16 v[80:95], v[8:11], v[40:43], v[48:63]
    v_exp_f32 v176, v176
    v_exp_f32 v177, v177
    v_exp_f32 v178, v178
    v_smfmac_f32_32x32x32_bf16 v[112:127], v[24:27], v[96:103], v7
    v_exp_f32 v179, v179
    v_exp_f32 v180, v180
    v_exp_f32 v181, v181
    v_smfmac_f32_32x32x32_bf16 v[112:127], v[28:31], v[104:111], v7
    s_waitcnt vmcnt(0)
    buffer_store_dword v158, v146, s[32:35], s36 offen sc1
    ds_read_b32 v145, v144 offset:20
    v_exp_f32 v182, v182
    v_exp_f32 v183, v183
    v_exp_f32 v184, v184
    v_exp_f32 v185, v185
    v_exp_f32 v186, v186
    v_exp_f32 v187, v187
    v_exp_f32 v188, v188
    v_exp_f32 v189, v189
    v_exp_f32 v190, v190
    v_exp_f32 v191, v191
    v_mfma_f32_32x32x16_bf16 v[96:111], v[8:11], v[44:47], v[64:79]
    v_exp_f32 v80, v80
    v_exp_f32 v81, v81
    v_exp_f32 v82, v82
    v_smfmac_f32_32x32x32_bf16 v[128:143], v[24:27], v[176:183], v7
    v_exp_f32 v83, v83
    v_exp_f32 v84, v84
    v_exp_f32 v85, v85
    v_smfmac_f32_32x32x32_bf16 v[128:143], v[28:31], v[184:191], v7
    s_waitcnt lgkmcnt(0)
    v_cmp_ne_u32 vcc, 626944, v145
    s_nop 0
    s_cbranch_vccnz L_eKV1_sl_164
L_eKV1_ok_163:
    ds_read_b128 v[8:11], v240 offset:16512
    ds_read_b128 v[24:27], v250 offset:8256
    ds_read_b128 v[28:31], v251 offset:8256
    v_exp_f32 v86, v86
    v_exp_f32 v87, v87
    v_exp_f32 v88, v88
    v_exp_f32 v89, v89
    v_exp_f32 v90, v90
    v_exp_f32 v91, v91
    v_exp_f32 v92, v92
    v_exp_f32 v93, v93
    v_exp_f32 v94, v94
    v_exp_f32 v95, v95
    v_mfma_f32_32x32x16_bf16 v[176:191], v[12:15], v[40:43], v[48:63]
    v_exp_f32 v96, v96
    v_exp_f32 v97, v97
    v_exp_f32 v98, v98
    v_smfmac_f32_32x32x32_bf16 v[112:127], v[16:19], v[80:87], v7
    v_exp_f32 v99, v99
    v_exp_f32 v100, v100
    v_exp_f32 v101, v101
    v_smfmac_f32_32x32x32_bf16 v[112:127], v[20:23], v[88:95], v7
    v_exp_f32 v102, v102
    v_exp_f32 v103, v103
    v_exp_f32 v104, v104
    v_exp_f32 v105, v105
    v_exp_f32 v106, v106
    v_exp_f32 v107, v107
    v_exp_f32 v108, v108
    v_exp_f32 v109, v109
    v_exp_f32 v110, v110
    v_exp_f32 v111, v111
    v_mfma_f32_32x32x16_bf16 v[80:95], v[12:15], v[44:47], v[64:79]
    v_exp_f32 v176, v176
    v_exp_f32 v177, v177
    v_exp_f32 v178, v178
    v_smfmac_f32_32x32x32_bf16 v[128:143], v[16:19], v[96:103], v7
    v_exp_f32 v179, v179
    v_exp_f32 v180, v180
    v_exp_f32 v181, v181
    v_smfmac_f32_32x32x32_bf16 v[128:143], v[20:23], v[104:111], v7
    s_waitcnt lgkmcnt(0)
    ds_read_b128 v[12:15], v240 offset:24768
    ds_read_b128 v[16:19], v241 offset:16512
    ds_read_b128 v[20:23], v242 offset:16512
    v_exp_f32 v182, v182
    v_exp_f32 v183, v183
    v_exp_f32 v184, v184
    v_exp_f32 v185, v185
    v_exp_f32 v186, v186
    v_exp_f32 v187, v187
    v_exp_f32 v188, v188
    v_exp_f32 v189, v189
    v_exp_f32 v190, v190
    v_exp_f32 v191, v191
    v_mfma_f32_32x32x16_bf16 v[96:111], v[8:11], v[40:43], v[48:63]
    v_exp_f32 v80, v80
    v_exp_f32 v81, v81
    v_exp_f32 v82, v82
    v_smfmac_f32_32x32x32_bf16 v[112:127], v[24:27], v[176:183], v7
    v_exp_f32 v83, v83
    v_exp_f32 v84, v84
    v_exp_f32 v85, v85
    v_smfmac_f32_32x32x32_bf16 v[112:127], v[28:31], v[184:191], v7
    v_exp_f32 v86, v86
    v_exp_f32 v87, v87
    v_exp_f32 v88, v88
    v_exp_f32 v89, v89
    v_exp_f32 v90, v90
    v_exp_f32 v91, v91
    v_exp_f32 v92, v92
    v_exp_f32 v93, v93
    v_exp_f32 v94, v94
    v_exp_f32 v95, v95
    v_mfma_f32_32x32x16_bf16 v[176:191], v[8:11], v[44:47], v[64:79]
    v_exp_f32 v96, v96
    v_exp_f32 v97, v97
    v_exp_f32 v98, v98
    v_smfmac_f32_32x32x32_bf16 v[128:143], v[24:27], v[80:87], v7
    v_exp_f32 v99, v99
    v_exp_f32 v100, v100
    v_exp_f32 v101, v101
    v_smfmac_f32_32x32x32_bf16 v[128:143], v[28:31], v[88:95], v7
    s_waitcnt lgkmcnt(0)
    ds_read_b128 v[8:11], v243 offset:16512
    ds_read_b128 v[24:27], v241 offset:24768
    ds_read_b128 v[28:31], v242 offset:24768
    v_exp_f32 v102, v102
    v_exp_f32 v103, v103
    v_exp_f32 v104, v104
    v_exp_f32 v105, v105
    v_exp_f32 v106, v106
    v_exp_f32 v107, v107
    v_exp_f32 v108, v108
    v_exp_f32 v109, v109
    v_exp_f32 v110, v110
    v_exp_f32 v111, v111
    v_mfma_f32_32x32x16_bf16 v[80:95], v[12:15], v[40:43], v[48:63]
    v_exp_f32 v176, v176
    v_exp_f32 v177, v177
    v_exp_f32 v178, v178
    v_smfmac_f32_32x32x32_bf16 v[112:127], v[16:19], v[96:103], v7
    v_exp_f32 v179, v179
    v_exp_f32 v180, v180
    v_exp_f32 v181, v181
    v_smfmac_f32_32x32x32_bf16 v[112:127], v[20:23], v[104:111], v7
    v_exp_f32 v182, v182
    v_exp_f32 v183, v183
    v_exp_f32 v184, v184
    v_exp_f32 v185, v185
    v_exp_f32 v186, v186
    v_exp_f32 v187, v187
    v_exp_f32 v188, v188
    v_exp_f32 v189, v189
    v_exp_f32 v190, v190
    v_exp_f32 v191, v191
    v_mfma_f32_32x32x16_bf16 v[96:111], v[12:15], v[44:47], v[64:79]
    v_exp_f32 v80, v80
    v_exp_f32 v81, v81
    v_exp_f32 v82, v82
    v_smfmac_f32_32x32x32_bf16 v[128:143], v[16:19], v[176:183], v7
    v_exp_f32 v83, v83
    v_exp_f32 v84, v84
    v_exp_f32 v85, v85
    v_smfmac_f32_32x32x32_bf16 v[128:143], v[20:23], v[184:191], v7
    s_waitcnt lgkmcnt(0)
    ds_read_b128 v[12:15], v243 offset:24768
    ds_read_b128 v[16:19], v244 offset:16512
    ds_read_b128 v[20:23], v245 offset:16512
    v_exp_f32 v86, v86
    v_exp_f32 v87, v87
    v_exp_f32 v88, v88
    v_exp_f32 v89, v89
    v_exp_f32 v90, v90
    v_exp_f32 v91, v91
    v_exp_f32 v92, v92
    v_exp_f32 v93, v93
    v_exp_f32 v94, v94
    v_exp_f32 v95, v95
    v_mfma_f32_32x32x16_bf16 v[176:191], v[8:11], v[40:43], v[48:63]
    v_exp_f32 v96, v96
    v_exp_f32 v97, v97
    v_exp_f32 v98, v98
    v_smfmac_f32_32x32x32_bf16 v[112:127], v[24:27], v[80:87], v7
    v_exp_f32 v99, v99
    v_exp_f32 v100, v100
    v_exp_f32 v101, v101
    v_smfmac_f32_32x32x32_bf16 v[112:127], v[28:31], v[88:95], v7
    v_exp_f32 v102, v102
    v_exp_f32 v103, v103
    v_exp_f32 v104, v104
    v_exp_f32 v105, v105
    v_exp_f32 v106, v106
    v_exp_f32 v107, v107
    v_exp_f32 v108, v108
    v_exp_f32 v109, v109
    v_exp_f32 v110, v110
    v_exp_f32 v111, v111
    v_mfma_f32_32x32x16_bf16 v[80:95], v[8:11], v[44:47], v[64:79]
    v_exp_f32 v176, v176
    v_exp_f32 v177, v177
    v_exp_f32 v178, v178
    v_smfmac_f32_32x32x32_bf16 v[128:143], v[24:27], v[96:103], v7
    v_exp_f32 v179, v179
    v_exp_f32 v180, v180
    v_exp_f32 v181, v181
    v_smfmac_f32_32x32x32_bf16 v[128:143], v[28:31], v[104:111], v7
    s_waitcnt lgkmcnt(0)
    ds_read_b128 v[8:11], v246 offset:16512
    ds_read_b128 v[24:27], v244 offset:24768
    ds_read_b128 v[28:31], v245 offset:24768
    v_exp_f32 v182, v182
    v_exp_f32 v183, v183
    v_exp_f32 v184, v184
    v_exp_f32 v185, v185
    v_exp_f32 v186, v186
    v_exp_f32 v187, v187
    v_exp_f32 v188, v188
    v_exp_f32 v189, v189
    v_exp_f32 v190, v190
    v_exp_f32 v191, v191
    v_mfma_f32_32x32x16_bf16 v[96:111], v[12:15], v[40:43], v[48:63]
    v_exp_f32 v80, v80
    v_exp_f32 v81, v81
    v_exp_f32 v82, v82
    v_smfmac_f32_32x32x32_bf16 v[112:127], v[16:19], v[176:183], v7
    v_exp_f32 v83, v83
    v_exp_f32 v84, v84
    v_exp_f32 v85, v85
    v_smfmac_f32_32x32x32_bf16 v[112:127], v[20:23], v[184:191], v7
    v_exp_f32 v86, v86
    v_exp_f32 v87, v87
    v_exp_f32 v88, v88
    v_exp_f32 v89, v89
    v_exp_f32 v90, v90
    v_exp_f32 v91, v91
    v_exp_f32 v92, v92
    v_exp_f32 v93, v93
    v_exp_f32 v94, v94
    v_exp_f32 v95, v95
    v_mfma_f32_32x32x16_bf16 v[176:191], v[12:15], v[44:47], v[64:79]
    v_exp_f32 v96, v96
    v_exp_f32 v97, v97
    v_exp_f32 v98, v98
    v_smfmac_f32_32x32x32_bf16 v[128:143], v[16:19], v[80:87], v7
    v_exp_f32 v99, v99
    v_exp_f32 v100, v100
    v_exp_f32 v101, v101
    v_smfmac_f32_32x32x32_bf16 v[128:143], v[20:23], v[88:95], v7
    s_waitcnt lgkmcnt(0)
    ds_read_b128 v[12:15], v246 offset:24768
    ds_read_b128 v[16:19], v247 offset:16512
    ds_read_b128 v[20:23], v248 offset:16512
    v_exp_f32 v102, v102
    v_exp_f32 v103, v103
    v_exp_f32 v104, v104
    v_exp_f32 v105, v105
    v_exp_f32 v106, v106
    v_exp_f32 v107, v107
    v_exp_f32 v108, v108
    v_exp_f32 v109, v109
    v_exp_f32 v110, v110
    v_exp_f32 v111, v111
    v_mfma_f32_32x32x16_bf16 v[80:95], v[8:11], v[40:43], v[48:63]
    v_exp_f32 v176, v176
    v_exp_f32 v177, v177
    v_exp_f32 v178, v178
    v_smfmac_f32_32x32x32_bf16 v[112:127], v[24:27], v[96:103], v7
    v_exp_f32 v179, v179
    v_exp_f32 v180, v180
    v_exp_f32 v181, v181
    v_smfmac_f32_32x32x32_bf16 v[112:127], v[28:31], v[104:111], v7
    v_exp_f32 v182, v182
    v_exp_f32 v183, v183
    v_exp_f32 v184, v184
    v_exp_f32 v185, v185
    v_exp_f32 v186, v186
    v_exp_f32 v187, v187
    v_exp_f32 v188, v188
    v_exp_f32 v189, v189
    v_exp_f32 v190, v190
    v_exp_f32 v191, v191
    v_mfma_f32_32x32x16_bf16 v[96:111], v[8:11], v[44:47], v[64:79]
    v_exp_f32 v80, v80
    v_exp_f32 v81, v81
    v_exp_f32 v82, v82
    v_smfmac_f32_32x32x32_bf16 v[128:143], v[24:27], v[176:183], v7
    v_exp_f32 v83, v83
    v_exp_f32 v84, v84
    v_exp_f32 v85, v85
    v_smfmac_f32_32x32x32_bf16 v[128:143], v[28:31], v[184:191], v7
    s_waitcnt lgkmcnt(0)
    ds_read_b128 v[8:11], v249 offset:16512
    ds_read_b128 v[24:27], v247 offset:24768
    ds_read_b128 v[28:31], v248 offset:24768
    v_exp_f32 v86, v86
    v_exp_f32 v87, v87
    v_exp_f32 v88, v88
    v_exp_f32 v89, v89
    v_exp_f32 v90, v90
    v_exp_f32 v91, v91
    v_exp_f32 v92, v92
    v_exp_f32 v93, v93
    v_exp_f32 v94, v94
    v_exp_f32 v95, v95
    v_mfma_f32_32x32x16_bf16 v[176:191], v[12:15], v[40:43], v[48:63]
    v_exp_f32 v96, v96
    v_exp_f32 v97, v97
    v_exp_f32 v98, v98
    v_smfmac_f32_32x32x32_bf16 v[112:127], v[16:19], v[80:87], v7
    v_exp_f32 v99, v99
    v_exp_f32 v100, v100
    v_exp_f32 v101, v101
    v_smfmac_f32_32x32x32_bf16 v[112:127], v[20:23], v[88:95], v7
    v_exp_f32 v102, v102
    v_exp_f32 v103, v103
    v_exp_f32 v104, v104
    v_exp_f32 v105, v105
    v_exp_f32 v106, v106
    v_exp_f32 v107, v107
    v_exp_f32 v108, v108
    v_exp_f32 v109, v109
    v_exp_f32 v110, v110
    v_exp_f32 v111, v111
    v_mfma_f32_32x32x16_bf16 v[80:95], v[12:15], v[44:47], v[64:79]
    v_exp_f32 v176, v176
    v_exp_f32 v177, v177
    v_exp_f32 v178, v178
    v_smfmac_f32_32x32x32_bf16 v[128:143], v[16:19], v[96:103], v7
    v_exp_f32 v179, v179
    v_exp_f32 v180, v180
    v_exp_f32 v181, v181
    v_smfmac_f32_32x32x32_bf16 v[128:143], v[20:23], v[104:111], v7
    s_waitcnt lgkmcnt(0)
    ds_read_b128 v[12:15], v249 offset:24768
    ds_read_b128 v[16:19], v250 offset:16512
    ds_read_b128 v[20:23], v251 offset:16512
    v_exp_f32 v182, v182
    v_exp_f32 v183, v183
    v_exp_f32 v184, v184
    v_exp_f32 v185, v185
    v_exp_f32 v186, v186
    v_exp_f32 v187, v187
    v_exp_f32 v188, v188
    v_exp_f32 v189, v189
    v_exp_f32 v190, v190
    v_exp_f32 v191, v191
    v_mfma_f32_32x32x16_bf16 v[96:111], v[8:11], v[40:43], v[48:63]
    v_exp_f32 v80, v80
    v_exp_f32 v81, v81
    v_exp_f32 v82, v82
    v_smfmac_f32_32x32x32_bf16 v[112:127], v[24:27], v[176:183], v7
    v_exp_f32 v83, v83
    v_exp_f32 v84, v84
    v_exp_f32 v85, v85
    v_smfmac_f32_32x32x32_bf16 v[112:127], v[28:31], v[184:191], v7
    ds_read_b32 v145, v144 offset:24
    v_exp_f32 v86, v86
    v_exp_f32 v87, v87
    v_exp_f32 v88, v88
    v_exp_f32 v89, v89
    v_exp_f32 v90, v90
    v_exp_f32 v91, v91
    v_exp_f32 v92, v92
    v_exp_f32 v93, v93
    v_exp_f32 v94, v94
    v_exp_f32 v95, v95
    v_mfma_f32_32x32x16_bf16 v[176:191], v[8:11], v[44:47], v[64:79]
    v_exp_f32 v96, v96
    v_exp_f32 v97, v97
    v_exp_f32 v98, v98
    v_smfmac_f32_32x32x32_bf16 v[128:143], v[24:27], v[80:87], v7
    v_exp_f32 v99, v99
    v_exp_f32 v100, v100
    v_exp_f32 v101, v101
    v_smfmac_f32_32x32x32_bf16 v[128:143], v[28:31], v[88:95], v7
    s_waitcnt lgkmcnt(0)
    v_cmp_ne_u32 vcc, 626944, v145
    s_nop 0
    s_cbranch_vccnz L_eKV2_sl_167
L_eKV2_ok_166:
    ds_read_b128 v[8:11], v240 offset:33024
    ds_read_b128 v[24:27], v250 offset:24768
    ds_read_b128 v[28:31], v251 offset:24768
    v_exp_f32 v102, v102
    v_exp_f32 v103, v103
    v_exp_f32 v104, v104
    v_exp_f32 v105, v105
    v_exp_f32 v106, v106
    v_exp_f32 v107, v107
    v_exp_f32 v108, v108
    v_exp_f32 v109, v109
    v_exp_f32 v110, v110
    v_exp_f32 v111, v111
    v_mfma_f32_32x32x16_bf16 v[80:95], v[12:15], v[40:43], v[48:63]
    v_exp_f32 v176, v176
    v_exp_f32 v177, v177
    v_exp_f32 v178, v178
    v_smfmac_f32_32x32x32_bf16 v[112:127], v[16:19], v[96:103], v7
    v_exp_f32 v179, v179
    v_exp_f32 v180, v180
    v_exp_f32 v181, v181
    v_smfmac_f32_32x32x32_bf16 v[112:127], v[20:23], v[104:111], v7
    v_exp_f32 v182, v182
    v_exp_f32 v183, v183
    v_exp_f32 v184, v184
    v_exp_f32 v185, v185
    v_exp_f32 v186, v186
    v_exp_f32 v187, v187
    v_exp_f32 v188, v188
    v_exp_f32 v189, v189
    v_exp_f32 v190, v190
    v_exp_f32 v191, v191
    v_mfma_f32_32x32x16_bf16 v[96:111], v[12:15], v[44:47], v[64:79]
    v_exp_f32 v80, v80
    v_exp_f32 v81, v81
    v_exp_f32 v82, v82
    v_smfmac_f32_32x32x32_bf16 v[128:143], v[16:19], v[176:183], v7
    v_exp_f32 v83, v83
    v_exp_f32 v84, v84
    v_exp_f32 v85, v85
    v_smfmac_f32_32x32x32_bf16 v[128:143], v[20:23], v[184:191], v7
    s_waitcnt lgkmcnt(0)
    ds_read_b128 v[12:15], v240 offset:41280
    ds_read_b128 v[16:19], v241 offset:33024
    ds_read_b128 v[20:23], v242 offset:33024
    v_exp_f32 v86, v86
    v_exp_f32 v87, v87
    v_exp_f32 v88, v88
    v_exp_f32 v89, v89
    v_exp_f32 v90, v90
    v_exp_f32 v91, v91
    v_exp_f32 v92, v92
    v_exp_f32 v93, v93
    v_exp_f32 v94, v94
    v_exp_f32 v95, v95
    v_mfma_f32_32x32x16_bf16 v[176:191], v[8:11], v[40:43], v[48:63]
    v_exp_f32 v96, v96
    v_exp_f32 v97, v97
    v_exp_f32 v98, v98
    v_smfmac_f32_32x32x32_bf16 v[112:127], v[24:27], v[80:87], v7
    v_exp_f32 v99, v99
    v_exp_f32 v100, v100
    v_exp_f32 v101, v101
    v_smfmac_f32_32x32x32_bf16 v[112:127], v[28:31], v[88:95], v7
    v_exp_f32 v102, v102
    v_exp_f32 v103, v103
    v_exp_f32 v104, v104
    v_exp_f32 v105, v105
    v_exp_f32 v106, v106
    v_exp_f32 v107, v107
    v_exp_f32 v108, v108
    v_exp_f32 v109, v109
    v_exp_f32 v110, v110
    v_exp_f32 v111, v111
    v_mfma_f32_32x32x16_bf16 v[80:95], v[8:11], v[44:47], v[64:79]
    v_exp_f32 v176, v176
    v_exp_f32 v177, v177
    v_exp_f32 v178, v178
    v_smfmac_f32_32x32x32_bf16 v[128:143], v[24:27], v[96:103], v7
    v_exp_f32 v179, v179
    v_exp_f32 v180, v180
    v_exp_f32 v181, v181
    v_smfmac_f32_32x32x32_bf16 v[128:143], v[28:31], v[104:111], v7
    s_waitcnt lgkmcnt(0)
    ds_read_b128 v[8:11], v243 offset:33024
    ds_read_b128 v[24:27], v241 offset:41280
    ds_read_b128 v[28:31], v242 offset:41280
    v_exp_f32 v182, v182
    v_exp_f32 v183, v183
    v_exp_f32 v184, v184
    v_exp_f32 v185, v185
    v_exp_f32 v186, v186
    v_exp_f32 v187, v187
    v_exp_f32 v188, v188
    v_exp_f32 v189, v189
    v_exp_f32 v190, v190
    v_exp_f32 v191, v191
    v_mfma_f32_32x32x16_bf16 v[96:111], v[12:15], v[40:43], v[48:63]
    v_exp_f32 v80, v80
    v_exp_f32 v81, v81
    v_exp_f32 v82, v82
    v_smfmac_f32_32x32x32_bf16 v[112:127], v[16:19], v[176:183], v7
    v_exp_f32 v83, v83
    v_exp_f32 v84, v84
    v_exp_f32 v85, v85
    v_smfmac_f32_32x32x32_bf16 v[112:127], v[20:23], v[184:191], v7
    s_mov_b64 exec, 1
    ds_add_u32 v144, v144 offset:36
    s_mov_b64 exec, -1
    v_exp_f32 v86, v86
    v_exp_f32 v87, v87
    v_exp_f32 v88, v88
    v_exp_f32 v89, v89
    v_exp_f32 v90, v90
    v_exp_f32 v91, v91
    v_exp_f32 v92, v92
    v_exp_f32 v93, v93
    v_exp_f32 v94, v94
    v_exp_f32 v95, v95
    v_mfma_f32_32x32x16_bf16 v[176:191], v[12:15], v[44:47], v[64:79]
    v_exp_f32 v96, v96
    v_exp_f32 v97, v97
    v_exp_f32 v98, v98
    v_smfmac_f32_32x32x32_bf16 v[128:143], v[16:19], v[80:87], v7
    v_exp_f32 v99, v99
    v_exp_f32 v100, v100
    v_exp_f32 v101, v101
    v_smfmac_f32_32x32x32_bf16 v[128:143], v[20:23], v[88:95], v7
    s_waitcnt lgkmcnt(0)
    ds_read_b128 v[12:15], v243 offset:41280
    ds_read_b128 v[16:19], v244 offset:33024
    ds_read_b128 v[20:23], v245 offset:33024
    v_exp_f32 v102, v102
    v_exp_f32 v103, v103
    v_exp_f32 v104, v104
    v_exp_f32 v105, v105
    v_exp_f32 v106, v106
    v_exp_f32 v107, v107
    v_exp_f32 v108, v108
    v_exp_f32 v109, v109
    v_exp_f32 v110, v110
    v_exp_f32 v111, v111
    v_mfma_f32_32x32x16_bf16 v[80:95], v[8:11], v[40:43], v[48:63]
    v_exp_f32 v176, v176
    v_exp_f32 v177, v177
    v_exp_f32 v178, v178
    v_smfmac_f32_32x32x32_bf16 v[112:127], v[24:27], v[96:103], v7
    v_exp_f32 v179, v179
    v_exp_f32 v180, v180
    v_exp_f32 v181, v181
    v_smfmac_f32_32x32x32_bf16 v[112:127], v[28:31], v[104:111], v7
    v_exp_f32 v182, v182
    v_exp_f32 v183, v183
    v_exp_f32 v184, v184
    v_exp_f32 v185, v185
    v_exp_f32 v186, v186
    v_exp_f32 v187, v187
    v_exp_f32 v188, v188
    v_exp_f32 v189, v189
    v_exp_f32 v190, v190
    v_exp_f32 v191, v191
    v_mfma_f32_32x32x16_bf16 v[96:111], v[8:11], v[44:47], v[64:79]
    v_exp_f32 v80, v80
    v_exp_f32 v81, v81
    v_exp_f32 v82, v82
    v_smfmac_f32_32x32x32_bf16 v[128:143], v[24:27], v[176:183], v7
    v_exp_f32 v83, v83
    v_exp_f32 v84, v84
    v_exp_f32 v85, v85
    v_smfmac_f32_32x32x32_bf16 v[128:143], v[28:31], v[184:191], v7
    s_waitcnt lgkmcnt(0)
    ds_read_b128 v[8:11], v246 offset:33024
    ds_read_b128 v[24:27], v244 offset:41280
    ds_read_b128 v[28:31], v245 offset:41280
    v_exp_f32 v86, v86
    v_exp_f32 v87, v87
    v_exp_f32 v88, v88
    v_exp_f32 v89, v89
    v_exp_f32 v90, v90
    v_exp_f32 v91, v91
    v_exp_f32 v92, v92
    v_exp_f32 v93, v93
    v_exp_f32 v94, v94
    v_exp_f32 v95, v95
    v_mfma_f32_32x32x16_bf16 v[176:191], v[12:15], v[40:43], v[48:63]
    v_exp_f32 v96, v96
    v_exp_f32 v97, v97
    v_exp_f32 v98, v98
    v_smfmac_f32_32x32x32_bf16 v[112:127], v[16:19], v[80:87], v7
    v_exp_f32 v99, v99
    v_exp_f32 v100, v100
    v_exp_f32 v101, v101
    v_smfmac_f32_32x32x32_bf16 v[112:127], v[20:23], v[88:95], v7
    v_exp_f32 v102, v102
    v_exp_f32 v103, v103
    v_exp_f32 v104, v104
    v_exp_f32 v105, v105
    v_exp_f32 v106, v106
    v_exp_f32 v107, v107
    v_exp_f32 v108, v108
    s_nop 4
    v_frexp_exp_i32_f32 v236, v120
    v_sub_u32 v236, -71, v236
    v_exp_f32 v109, v109
    v_cvt_f32_i32 v232, v236
    v_cvt_pk_bf16_f32 v232, v232, 0
    v_exp_f32 v110, v110
    s_nop 0
    v_mfma_f32_32x32x16_bf16 v[48:63], v[228:231], v[232:235], v[48:63]
    v_exp_f32 v111, v111
    v_mfma_f32_32x32x16_bf16 v[80:95], v[12:15], v[44:47], v[64:79]
    v_exp_f32 v176, v176
    v_exp_f32 v177, v177
    v_exp_f32 v178, v178
    v_smfmac_f32_32x32x32_bf16 v[128:143], v[16:19], v[96:103], v7
    v_exp_f32 v179, v179
    v_exp_f32 v180, v180
    v_exp_f32 v181, v181
    v_smfmac_f32_32x32x32_bf16 v[128:143], v[20:23], v[104:111], v7
    s_waitcnt lgkmcnt(0)
    ds_read_b128 v[12:15], v246 offset:41280
    ds_read_b128 v[16:19], v247 offset:33024
    ds_read_b128 v[20:23], v248 offset:33024
    v_exp_f32 v182, v182
    v_exp_f32 v183, v183
    v_exp_f32 v184, v184
    v_exp_f32 v185, v185
    v_exp_f32 v186, v186
    v_exp_f32 v187, v187
    v_exp_f32 v188, v188
    s_nop 0
    v_frexp_exp_i32_f32 v237, v136
    v_sub_u32 v237, -71, v237
    v_exp_f32 v189, v189
    v_cvt_f32_i32 v232, v237
    v_cvt_pk_bf16_f32 v232, v232, 0
    v_exp_f32 v190, v190
    s_nop 0
    v_mfma_f32_32x32x16_bf16 v[64:79], v[228:231], v[232:235], v[64:79]
    v_exp_f32 v191, v191
    v_mfma_f32_32x32x16_bf16 v[96:111], v[8:11], v[40:43], v[48:63]
    v_exp_f32 v80, v80
    v_exp_f32 v81, v81
    v_exp_f32 v82, v82
    v_smfmac_f32_32x32x32_bf16 v[112:127], v[24:27], v[176:183], v7
    v_exp_f32 v83, v83
    v_exp_f32 v84, v84
    v_exp_f32 v85, v85
    v_smfmac_f32_32x32x32_bf16 v[112:127], v[28:31], v[184:191], v7
    v_exp_f32 v86, v86
    v_exp_f32 v87, v87
    v_exp_f32 v88, v88
    v_exp_f32 v89, v89
    v_exp_f32 v90, v90
    v_exp_f32 v91, v91
    v_exp_f32 v92, v92
    v_exp_f32 v93, v93
    v_exp_f32 v94, v94
    v_exp_f32 v95, v95
    s_nop 1
    v_ldexp_f32 v112, v112, v236
    v_ldexp_f32 v113, v113, v236
    v_ldexp_f32 v114, v114, v236
    v_ldexp_f32 v115, v115, v236
    v_ldexp_f32 v116, v116, v236
    v_ldexp_f32 v117, v117, v236
    v_ldexp_f32 v118, v118, v236
    v_ldexp_f32 v119, v119, v236
    v_ldexp_f32 v120, v120, v236
    v_mfma_f32_32x32x16_bf16 v[176:191], v[8:11], v[44:47], v[64:79]
    v_exp_f32 v96, v96
    v_exp_f32 v97, v97
    v_exp_f32 v98, v98
    v_smfmac_f32_32x32x32_bf16 v[128:143], v[24:27], v[80:87], v7
    v_exp_f32 v99, v99
    v_exp_f32 v100, v100
    v_exp_f32 v101, v101
    v_smfmac_f32_32x32x32_bf16 v[128:143], v[28:31], v[88:95], v7
    s_waitcnt lgkmcnt(0)
    ds_read_b128 v[8:11], v249 offset:33024
    ds_read_b128 v[24:27], v247 offset:41280
    ds_read_b128 v[28:31], v248 offset:41280
    v_exp_f32 v102, v102
    v_exp_f32 v103, v103
    v_exp_f32 v104, v104
    v_exp_f32 v105, v105
    v_exp_f32 v106, v106
    v_exp_f32 v107, v107
    v_exp_f32 v108, v108
    v_exp_f32 v109, v109
    v_exp_f32 v110, v110
    v_exp_f32 v111, v111
    v_ldexp_f32 v128, v128, v237
    v_ldexp_f32 v129, v129, v237
    v_ldexp_f32 v130, v130, v237
    v_ldexp_f32 v131, v131, v237
    v_ldexp_f32 v132, v132, v237
    v_ldexp_f32 v133, v133, v237
    v_ldexp_f32 v134, v134, v237
    v_ldexp_f32 v135, v135, v237
    v_ldexp_f32 v136, v136, v237
    v_mfma_f32_32x32x16_bf16 v[80:95], v[12:15], v[40:43], v[48:63]
    v_exp_f32 v176, v176
    v_exp_f32 v177, v177
    v_exp_f32 v178, v178
    v_smfmac_f32_32x32x32_bf16 v[112:127], v[16:19], v[96:103], v7
    v_exp_f32 v179, v179
    v_exp_f32 v180, v180
    v_exp_f32 v181, v181
    v_smfmac_f32_32x32x32_bf16 v[112:127], v[20:23], v[104:111], v7
    v_exp_f32 v182, v182
    v_exp_f32 v183, v183
    v_exp_f32 v184, v184
    v_exp_f32 v185, v185
    v_exp_f32 v186, v186
    v_exp_f32 v187, v187
    v_exp_f32 v188, v188
    v_exp_f32 v189, v189
    v_exp_f32 v190, v190
    v_exp_f32 v191, v191
    v_mfma_f32_32x32x16_bf16 v[96:111], v[12:15], v[44:47], v[64:79]
    v_exp_f32 v80, v80
    v_exp_f32 v81, v81
    v_exp_f32 v82, v82
    v_smfmac_f32_32x32x32_bf16 v[128:143], v[16:19], v[176:183], v7
    v_exp_f32 v83, v83
    v_exp_f32 v84, v84
    v_exp_f32 v85, v85
    v_smfmac_f32_32x32x32_bf16 v[128:143], v[20:23], v[184:191], v7
    s_waitcnt lgkmcnt(0)
    ds_read_b128 v[12:15], v249 offset:41280
    ds_read_b128 v[16:19], v250 offset:33024
    ds_read_b128 v[20:23], v251 offset:33024
    v_exp_f32 v86, v86
    v_exp_f32 v87, v87
    v_exp_f32 v88, v88
    v_exp_f32 v89, v89
    v_exp_f32 v90, v90
    v_exp_f32 v91, v91
    v_exp_f32 v92, v92
    v_exp_f32 v93, v93
    v_exp_f32 v94, v94
    v_exp_f32 v95, v95
    v_mfma_f32_32x32x16_bf16 v[176:191], v[8:11], v[40:43], v[48:63]
    v_exp_f32 v96, v96
    v_exp_f32 v97, v97
    v_exp_f32 v98, v98
    v_smfmac_f32_32x32x32_bf16 v[112:127], v[24:27], v[80:87], v7
    v_exp_f32 v99, v99
    v_exp_f32 v100, v100
    v_exp_f32 v101, v101
    v_smfmac_f32_32x32x32_bf16 v[112:127], v[28:31], v[88:95], v7
    v_exp_f32 v102, v102
    v_exp_f32 v103, v103
    v_exp_f32 v104, v104
    v_exp_f32 v105, v105
    v_exp_f32 v106, v106
    v_exp_f32 v107, v107
    v_exp_f32 v108, v108
    v_exp_f32 v109, v109
    v_exp_f32 v110, v110
    v_exp_f32 v111, v111
    v_mfma_f32_32x32x16_bf16 v[80:95], v[8:11], v[44:47], v[64:79]
    v_exp_f32 v176, v176
    v_exp_f32 v177, v177
    v_exp_f32 v178, v178
    v_smfmac_f32_32x32x32_bf16 v[128:143], v[24:27], v[96:103], v7
    v_exp_f32 v179, v179
    v_exp_f32 v180, v180
    v_exp_f32 v181, v181
    v_smfmac_f32_32x32x32_bf16 v[128:143], v[28:31], v[104:111], v7
    s_waitcnt lgkmcnt(0)
    ds_read_b128 v[8:11], v240 offset:49536
    ds_read_b128 v[24:27], v250 offset:41280
L_tp8800:
    s_cbranch_execz L_ret_d
    ds_read_b128 v[28:31], v251 offset:41280
    v_exp_f32 v182, v182
    v_exp_f32 v183, v183
    v_exp_f32 v184, v184
    v_exp_f32 v185, v185
    v_exp_f32 v186, v186
    v_exp_f32 v187, v187
    v_exp_f32 v188, v188
    v_exp_f32 v189, v189
    v_exp_f32 v190, v190
    v_exp_f32 v191, v191
    v_mfma_f32_32x32x16_bf16 v[96:111], v[12:15], v[40:43], v[48:63]
    v_exp_f32 v80, v80
    v_exp_f32 v81, v81
    v_exp_f32 v82, v82
    v_smfmac_f32_32x32x32_bf16 v[112:127], v[16:19], v[176:183], v7
    v_exp_f32 v83, v83
    v_exp_f32 v84, v84
    v_exp_f32 v85, v85
    v_smfmac_f32_32x32x32_bf16 v[112:127], v[20:23], v[184:191], v7
    v_exp_f32 v86, v86
    v_exp_f32 v87, v87
    v_exp_f32 v88, v88
    v_exp_f32 v89, v89
    v_exp_f32 v90, v90
    v_exp_f32 v91, v91
    v_exp_f32 v92, v92
    v_exp_f32 v93, v93
    v_exp_f32 v94, v94
    v_exp_f32 v95, v95
    v_mfma_f32_32x32x16_bf16 v[176:191], v[12:15], v[44:47], v[64:79]
    v_exp_f32 v96, v96
    v_exp_f32 v97, v97
    v_exp_f32 v98, v98
    v_smfmac_f32_32x32x32_bf16 v[128:143], v[16:19], v[80:87], v7
    v_exp_f32 v99, v99
    v_exp_f32 v100, v100
    v_exp_f32 v101, v101
    v_smfmac_f32_32x32x32_bf16 v[128:143], v[20:23], v[88:95], v7
    s_waitcnt lgkmcnt(0)
    ds_read_b128 v[12:15], v240 offset:57792
    ds_read_b128 v[16:19], v241 offset:49536
    ds_read_b128 v[20:23], v242 offset:49536
    v_exp_f32 v102, v102
    v_exp_f32 v103, v103
    v_exp_f32 v104, v104
    v_exp_f32 v105, v105
    v_exp_f32 v106, v106
    v_exp_f32 v107, v107
    v_exp_f32 v108, v108
    v_exp_f32 v109, v109
    v_exp_f32 v110, v110
    v_exp_f32 v111, v111
    v_mfma_f32_32x32x16_bf16 v[80:95], v[8:11], v[40:43], v[48:63]
    v_exp_f32 v176, v176
    v_exp_f32 v177, v177
    v_exp_f32 v178, v178
    v_smfmac_f32_32x32x32_bf16 v[112:127], v[24:27], v[96:103], v7
    v_exp_f32 v179, v179
    v_exp_f32 v180, v180
    v_exp_f32 v181, v181
    v_smfmac_f32_32x32x32_bf16 v[112:127], v[28:31], v[104:111], v7
    v_exp_f32 v182, v182
    v_exp_f32 v183, v183
    v_exp_f32 v184, v184
    v_exp_f32 v185, v185
    v_exp_f32 v186, v186
    v_exp_f32 v187, v187
    v_exp_f32 v188, v188
    v_exp_f32 v189, v189
    v_exp_f32 v190, v190
    v_exp_f32 v191, v191
    v_mfma_f32_32x32x16_bf16 v[96:111], v[8:11], v[44:47], v[64:79]
    v_exp_f32 v80, v80
    v_exp_f32 v81, v81
    v_exp_f32 v82, v82
    v_smfmac_f32_32x32x32_bf16 v[128:143], v[24:27], v[176:183], v7
    v_exp_f32 v83, v83
    v_exp_f32 v84, v84
    v_exp_f32 v85, v85
    v_smfmac_f32_32x32x32_bf16 v[128:143], v[28:31], v[184:191], v7
    s_waitcnt lgkmcnt(0)
    ds_read_b128 v[8:11], v243 offset:49536
    ds_read_b128 v[24:27], v241 offset:57792
    ds_read_b128 v[28:31], v242 offset:57792
    v_exp_f32 v86, v86
    v_exp_f32 v87, v87
    v_exp_f32 v88, v88
    v_exp_f32 v89, v89
    v_exp_f32 v90, v90
    v_exp_f32 v91, v91
    v_exp_f32 v92, v92
    v_exp_f32 v93, v93
    v_exp_f32 v94, v94
    v_exp_f32 v95, v95
    v_mfma_f32_32x32x16_bf16 v[176:191], v[12:15], v[40:43], v[48:63]
    v_exp_f32 v96, v96
    v_exp_f32 v97, v97
    v_exp_f32 v98, v98
    v_smfmac_f32_32x32x32_bf16 v[112:127], v[16:19], v[80:87], v7
    v_exp_f32 v99, v99
    v_exp_f32 v100, v100
    v_exp_f32 v101, v101
    v_smfmac_f32_32x32x32_bf16 v[112:127], v[20:23], v[88:95], v7
    v_exp_f32 v102, v102
    v_exp_f32 v103, v103
    v_exp_f32 v104, v104
    v_exp_f32 v105, v105
    v_exp_f32 v106, v106
    v_exp_f32 v107, v107
    v_exp_f32 v108, v108
    v_exp_f32 v109, v109
    v_exp_f32 v110, v110
    v_exp_f32 v111, v111
    v_mfma_f32_32x32x16_bf16 v[80:95], v[12:15], v[44:47], v[64:79]
    v_exp_f32 v176, v176
    v_exp_f32 v177, v177
    v_exp_f32 v178, v178
    v_smfmac_f32_32x32x32_bf16 v[128:143], v[16:19], v[96:103], v7
    v_exp_f32 v179, v179
    v_exp_f32 v180, v180
    v_exp_f32 v181, v181
    v_smfmac_f32_32x32x32_bf16 v[128:143], v[20:23], v[104:111], v7
    s_waitcnt lgkmcnt(0)
    ds_read_b128 v[12:15], v243 offset:57792
    ds_read_b128 v[16:19], v244 offset:49536
    ds_read_b128 v[20:23], v245 offset:49536
    v_exp_f32 v182, v182
    v_exp_f32 v183, v183
    v_exp_f32 v184, v184
    v_exp_f32 v185, v185
    v_exp_f32 v186, v186
    v_exp_f32 v187, v187
    v_exp_f32 v188, v188
    v_exp_f32 v189, v189
    v_exp_f32 v190, v190
    v_exp_f32 v191, v191
    v_mfma_f32_32x32x16_bf16 v[96:111], v[8:11], v[40:43], v[48:63]
    v_exp_f32 v80, v80
    v_exp_f32 v81, v81
    v_exp_f32 v82, v82
    v_smfmac_f32_32x32x32_bf16 v[112:127], v[24:27], v[176:183], v7
    v_exp_f32 v83, v83
    v_exp_f32 v84, v84
    v_exp_f32 v85, v85
    v_smfmac_f32_32x32x32_bf16 v[112:127], v[28:31], v[184:191], v7
    v_exp_f32 v86, v86
    v_exp_f32 v87, v87
    v_exp_f32 v88, v88
    v_exp_f32 v89, v89
    v_exp_f32 v90, v90
    v_exp_f32 v91, v91
    v_exp_f32 v92, v92
    v_exp_f32 v93, v93
    v_exp_f32 v94, v94
    v_exp_f32 v95, v95
    v_mfma_f32_32x32x16_bf16 v[176:191], v[8:11], v[44:47], v[64:79]
    v_exp_f32 v96, v96
    v_exp_f32 v97, v97
    v_exp_f32 v98, v98
    v_smfmac_f32_32x32x32_bf16 v[128:143], v[24:27], v[80:87], v7
    v_exp_f32 v99, v99
    v_exp_f32 v100, v100
    v_exp_f32 v101, v101
    v_smfmac_f32_32x32x32_bf16 v[128:143], v[28:31], v[88:95], v7
    s_waitcnt lgkmcnt(0)
    ds_read_b128 v[8:11], v246 offset:49536
    ds_read_b128 v[24:27], v244 offset:57792
    ds_read_b128 v[28:31], v245 offset:57792
    v_exp_f32 v102, v102
    v_exp_f32 v103, v103
    v_exp_f32 v104, v104
    v_exp_f32 v105, v105
    v_exp_f32 v106, v106
    v_exp_f32 v107, v107
    v_exp_f32 v108, v108
    v_exp_f32 v109, v109
    v_exp_f32 v110, v110
    v_exp_f32 v111, v111
    v_mfma_f32_32x32x16_bf16 v[80:95], v[12:15], v[40:43], v[48:63]
    v_exp_f32 v176, v176
    v_exp_f32 v177, v177
    v_exp_f32 v178, v178
    v_smfmac_f32_32x32x32_bf16 v[112:127], v[16:19], v[96:103], v7
    v_exp_f32 v179, v179
    v_exp_f32 v180, v180
    v_exp_f32 v181, v181
    v_smfmac_f32_32x32x32_bf16 v[112:127], v[20:23], v[104:111], v7
    v_exp_f32 v182, v182
    v_exp_f32 v183, v183
    v_exp_f32 v184, v184
    v_exp_f32 v185, v185
    v_exp_f32 v186, v186
    v_exp_f32 v187, v187
    v_exp_f32 v188, v188
    v_exp_f32 v189, v189
    v_exp_f32 v190, v190
    v_exp_f32 v191, v191
    v_mfma_f32_32x32x16_bf16 v[96:111], v[12:15], v[44:47], v[64:79]
    v_exp_f32 v80, v80
    v_exp_f32 v81, v81
    v_exp_f32 v82, v82
    v_smfmac_f32_32x32x32_bf16 v[128:143], v[16:19], v[176:183], v7
    v_exp_f32 v83, v83
    v_exp_f32 v84, v84
    v_exp_f32 v85, v85
    v_smfmac_f32_32x32x32_bf16 v[128:143], v[20:23], v[184:191], v7
    s_waitcnt lgkmcnt(0)
    ds_read_b128 v[12:15], v246 offset:57792
    ds_read_b128 v[16:19], v247 offset:49536
    ds_read_b128 v[20:23], v248 offset:49536
    v_exp_f32 v86, v86
    v_exp_f32 v87, v87
    v_exp_f32 v88, v88
    v_exp_f32 v89, v89
    v_exp_f32 v90, v90
    v_exp_f32 v91, v91
    v_exp_f32 v92, v92
    v_exp_f32 v93, v93
    v_exp_f32 v94, v94
    v_exp_f32 v95, v95
    v_mfma_f32_32x32x16_bf16 v[176:191], v[8:11], v[40:43], v[48:63]
    v_exp_f32 v96, v96
    v_exp_f32 v97, v97
    v_exp_f32 v98, v98
    v_smfmac_f32_32x32x32_bf16 v[112:127], v[24:27], v[80:87], v7
    v_exp_f32 v99, v99
    v_exp_f32 v100, v100
    v_exp_f32 v101, v101
    v_smfmac_f32_32x32x32_bf16 v[112:127], v[28:31], v[88:95], v7
    v_exp_f32 v102, v102
    v_exp_f32 v103, v103
    v_exp_f32 v104, v104
    v_exp_f32 v105, v105
    v_exp_f32 v106, v106
    v_exp_f32 v107, v107
    v_exp_f32 v108, v108
    v_exp_f32 v109, v109
    v_exp_f32 v110, v110
    v_exp_f32 v111, v111
    v_mfma_f32_32x32x16_bf16 v[80:95], v[8:11], v[44:47], v[64:79]
    v_exp_f32 v176, v176
    v_exp_f32 v177, v177
    v_exp_f32 v178, v178
    v_smfmac_f32_32x32x32_bf16 v[128:143], v[24:27], v[96:103], v7
    v_exp_f32 v179, v179
    v_exp_f32 v180, v180
    v_exp_f32 v181, v181
    v_smfmac_f32_32x32x32_bf16 v[128:143], v[28:31], v[104:111], v7
    s_waitcnt lgkmcnt(0)
    ds_read_b128 v[8:11], v249 offset:49536
    ds_read_b128 v[24:27], v247 offset:57792
    ds_read_b128 v[28:31], v248 offset:57792
    v_exp_f32 v182, v182
    v_exp_f32 v183, v183
    v_exp_f32 v184, v184
    v_exp_f32 v185, v185
    v_exp_f32 v186, v186
    v_exp_f32 v187, v187
    v_exp_f32 v188, v188
    v_exp_f32 v189, v189
    v_exp_f32 v190, v190
    v_exp_f32 v191, v191
    v_mfma_f32_32x32x16_bf16 v[96:111], v[12:15], v[40:43], v[48:63]
    v_exp_f32 v80, v80
    v_exp_f32 v81, v81
    v_exp_f32 v82, v82
    v_smfmac_f32_32x32x32_bf16 v[112:127], v[16:19], v[176:183], v7
    v_exp_f32 v83, v83
    v_exp_f32 v84, v84
    v_exp_f32 v85, v85
    v_smfmac_f32_32x32x32_bf16 v[112:127], v[20:23], v[184:191], v7
    v_exp_f32 v86, v86
    v_exp_f32 v87, v87
    v_exp_f32 v88, v88
    v_exp_f32 v89, v89
    v_exp_f32 v90, v90
    v_exp_f32 v91, v91
    v_exp_f32 v92, v92
    v_exp_f32 v93, v93
    v_exp_f32 v94, v94
    v_exp_f32 v95, v95
    v_mfma_f32_32x32x16_bf16 v[176:191], v[12:15], v[44:47], v[64:79]
    v_exp_f32 v96, v96
    v_exp_f32 v97, v97
    v_exp_f32 v98, v98
    v_smfmac_f32_32x32x32_bf16 v[128:143], v[16:19], v[80:87], v7
    v_exp_f32 v99, v99
    v_exp_f32 v100, v100
    v_exp_f32 v101, v101
    v_smfmac_f32_32x32x32_bf16 v[128:143], v[20:23], v[88:95], v7
    s_waitcnt lgkmcnt(0)
    ds_read_b128 v[12:15], v249 offset:57792
    ds_read_b128 v[16:19], v250 offset:49536
    ds_read_b128 v[20:23], v251 offset:49536
    v_exp_f32 v102, v102
    v_exp_f32 v103, v103
    v_exp_f32 v104, v104
    v_exp_f32 v105, v105
    v_exp_f32 v106, v106
    v_exp_f32 v107, v107
    v_exp_f32 v108, v108
    v_exp_f32 v109, v109
    v_exp_f32 v110, v110
    v_exp_f32 v111, v111
    v_mfma_f32_32x32x16_bf16 v[80:95], v[8:11], v[40:43], v[48:63]
    v_exp_f32 v176, v176
    v_exp_f32 v177, v177
    v_exp_f32 v178, v178
    v_smfmac_f32_32x32x32_bf16 v[112:127], v[24:27], v[96:103], v7
    v_exp_f32 v179, v179
    v_exp_f32 v180, v180
    v_exp_f32 v181, v181
    v_smfmac_f32_32x32x32_bf16 v[112:127], v[28:31], v[104:111], v7
    ds_read_b32 v145, v144 offset:28
    v_exp_f32 v182, v182
    v_exp_f32 v183, v183
    v_exp_f32 v184, v184
    v_exp_f32 v185, v185
    v_exp_f32 v186, v186
    v_exp_f32 v187, v187
    v_exp_f32 v188, v188
    v_exp_f32 v189, v189
    v_exp_f32 v190, v190
    v_exp_f32 v191, v191
    v_mfma_f32_32x32x16_bf16 v[96:111], v[8:11], v[44:47], v[64:79]
    v_exp_f32 v80, v80
    v_exp_f32 v81, v81
    v_exp_f32 v82, v82
    v_smfmac_f32_32x32x32_bf16 v[128:143], v[24:27], v[176:183], v7
    v_exp_f32 v83, v83
    v_exp_f32 v84, v84
    v_exp_f32 v85, v85
    v_smfmac_f32_32x32x32_bf16 v[128:143], v[28:31], v[184:191], v7
    s_waitcnt lgkmcnt(0)
    v_cmp_ne_u32 vcc, 626944, v145
    s_nop 0
    s_cbranch_vccnz L_eKV3_sl_170
L_eKV3_ok_169:
    ds_read_b128 v[8:11], v3 offset:0
    ds_read_b128 v[24:27], v250 offset:57792
    ds_read_b128 v[28:31], v251 offset:57792
    v_exp_f32 v86, v86
    v_exp_f32 v87, v87
    v_exp_f32 v88, v88
    v_exp_f32 v89, v89
    v_exp_f32 v90, v90
    v_exp_f32 v91, v91
    v_exp_f32 v92, v92
    v_exp_f32 v93, v93
    v_exp_f32 v94, v94
    v_exp_f32 v95, v95
    v_mfma_f32_32x32x16_bf16 v[176:191], v[12:15], v[40:43], v[48:63]
    v_exp_f32 v96, v96
    v_exp_f32 v97, v97
    v_exp_f32 v98, v98
    v_smfmac_f32_32x32x32_bf16 v[112:127], v[16:19], v[80:87], v7
    v_exp_f32 v99, v99
    v_exp_f32 v100, v100
    v_exp_f32 v101, v101
    v_smfmac_f32_32x32x32_bf16 v[112:127], v[20:23], v[88:95], v7
    v_exp_f32 v102, v102
    v_exp_f32 v103, v103
    v_exp_f32 v104, v104
    v_exp_f32 v105, v105
    v_exp_f32 v106, v106
    v_exp_f32 v107, v107
    v_exp_f32 v108, v108
    v_exp_f32 v109, v109
    v_exp_f32 v110, v110
    v_exp_f32 v111, v111
    v_mfma_f32_32x32x16_bf16 v[80:95], v[12:15], v[44:47], v[64:79]
    v_exp_f32 v176, v176
    v_exp_f32 v177, v177
    v_exp_f32 v178, v178
    v_smfmac_f32_32x32x32_bf16 v[128:143], v[16:19], v[96:103], v7
    v_exp_f32 v179, v179
    v_exp_f32 v180, v180
    v_exp_f32 v181, v181
    v_smfmac_f32_32x32x32_bf16 v[128:143], v[20:23], v[104:111], v7
    s_waitcnt lgkmcnt(0)
    ds_read_b128 v[12:15], v3 offset:2064
    ds_read_b128 v[16:19], v4 offset:0
    ds_read_b128 v[20:23], v5 offset:0
    v_exp_f32 v182, v182
    v_exp_f32 v183, v183
    v_exp_f32 v184, v184
    v_exp_f32 v185, v185
    v_exp_f32 v186, v186
    v_exp_f32 v187, v187
    v_exp_f32 v188, v188
    v_exp_f32 v189, v189
    v_exp_f32 v190, v190
    v_exp_f32 v191, v191
    v_mfma_f32_32x32x16_bf16 v[96:111], v[8:11], v[40:43], v[48:63]
    v_exp_f32 v80, v80
    v_exp_f32 v81, v81
    v_exp_f32 v82, v82
    v_smfmac_f32_32x32x32_bf16 v[112:127], v[24:27], v[176:183], v7
    v_exp_f32 v83, v83
    v_exp_f32 v84, v84
    v_exp_f32 v85, v85
    v_smfmac_f32_32x32x32_bf16 v[112:127], v[28:31], v[184:191], v7
    v_exp_f32 v86, v86
    v_exp_f32 v87, v87
    v_exp_f32 v88, v88
    v_exp_f32 v89, v89
    v_exp_f32 v90, v90
    v_exp_f32 v91, v91
    v_exp_f32 v92, v92
    v_exp_f32 v93, v93
    v_exp_f32 v94, v94
    v_exp_f32 v95, v95
    v_mfma_f32_32x32x16_bf16 v[176:191], v[8:11], v[44:47], v[64:79]
    v_exp_f32 v96, v96
    v_exp_f32 v97, v97
    v_exp_f32 v98, v98
    v_smfmac_f32_32x32x32_bf16 v[128:143], v[24:27], v[80:87], v7
    v_exp_f32 v99, v99
    v_exp_f32 v100, v100
    v_exp_f32 v101, v101
    v_smfmac_f32_32x32x32_bf16 v[128:143], v[28:31], v[88:95], v7
    s_waitcnt lgkmcnt(0)
    ds_read_b128 v[8:11], v3 offset:4128
    ds_read_b128 v[24:27], v4 offset:2064
    ds_read_b128 v[28:31], v5 offset:2064
    v_exp_f32 v102, v102
    v_exp_f32 v103, v103
    v_exp_f32 v104, v104
    v_exp_f32 v105, v105
    v_exp_f32 v106, v106
    v_exp_f32 v107, v107
    v_exp_f32 v108, v108
    v_exp_f32 v109, v109
    v_exp_f32 v110, v110
    v_exp_f32 v111, v111
    v_mfma_f32_32x32x16_bf16 v[80:95], v[12:15], v[40:43], v[48:63]
    v_exp_f32 v176, v176
    v_exp_f32 v177, v177
    v_exp_f32 v178, v178
    v_smfmac_f32_32x32x32_bf16 v[112:127], v[16:19], v[96:103], v7
    v_exp_f32 v179, v179
    v_exp_f32 v180, v180
    v_exp_f32 v181, v181
    v_smfmac_f32_32x32x32_bf16 v[112:127], v[20:23], v[104:111], v7
    s_mov_b64 exec, 1
    ds_add_u32 v144, v144 offset:40
    s_mov_b64 exec, -1
    v_exp_f32 v182, v182
    v_exp_f32 v183, v183
    v_exp_f32 v184, v184
    v_exp_f32 v185, v185
    v_exp_f32 v186, v186
    v_exp_f32 v187, v187
    v_exp_f32 v188, v188
    v_exp_f32 v189, v189
    v_exp_f32 v190, v190
    v_exp_f32 v191, v191
    v_mfma_f32_32x32x16_bf16 v[96:111], v[12:15], v[44:47], v[64:79]
    v_exp_f32 v80, v80
    v_exp_f32 v81, v81
    v_exp_f32 v82, v82
    v_smfmac_f32_32x32x32_bf16 v[128:143], v[16:19], v[176:183], v7
    v_exp_f32 v83, v83
    v_exp_f32 v84, v84
    v_exp_f32 v85, v85
    v_smfmac_f32_32x32x32_bf16 v[128:143], v[20:23], v[184:191], v7
    s_waitcnt lgkmcnt(0)
    ds_read_b128 v[12:15], v3 offset:6192
    ds_read_b128 v[16:19], v4 offset:4128
    ds_read_b128 v[20:23], v5 offset:4128
    v_exp_f32 v86, v86
    v_exp_f32 v87, v87
    v_exp_f32 v88, v88
    v_exp_f32 v89, v89
    v_exp_f32 v90, v90
    v_exp_f32 v91, v91
    v_exp_f32 v92, v92
    v_exp_f32 v93, v93
    v_exp_f32 v94, v94
    v_exp_f32 v95, v95
    v_mfma_f32_32x32x16_bf16 v[176:191], v[8:11], v[40:43], v[48:63]
    v_exp_f32 v96, v96
    v_exp_f32 v97, v97
    v_exp_f32 v98, v98
    v_smfmac_f32_32x32x32_bf16 v[112:127], v[24:27], v[80:87], v7
    v_exp_f32 v99, v99
    v_exp_f32 v100, v100
    v_exp_f32 v101, v101
    v_smfmac_f32_32x32x32_bf16 v[112:127], v[28:31], v[88:95], v7
    v_exp_f32 v102, v102
    v_exp_f32 v103, v103
    v_exp_f32 v104, v104
    v_exp_f32 v105, v105
    v_exp_f32 v106, v106
    v_exp_f32 v107, v107
    v_exp_f32 v108, v108
    v_exp_f32 v109, v109
    v_exp_f32 v110, v110
    v_exp_f32 v111, v111
    v_mfma_f32_32x32x16_bf16 v[80:95], v[8:11], v[44:47], v[64:79]
    v_exp_f32 v176, v176
    v_exp_f32 v177, v177
    v_exp_f32 v178, v178
    v_smfmac_f32_32x32x32_bf16 v[128:143], v[24:27], v[96:103], v7
    v_exp_f32 v179, v179
    v_exp_f32 v180, v180
    v_exp_f32 v181, v181
    v_smfmac_f32_32x32x32_bf16 v[128:143], v[28:31], v[104:111], v7
    s_waitcnt lgkmcnt(0)
    ds_read_b128 v[8:11], v3 offset:8256
    ds_read_b128 v[24:27], v4 offset:6192
    ds_read_b128 v[28:31], v5 offset:6192
    v_exp_f32 v182, v182
    v_exp_f32 v183, v183
    v_exp_f32 v184, v184
    v_exp_f32 v185, v185
    v_exp_f32 v186, v186
    v_exp_f32 v187, v187
    v_exp_f32 v188, v188
    v_exp_f32 v189, v189
    v_exp_f32 v190, v190
    v_exp_f32 v191, v191
    v_mfma_f32_32x32x16_bf16 v[96:111], v[12:15], v[40:43], v[48:63]
    v_exp_f32 v80, v80
    v_exp_f32 v81, v81
    v_exp_f32 v82, v82
    v_smfmac_f32_32x32x32_bf16 v[112:127], v[16:19], v[176:183], v7
    v_exp_f32 v83, v83
    v_exp_f32 v84, v84
    v_exp_f32 v85, v85
    v_smfmac_f32_32x32x32_bf16 v[112:127], v[20:23], v[184:191], v7
    v_exp_f32 v86, v86
    v_exp_f32 v87, v87
    v_exp_f32 v88, v88
    v_exp_f32 v89, v89
    v_exp_f32 v90, v90
    v_exp_f32 v91, v91
    v_exp_f32 v92, v92
    v_exp_f32 v93, v93
    v_exp_f32 v94, v94
    v_exp_f32 v95, v95
    v_mfma_f32_32x32x16_bf16 v[176:191], v[12:15], v[44:47], v[64:79]
    v_exp_f32 v96, v96
    v_exp_f32 v97, v97
    v_exp_f32 v98, v98
    v_smfmac_f32_32x32x32_bf16 v[128:143], v[16:19], v[80:87], v7
    v_exp_f32 v99, v99
    v_exp_f32 v100, v100
    v_exp_f32 v101, v101
    v_smfmac_f32_32x32x32_bf16 v[128:143], v[20:23], v[88:95], v7
    s_waitcnt lgkmcnt(0)
    ds_read_b128 v[12:15], v3 offset:10320
    ds_read_b128 v[16:19], v4 offset:8256
    ds_read_b128 v[20:23], v5 offset:8256
    v_exp_f32 v102, v102
    v_exp_f32 v103, v103
    v_exp_f32 v104, v104
    v_exp_f32 v105, v105
    v_exp_f32 v106, v106
    v_exp_f32 v107, v107
    v_exp_f32 v108, v108
    v_exp_f32 v109, v109
    v_exp_f32 v110, v110
    v_exp_f32 v111, v111
    v_mfma_f32_32x32x16_bf16 v[80:95], v[8:11], v[40:43], v[48:63]
    v_exp_f32 v176, v176
    v_exp_f32 v177, v177
    v_exp_f32 v178, v178
    v_smfmac_f32_32x32x32_bf16 v[112:127], v[24:27], v[96:103], v7
    v_exp_f32 v179, v179
    v_exp_f32 v180, v180
    v_exp_f32 v181, v181
    v_smfmac_f32_32x32x32_bf16 v[112:127], v[28:31], v[104:111], v7
    v_exp_f32 v182, v182
    v_exp_f32 v183, v183
    v_exp_f32 v184, v184
    v_exp_f32 v185, v185
    v_exp_f32 v186, v186
    v_exp_f32 v187, v187
    v_exp_f32 v188, v188
    v_exp_f32 v189, v189
    v_exp_f32 v190, v190
    v_exp_f32 v191, v191
    v_mfma_f32_32x32x16_bf16 v[96:111], v[8:11], v[44:47], v[64:79]
    v_exp_f32 v80, v80
    v_exp_f32 v81, v81
    v_exp_f32 v82, v82
    v_smfmac_f32_32x32x32_bf16 v[128:143], v[24:27], v[176:183], v7
    v_exp_f32 v83, v83
    v_exp_f32 v84, v84
    v_exp_f32 v85, v85
    v_smfmac_f32_32x32x32_bf16 v[128:143], v[28:31], v[184:191], v7
    s_waitcnt lgkmcnt(0)
    ds_read_b128 v[8:11], v3 offset:12384
    ds_read_b128 v[24:27], v4 offset:10320
    ds_read_b128 v[28:31], v5 offset:10320
    v_exp_f32 v86, v86
    v_exp_f32 v87, v87
    v_exp_f32 v88, v88
    v_exp_f32 v89, v89
    v_exp_f32 v90, v90
    v_exp_f32 v91, v91
    v_exp_f32 v92, v92
    v_exp_f32 v93, v93
    v_exp_f32 v94, v94
    v_exp_f32 v95, v95
    v_mfma_f32_32x32x16_bf16 v[176:191], v[12:15], v[40:43], v[48:63]
    v_exp_f32 v96, v96
    v_exp_f32 v97, v97
    v_exp_f32 v98, v98
    v_smfmac_f32_32x32x32_bf16 v[112:127], v[16:19], v[80:87], v7
    v_exp_f32 v99, v99
    v_exp_f32 v100, v100
    v_exp_f32 v101, v101
    v_smfmac_f32_32x32x32_bf16 v[112:127], v[20:23], v[88:95], v7
    v_exp_f32 v102, v102
    v_exp_f32 v103, v103
    v_exp_f32 v104, v104
    v_exp_f32 v105, v105
    v_exp_f32 v106, v106
    v_exp_f32 v107, v107
    v_exp_f32 v108, v108
    v_exp_f32 v109, v109
    v_exp_f32 v110, v110
    v_exp_f32 v111, v111
    v_mfma_f32_32x32x16_bf16 v[80:95], v[12:15], v[44:47], v[64:79]
    v_exp_f32 v176, v176
    v_exp_f32 v177, v177
    v_exp_f32 v178, v178
    v_smfmac_f32_32x32x32_bf16 v[128:143], v[16:19], v[96:103], v7
    v_exp_f32 v179, v179
    v_exp_f32 v180, v180
    v_exp_f32 v181, v181
    v_smfmac_f32_32x32x32_bf16 v[128:143], v[20:23], v[104:111], v7
    s_waitcnt lgkmcnt(0)
    ds_read_b128 v[12:15], v3 offset:14448
    ds_read_b128 v[16:19], v4 offset:12384
    ds_read_b128 v[20:23], v5 offset:12384
    v_exp_f32 v182, v182
    v_exp_f32 v183, v183
    v_exp_f32 v184, v184
    v_exp_f32 v185, v185
    v_exp_f32 v186, v186
    v_exp_f32 v187, v187
    v_exp_f32 v188, v188
    v_exp_f32 v189, v189
    v_exp_f32 v190, v190
    v_exp_f32 v191, v191
    v_mfma_f32_32x32x16_bf16 v[96:111], v[8:11], v[40:43], v[48:63]
    v_exp_f32 v80, v80
    v_exp_f32 v81, v81
    v_exp_f32 v82, v82
    v_smfmac_f32_32x32x32_bf16 v[112:127], v[24:27], v[176:183], v7
    v_exp_f32 v83, v83
    v_exp_f32 v84, v84
    v_exp_f32 v85, v85
    v_smfmac_f32_32x32x32_bf16 v[112:127], v[28:31], v[184:191], v7
    ds_read_b32 v145, v144 offset:32
    v_exp_f32 v86, v86
    v_exp_f32 v87, v87
    v_exp_f32 v88, v88
    v_exp_f32 v89, v89
    v_exp_f32 v90, v90
    v_exp_f32 v91, v91
    v_exp_f32 v92, v92
    v_exp_f32 v93, v93
    v_exp_f32 v94, v94
    v_exp_f32 v95, v95
    v_mfma_f32_32x32x16_bf16 v[176:191], v[8:11], v[44:47], v[64:79]
    v_exp_f32 v96, v96
    v_exp_f32 v97, v97
    v_exp_f32 v98, v98
    v_smfmac_f32_32x32x32_bf16 v[128:143], v[24:27], v[80:87], v7
    v_exp_f32 v99, v99
    v_exp_f32 v100, v100
    v_exp_f32 v101, v101
    v_smfmac_f32_32x32x32_bf16 v[128:143], v[28:31], v[88:95], v7
    s_waitcnt lgkmcnt(0)
    v_cmp_ne_u32 vcc, 626944, v145
    s_nop 0
    s_cbranch_vccnz L_eKV4_sl_173
L_eKV4_ok_172:
    ds_read_b128 v[8:11], v3 offset:16512
    ds_read_b128 v[24:27], v4 offset:14448
    ds_read_b128 v[28:31], v5 offset:14448
    v_exp_f32 v102, v102
    v_exp_f32 v103, v103
    v_exp_f32 v104, v104
    v_exp_f32 v105, v105
    v_exp_f32 v106, v106
    v_exp_f32 v107, v107
    v_exp_f32 v108, v108
    v_exp_f32 v109, v109
    v_exp_f32 v110, v110
    v_exp_f32 v111, v111
    v_mfma_f32_32x32x16_bf16 v[80:95], v[12:15], v[40:43], v[48:63]
    v_exp_f32 v176, v176
    v_exp_f32 v177, v177
    v_exp_f32 v178, v178
    v_smfmac_f32_32x32x32_bf16 v[112:127], v[16:19], v[96:103], v7
    v_exp_f32 v179, v179
    v_exp_f32 v180, v180
    v_exp_f32 v181, v181
    v_smfmac_f32_32x32x32_bf16 v[112:127], v[20:23], v[104:111], v7
    v_exp_f32 v182, v182
    v_exp_f32 v183, v183
    v_exp_f32 v184, v184
    v_exp_f32 v185, v185
    v_exp_f32 v186, v186
    v_exp_f32 v187, v187
    v_exp_f32 v188, v188
    v_exp_f32 v189, v189
    v_exp_f32 v190, v190
    v_exp_f32 v191, v191
    v_mfma_f32_32x32x16_bf16 v[96:111], v[12:15], v[44:47], v[64:79]
    v_exp_f32 v80, v80
    v_exp_f32 v81, v81
    v_exp_f32 v82, v82
    v_smfmac_f32_32x32x32_bf16 v[128:143], v[16:19], v[176:183], v7
    v_exp_f32 v83, v83
    v_exp_f32 v84, v84
    v_exp_f32 v85, v85
    v_smfmac_f32_32x32x32_bf16 v[128:143], v[20:23], v[184:191], v7
    s_waitcnt lgkmcnt(0)
    ds_read_b128 v[12:15], v3 offset:18576
    ds_read_b128 v[16:19], v4 offset:16512
    ds_read_b128 v[20:23], v5 offset:16512
    v_exp_f32 v86, v86
    v_exp_f32 v87, v87
    v_exp_f32 v88, v88
    v_exp_f32 v89, v89
    v_exp_f32 v90, v90
    v_exp_f32 v91, v91
    v_exp_f32 v92, v92
    v_exp_f32 v93, v93
    v_exp_f32 v94, v94
    v_exp_f32 v95, v95
    v_mfma_f32_32x32x16_bf16 v[176:191], v[8:11], v[40:43], v[48:63]
    v_exp_f32 v96, v96
    v_exp_f32 v97, v97
    v_exp_f32 v98, v98
    v_smfmac_f32_32x32x32_bf16 v[112:127], v[24:27], v[80:87], v7
    v_exp_f32 v99, v99
    v_exp_f32 v100, v100
    v_exp_f32 v101, v101
    v_smfmac_f32_32x32x32_bf16 v[112:127], v[28:31], v[88:95], v7
    v_exp_f32 v102, v102
    v_exp_f32 v103, v103
    v_exp_f32 v104, v104
    v_exp_f32 v105, v105
    v_exp_f32 v106, v106
    v_exp_f32 v107, v107
    v_exp_f32 v108, v108
    v_exp_f32 v109, v109
    v_exp_f32 v110, v110
    v_exp_f32 v111, v111
    v_mfma_f32_32x32x16_bf16 v[80:95], v[8:11], v[44:47], v[64:79]
    v_exp_f32 v176, v176
    v_exp_f32 v177, v177
    v_exp_f32 v178, v178
    v_smfmac_f32_32x32x32_bf16 v[128:143], v[24:27], v[96:103], v7
    v_exp_f32 v179, v179
    v_exp_f32 v180, v180
    v_exp_f32 v181, v181
    v_smfmac_f32_32x32x32_bf16 v[128:143], v[28:31], v[104:111], v7
    s_waitcnt lgkmcnt(0)
    ds_read_b128 v[8:11], v3 offset:20640
    ds_read_b128 v[24:27], v4 offset:18576
    ds_read_b128 v[28:31], v5 offset:18576
    v_exp_f32 v182, v182
    v_exp_f32 v183, v183
    v_exp_f32 v184, v184
    v_exp_f32 v185, v185
    v_exp_f32 v186, v186
    v_exp_f32 v187, v187
    v_exp_f32 v188, v188
    v_exp_f32 v189, v189
    v_exp_f32 v190, v190
    v_exp_f32 v191, v191
    v_mfma_f32_32x32x16_bf16 v[96:111], v[12:15], v[40:43], v[48:63]
    v_exp_f32 v80, v80
    v_exp_f32 v81, v81
    v_exp_f32 v82, v82
    v_smfmac_f32_32x32x32_bf16 v[112:127], v[16:19], v[176:183], v7
    v_exp_f32 v83, v83
    v_exp_f32 v84, v84
    v_exp_f32 v85, v85
    v_smfmac_f32_32x32x32_bf16 v[112:127], v[20:23], v[184:191], v7
    v_exp_f32 v86, v86
    v_exp_f32 v87, v87
    v_exp_f32 v88, v88
    v_exp_f32 v89, v89
    v_exp_f32 v90, v90
    v_exp_f32 v91, v91
    v_exp_f32 v92, v92
    v_exp_f32 v93, v93
    v_exp_f32 v94, v94
    v_exp_f32 v95, v95
    v_mfma_f32_32x32x16_bf16 v[176:191], v[12:15], v[44:47], v[64:79]
    v_exp_f32 v96, v96
    v_exp_f32 v97, v97
    v_exp_f32 v98, v98
    v_smfmac_f32_32x32x32_bf16 v[128:143], v[16:19], v[80:87], v7
    v_exp_f32 v99, v99
    v_exp_f32 v100, v100
    v_exp_f32 v101, v101
    v_smfmac_f32_32x32x32_bf16 v[128:143], v[20:23], v[88:95], v7
    s_waitcnt lgkmcnt(0)
    ds_read_b128 v[12:15], v3 offset:22704
    ds_read_b128 v[16:19], v4 offset:20640
    ds_read_b128 v[20:23], v5 offset:20640
    v_exp_f32 v102, v102
    v_exp_f32 v103, v103
    v_exp_f32 v104, v104
    v_exp_f32 v105, v105
    v_exp_f32 v106, v106
    v_exp_f32 v107, v107
    v_exp_f32 v108, v108
    v_exp_f32 v109, v109
    v_exp_f32 v110, v110
    v_exp_f32 v111, v111
    v_mfma_f32_32x32x16_bf16 v[80:95], v[8:11], v[40:43], v[48:63]
    v_exp_f32 v176, v176
    v_exp_f32 v177, v177
    v_exp_f32 v178, v178
    v_smfmac_f32_32x32x32_bf16 v[112:127], v[24:27], v[96:103], v7
    v_exp_f32 v179, v179
    v_exp_f32 v180, v180
    v_exp_f32 v181, v181
    v_smfmac_f32_32x32x32_bf16 v[112:127], v[28:31], v[104:111], v7
    v_exp_f32 v182, v182
    v_exp_f32 v183, v183
    v_exp_f32 v184, v184
    v_exp_f32 v185, v185
    v_exp_f32 v186, v186
    v_exp_f32 v187, v187
    v_exp_f32 v188, v188
    v_exp_f32 v189, v189
    v_exp_f32 v190, v190
    v_exp_f32 v191, v191
    v_mfma_f32_32x32x16_bf16 v[96:111], v[8:11], v[44:47], v[64:79]
    v_exp_f32 v80, v80
    v_exp_f32 v81, v81
L_tp9686:
    s_cbranch_execz L_ret_d
    v_exp_f32 v82, v82
    v_smfmac_f32_32x32x32_bf16 v[128:143], v[24:27], v[176:183], v7
    v_exp_f32 v83, v83
    v_exp_f32 v84, v84
    v_exp_f32 v85, v85
    v_smfmac_f32_32x32x32_bf16 v[128:143], v[28:31], v[184:191], v7
    s_waitcnt lgkmcnt(0)
    ds_read_b128 v[8:11], v3 offset:24768
    ds_read_b128 v[24:27], v4 offset:22704
    ds_read_b128 v[28:31], v5 offset:22704
    v_exp_f32 v86, v86
    v_exp_f32 v87, v87
    v_exp_f32 v88, v88
    v_exp_f32 v89, v89
    v_exp_f32 v90, v90
    v_exp_f32 v91, v91
    v_exp_f32 v92, v92
    v_exp_f32 v93, v93
    v_exp_f32 v94, v94
    v_exp_f32 v95, v95
    v_mfma_f32_32x32x16_bf16 v[176:191], v[12:15], v[40:43], v[48:63]
    v_exp_f32 v96, v96
    v_exp_f32 v97, v97
    v_exp_f32 v98, v98
    v_smfmac_f32_32x32x32_bf16 v[112:127], v[16:19], v[80:87], v7
    v_exp_f32 v99, v99
    v_exp_f32 v100, v100
    v_exp_f32 v101, v101
    v_smfmac_f32_32x32x32_bf16 v[112:127], v[20:23], v[88:95], v7
    v_exp_f32 v102, v102
    v_exp_f32 v103, v103
    v_exp_f32 v104, v104
    v_exp_f32 v105, v105
    v_exp_f32 v106, v106
    v_exp_f32 v107, v107
    v_exp_f32 v108, v108
    v_exp_f32 v109, v109
    v_exp_f32 v110, v110
    v_exp_f32 v111, v111
    v_mfma_f32_32x32x16_bf16 v[80:95], v[12:15], v[44:47], v[64:79]
    v_exp_f32 v176, v176
    v_exp_f32 v177, v177
    v_exp_f32 v178, v178
    v_smfmac_f32_32x32x32_bf16 v[128:143], v[16:19], v[96:103], v7
    v_exp_f32 v179, v179
    v_exp_f32 v180, v180
    v_exp_f32 v181, v181
    v_smfmac_f32_32x32x32_bf16 v[128:143], v[20:23], v[104:111], v7
    s_waitcnt lgkmcnt(0)
    ds_read_b128 v[12:15], v3 offset:26832
    ds_read_b128 v[16:19], v4 offset:24768
    ds_read_b128 v[20:23], v5 offset:24768
    v_exp_f32 v182, v182
    v_exp_f32 v183, v183
    v_exp_f32 v184, v184
    v_exp_f32 v185, v185
    v_exp_f32 v186, v186
    v_exp_f32 v187, v187
    v_exp_f32 v188, v188
    v_exp_f32 v189, v189
    v_exp_f32 v190, v190
    v_exp_f32 v191, v191
    v_mfma_f32_32x32x16_bf16 v[96:111], v[8:11], v[40:43], v[48:63]
    v_exp_f32 v80, v80
    v_exp_f32 v81, v81
    v_exp_f32 v82, v82
    v_smfmac_f32_32x32x32_bf16 v[112:127], v[24:27], v[176:183], v7
    v_exp_f32 v83, v83
    v_exp_f32 v84, v84
    v_exp_f32 v85, v85
    v_smfmac_f32_32x32x32_bf16 v[112:127], v[28:31], v[184:191], v7
    v_exp_f32 v86, v86
    v_exp_f32 v87, v87
    v_exp_f32 v88, v88
    v_exp_f32 v89, v89
    v_exp_f32 v90, v90
    v_exp_f32 v91, v91
    v_exp_f32 v92, v92
    v_exp_f32 v93, v93
    v_exp_f32 v94, v94
    v_exp_f32 v95, v95
    v_mfma_f32_32x32x16_bf16 v[176:191], v[8:11], v[44:47], v[64:79]
    v_exp_f32 v96, v96
    v_exp_f32 v97, v97
    v_exp_f32 v98, v98
    v_smfmac_f32_32x32x32_bf16 v[128:143], v[24:27], v[80:87], v7
    v_exp_f32 v99, v99
    v_exp_f32 v100, v100
    v_exp_f32 v101, v101
    v_smfmac_f32_32x32x32_bf16 v[128:143], v[28:31], v[88:95], v7
    s_waitcnt lgkmcnt(0)
    ds_read_b128 v[8:11], v3 offset:28896
    ds_read_b128 v[24:27], v4 offset:26832
    ds_read_b128 v[28:31], v5 offset:26832
    v_exp_f32 v102, v102
    v_exp_f32 v103, v103
    v_exp_f32 v104, v104
    v_exp_f32 v105, v105
    v_exp_f32 v106, v106
    v_exp_f32 v107, v107
    v_exp_f32 v108, v108
    v_exp_f32 v109, v109
    v_exp_f32 v110, v110
    v_exp_f32 v111, v111
    v_mfma_f32_32x32x16_bf16 v[80:95], v[12:15], v[40:43], v[48:63]
    v_exp_f32 v176, v176
    v_exp_f32 v177, v177
    v_exp_f32 v178, v178
    v_smfmac_f32_32x32x32_bf16 v[112:127], v[16:19], v[96:103], v7
    v_exp_f32 v179, v179
    v_exp_f32 v180, v180
    v_exp_f32 v181, v181
    v_smfmac_f32_32x32x32_bf16 v[112:127], v[20:23], v[104:111], v7
    v_exp_f32 v182, v182
    v_exp_f32 v183, v183
    v_exp_f32 v184, v184
    v_exp_f32 v185, v185
    v_exp_f32 v186, v186
    v_exp_f32 v187, v187
    v_exp_f32 v188, v188
    v_exp_f32 v189, v189
    v_exp_f32 v190, v190
    v_exp_f32 v191, v191
    v_mfma_f32_32x32x16_bf16 v[96:111], v[12:15], v[44:47], v[64:79]
    v_exp_f32 v80, v80
    v_exp_f32 v81, v81
    v_exp_f32 v82, v82
    v_smfmac_f32_32x32x32_bf16 v[128:143], v[16:19], v[176:183], v7
    v_exp_f32 v83, v83
    v_exp_f32 v84, v84
    v_exp_f32 v85, v85
    v_smfmac_f32_32x32x32_bf16 v[128:143], v[20:23], v[184:191], v7
    s_waitcnt lgkmcnt(0)
    ds_read_b128 v[12:15], v3 offset:30960
    ds_read_b128 v[16:19], v4 offset:28896
    ds_read_b128 v[20:23], v5 offset:28896
    v_exp_f32 v86, v86
    v_exp_f32 v87, v87
    v_exp_f32 v88, v88
    v_exp_f32 v89, v89
    v_exp_f32 v90, v90
    v_exp_f32 v91, v91
    v_exp_f32 v92, v92
    v_exp_f32 v93, v93
    v_exp_f32 v94, v94
    v_exp_f32 v95, v95
    v_mfma_f32_32x32x16_bf16 v[176:191], v[8:11], v[40:43], v[48:63]
    v_exp_f32 v96, v96
    v_exp_f32 v97, v97
    v_exp_f32 v98, v98
    v_smfmac_f32_32x32x32_bf16 v[112:127], v[24:27], v[80:87], v7
    v_exp_f32 v99, v99
    v_exp_f32 v100, v100
    v_exp_f32 v101, v101
    v_smfmac_f32_32x32x32_bf16 v[112:127], v[28:31], v[88:95], v7
    v_exp_f32 v102, v102
    v_exp_f32 v103, v103
    v_exp_f32 v104, v104
    v_exp_f32 v105, v105
    v_exp_f32 v106, v106
    v_exp_f32 v107, v107
    v_exp_f32 v108, v108
    v_exp_f32 v109, v109
    v_exp_f32 v110, v110
    v_exp_f32 v111, v111
    v_mfma_f32_32x32x16_bf16 v[80:95], v[8:11], v[44:47], v[64:79]
    v_exp_f32 v176, v176
    v_exp_f32 v177, v177
    v_exp_f32 v178, v178
    v_smfmac_f32_32x32x32_bf16 v[128:143], v[24:27], v[96:103], v7
    v_exp_f32 v179, v179
    v_exp_f32 v180, v180
    v_exp_f32 v181, v181
    v_smfmac_f32_32x32x32_bf16 v[128:143], v[28:31], v[104:111], v7
    s_waitcnt lgkmcnt(0)
    ds_read_b128 v[8:11], v3 offset:33024
    ds_read_b128 v[24:27], v4 offset:30960
    ds_read_b128 v[28:31], v5 offset:30960
    v_exp_f32 v182, v182
    v_exp_f32 v183, v183
    v_exp_f32 v184, v184
    v_exp_f32 v185, v185
    v_exp_f32 v186, v186
    v_exp_f32 v187, v187
    v_exp_f32 v188, v188
    v_exp_f32 v189, v189
    v_exp_f32 v190, v190
    v_exp_f32 v191, v191
    v_mfma_f32_32x32x16_bf16 v[96:111], v[12:15], v[40:43], v[48:63]
    v_exp_f32 v80, v80
    v_exp_f32 v81, v81
    v_exp_f32 v82, v82
    v_smfmac_f32_32x32x32_bf16 v[112:127], v[16:19], v[176:183], v7
    v_exp_f32 v83, v83
    v_exp_f32 v84, v84
    v_exp_f32 v85, v85
    v_smfmac_f32_32x32x32_bf16 v[112:127], v[20:23], v[184:191], v7
    v_exp_f32 v86, v86
    v_exp_f32 v87, v87
    v_exp_f32 v88, v88
    v_exp_f32 v89, v89
    v_exp_f32 v90, v90
    v_exp_f32 v91, v91
    v_exp_f32 v92, v92
    v_exp_f32 v93, v93
    v_exp_f32 v94, v94
    v_exp_f32 v95, v95
    v_mfma_f32_32x32x16_bf16 v[176:191], v[12:15], v[44:47], v[64:79]
    v_exp_f32 v96, v96
    v_exp_f32 v97, v97
    v_exp_f32 v98, v98
    v_smfmac_f32_32x32x32_bf16 v[128:143], v[16:19], v[80:87], v7
    v_exp_f32 v99, v99
    v_exp_f32 v100, v100
    v_exp_f32 v101, v101
    v_smfmac_f32_32x32x32_bf16 v[128:143], v[20:23], v[88:95], v7
    s_waitcnt lgkmcnt(0)
    ds_read_b128 v[12:15], v3 offset:35088
    ds_read_b128 v[16:19], v4 offset:33024
    ds_read_b128 v[20:23], v5 offset:33024
    v_exp_f32 v102, v102
    v_exp_f32 v103, v103
    v_exp_f32 v104, v104
    v_exp_f32 v105, v105
    v_exp_f32 v106, v106
    v_exp_f32 v107, v107
    v_exp_f32 v108, v108
    v_exp_f32 v109, v109
    v_exp_f32 v110, v110
    v_exp_f32 v111, v111
    v_mfma_f32_32x32x16_bf16 v[80:95], v[8:11], v[40:43], v[48:63]
    v_exp_f32 v176, v176
    v_exp_f32 v177, v177
    v_exp_f32 v178, v178
    v_smfmac_f32_32x32x32_bf16 v[112:127], v[24:27], v[96:103], v7
    v_exp_f32 v179, v179
    v_exp_f32 v180, v180
    v_exp_f32 v181, v181
    v_smfmac_f32_32x32x32_bf16 v[112:127], v[28:31], v[104:111], v7
    v_exp_f32 v182, v182
    v_exp_f32 v183, v183
    v_exp_f32 v184, v184
    v_exp_f32 v185, v185
    v_exp_f32 v186, v186
    v_exp_f32 v187, v187
    v_exp_f32 v188, v188
    v_exp_f32 v189, v189
    v_exp_f32 v190, v190
    v_exp_f32 v191, v191
    v_mfma_f32_32x32x16_bf16 v[96:111], v[8:11], v[44:47], v[64:79]
    v_exp_f32 v80, v80
    v_exp_f32 v81, v81
    v_exp_f32 v82, v82
    v_smfmac_f32_32x32x32_bf16 v[128:143], v[24:27], v[176:183], v7
    v_exp_f32 v83, v83
    v_exp_f32 v84, v84
    v_exp_f32 v85, v85
    v_smfmac_f32_32x32x32_bf16 v[128:143], v[28:31], v[184:191], v7
    s_waitcnt lgkmcnt(0)
    ds_read_b128 v[8:11], v3 offset:37152
    ds_read_b128 v[24:27], v4 offset:35088
    ds_read_b128 v[28:31], v5 offset:35088
    v_exp_f32 v86, v86
    v_exp_f32 v87, v87
    v_exp_f32 v88, v88
    v_exp_f32 v89, v89
    v_exp_f32 v90, v90
    v_exp_f32 v91, v91
    v_exp_f32 v92, v92
    v_exp_f32 v93, v93
    v_exp_f32 v94, v94
    v_exp_f32 v95, v95
    v_mfma_f32_32x32x16_bf16 v[176:191], v[12:15], v[40:43], v[48:63]
    v_exp_f32 v96, v96
    v_exp_f32 v97, v97
    v_exp_f32 v98, v98
    v_smfmac_f32_32x32x32_bf16 v[112:127], v[16:19], v[80:87], v7
    v_exp_f32 v99, v99
    v_exp_f32 v100, v100
    v_exp_f32 v101, v101
    v_smfmac_f32_32x32x32_bf16 v[112:127], v[20:23], v[88:95], v7
    s_mov_b64 exec, 1
    ds_add_u32 v144, v144 offset:48
    s_mov_b64 exec, -1
    v_exp_f32 v102, v102
    v_exp_f32 v103, v103
    v_exp_f32 v104, v104
    v_exp_f32 v105, v105
    v_exp_f32 v106, v106
    v_exp_f32 v107, v107
    v_exp_f32 v108, v108
    v_exp_f32 v109, v109
    v_exp_f32 v110, v110
    v_exp_f32 v111, v111
    v_mfma_f32_32x32x16_bf16 v[80:95], v[12:15], v[44:47], v[64:79]
    v_exp_f32 v176, v176
    v_exp_f32 v177, v177
    v_exp_f32 v178, v178
    v_smfmac_f32_32x32x32_bf16 v[128:143], v[16:19], v[96:103], v7
    v_exp_f32 v179, v179
    v_exp_f32 v180, v180
    v_exp_f32 v181, v181
    v_smfmac_f32_32x32x32_bf16 v[128:143], v[20:23], v[104:111], v7
    s_waitcnt lgkmcnt(0)
    ds_read_b128 v[12:15], v3 offset:39216
    ds_read_b128 v[16:19], v4 offset:37152
    ds_read_b128 v[20:23], v5 offset:37152
    v_exp_f32 v182, v182
    v_exp_f32 v183, v183
    v_exp_f32 v184, v184
    v_exp_f32 v185, v185
    v_exp_f32 v186, v186
    v_exp_f32 v187, v187
    v_exp_f32 v188, v188
    v_exp_f32 v189, v189
    v_exp_f32 v190, v190
    v_exp_f32 v191, v191
    v_mfma_f32_32x32x16_bf16 v[96:111], v[8:11], v[40:43], v[48:63]
    v_exp_f32 v80, v80
    v_exp_f32 v81, v81
    v_exp_f32 v82, v82
    v_smfmac_f32_32x32x32_bf16 v[112:127], v[24:27], v[176:183], v7
    v_exp_f32 v83, v83
    v_exp_f32 v84, v84
    v_exp_f32 v85, v85
    v_smfmac_f32_32x32x32_bf16 v[112:127], v[28:31], v[184:191], v7
    v_exp_f32 v86, v86
    v_exp_f32 v87, v87
    v_exp_f32 v88, v88
    v_exp_f32 v89, v89
    v_exp_f32 v90, v90
    v_exp_f32 v91, v91
    v_exp_f32 v92, v92
    v_exp_f32 v93, v93
    v_exp_f32 v94, v94
    v_exp_f32 v95, v95
    v_mfma_f32_32x32x16_bf16 v[176:191], v[8:11], v[44:47], v[64:79]
    v_exp_f32 v96, v96
    v_exp_f32 v97, v97
    v_exp_f32 v98, v98
    v_smfmac_f32_32x32x32_bf16 v[128:143], v[24:27], v[80:87], v7
    v_exp_f32 v99, v99
    v_exp_f32 v100, v100
    v_exp_f32 v101, v101
    v_smfmac_f32_32x32x32_bf16 v[128:143], v[28:31], v[88:95], v7
    s_waitcnt lgkmcnt(0)
    ds_read_b128 v[8:11], v3 offset:41280
    ds_read_b128 v[24:27], v4 offset:39216
    ds_read_b128 v[28:31], v5 offset:39216
    v_exp_f32 v102, v102
    v_exp_f32 v103, v103
    v_exp_f32 v104, v104
    v_exp_f32 v105, v105
    v_exp_f32 v106, v106
    v_exp_f32 v107, v107
    v_exp_f32 v108, v108
    v_exp_f32 v109, v109
    v_exp_f32 v110, v110
    v_exp_f32 v111, v111
    v_mfma_f32_32x32x16_bf16 v[80:95], v[12:15], v[40:43], v[48:63]
    v_exp_f32 v176, v176
    v_exp_f32 v177, v177
    v_exp_f32 v178, v178
    v_smfmac_f32_32x32x32_bf16 v[112:127], v[16:19], v[96:103], v7
    v_exp_f32 v179, v179
    v_exp_f32 v180, v180
    v_exp_f32 v181, v181
    v_smfmac_f32_32x32x32_bf16 v[112:127], v[20:23], v[104:111], v7
    v_exp_f32 v182, v182
    v_exp_f32 v183, v183
    v_exp_f32 v184, v184
    v_exp_f32 v185, v185
    v_exp_f32 v186, v186
    v_exp_f32 v187, v187
    v_exp_f32 v188, v188
    v_exp_f32 v189, v189
    v_exp_f32 v190, v190
    v_exp_f32 v191, v191
    v_mfma_f32_32x32x16_bf16 v[96:111], v[12:15], v[44:47], v[64:79]
    v_exp_f32 v80, v80
    v_exp_f32 v81, v81
    v_exp_f32 v82, v82
    v_smfmac_f32_32x32x32_bf16 v[128:143], v[16:19], v[176:183], v7
    v_exp_f32 v83, v83
    v_exp_f32 v84, v84
    v_exp_f32 v85, v85
    v_smfmac_f32_32x32x32_bf16 v[128:143], v[20:23], v[184:191], v7
    s_waitcnt lgkmcnt(0)
    ds_read_b128 v[12:15], v3 offset:43344
    ds_read_b128 v[16:19], v4 offset:41280
    ds_read_b128 v[20:23], v5 offset:41280
    v_exp_f32 v86, v86
    v_exp_f32 v87, v87
    v_exp_f32 v88, v88
    v_exp_f32 v89, v89
    v_exp_f32 v90, v90
    v_exp_f32 v91, v91
    v_exp_f32 v92, v92
    v_exp_f32 v93, v93
    v_exp_f32 v94, v94
    v_exp_f32 v95, v95
    v_mfma_f32_32x32x16_bf16 v[176:191], v[8:11], v[40:43], v[48:63]
    v_exp_f32 v96, v96
    v_exp_f32 v97, v97
    v_exp_f32 v98, v98
    v_smfmac_f32_32x32x32_bf16 v[112:127], v[24:27], v[80:87], v7
    v_exp_f32 v99, v99
    v_exp_f32 v100, v100
    v_exp_f32 v101, v101
    v_smfmac_f32_32x32x32_bf16 v[112:127], v[28:31], v[88:95], v7
    v_exp_f32 v102, v102
    v_exp_f32 v103, v103
    v_exp_f32 v104, v104
    v_exp_f32 v105, v105
    v_exp_f32 v106, v106
    v_exp_f32 v107, v107
    v_exp_f32 v108, v108
    v_exp_f32 v109, v109
    v_exp_f32 v110, v110
    v_exp_f32 v111, v111
    v_mfma_f32_32x32x16_bf16 v[80:95], v[8:11], v[44:47], v[64:79]
    v_exp_f32 v176, v176
    v_exp_f32 v177, v177
    v_exp_f32 v178, v178
    v_smfmac_f32_32x32x32_bf16 v[128:143], v[24:27], v[96:103], v7
    v_exp_f32 v179, v179
    v_exp_f32 v180, v180
    v_exp_f32 v181, v181
    v_smfmac_f32_32x32x32_bf16 v[128:143], v[28:31], v[104:111], v7
    s_waitcnt lgkmcnt(0)
    ds_read_b128 v[8:11], v3 offset:45408
    ds_read_b128 v[24:27], v4 offset:43344
    ds_read_b128 v[28:31], v5 offset:43344
    v_exp_f32 v182, v182
    v_exp_f32 v183, v183
    v_exp_f32 v184, v184
    v_exp_f32 v185, v185
    v_exp_f32 v186, v186
    v_exp_f32 v187, v187
    v_exp_f32 v188, v188
    v_exp_f32 v189, v189
    v_exp_f32 v190, v190
    v_exp_f32 v191, v191
    v_mfma_f32_32x32x16_bf16 v[96:111], v[12:15], v[40:43], v[48:63]
    v_exp_f32 v80, v80
    v_exp_f32 v81, v81
    v_exp_f32 v82, v82
    v_smfmac_f32_32x32x32_bf16 v[112:127], v[16:19], v[176:183], v7
    v_exp_f32 v83, v83
    v_exp_f32 v84, v84
    v_exp_f32 v85, v85
    v_smfmac_f32_32x32x32_bf16 v[112:127], v[20:23], v[184:191], v7
    v_exp_f32 v86, v86
    v_exp_f32 v87, v87
    v_exp_f32 v88, v88
    v_exp_f32 v89, v89
    v_exp_f32 v90, v90
    v_exp_f32 v91, v91
    v_exp_f32 v92, v92
    v_exp_f32 v93, v93
    v_exp_f32 v94, v94
    v_exp_f32 v95, v95
    v_mfma_f32_32x32x16_bf16 v[176:191], v[12:15], v[44:47], v[64:79]
    v_exp_f32 v96, v96
    v_exp_f32 v97, v97
    v_exp_f32 v98, v98
    v_smfmac_f32_32x32x32_bf16 v[128:143], v[16:19], v[80:87], v7
    v_exp_f32 v99, v99
    v_exp_f32 v100, v100
    v_exp_f32 v101, v101
    v_smfmac_f32_32x32x32_bf16 v[128:143], v[20:23], v[88:95], v7
    s_waitcnt lgkmcnt(0)
    ds_read_b128 v[12:15], v3 offset:47472
    ds_read_b128 v[16:19], v4 offset:45408
    ds_read_b128 v[20:23], v5 offset:45408
    v_exp_f32 v102, v102
    v_exp_f32 v103, v103
    v_exp_f32 v104, v104
    v_exp_f32 v105, v105
    v_exp_f32 v106, v106
    v_exp_f32 v107, v107
    v_exp_f32 v108, v108
    v_exp_f32 v109, v109
    v_exp_f32 v110, v110
    v_exp_f32 v111, v111
    v_mfma_f32_32x32x16_bf16 v[80:95], v[8:11], v[40:43], v[48:63]
    v_exp_f32 v176, v176
    v_exp_f32 v177, v177
    v_exp_f32 v178, v178
    v_smfmac_f32_32x32x32_bf16 v[112:127], v[24:27], v[96:103], v7
    v_exp_f32 v179, v179
    v_exp_f32 v180, v180
    v_exp_f32 v181, v181
    v_smfmac_f32_32x32x32_bf16 v[112:127], v[28:31], v[104:111], v7
    v_exp_f32 v182, v182
    v_exp_f32 v183, v183
    v_exp_f32 v184, v184
    v_exp_f32 v185, v185
    v_exp_f32 v186, v186
    v_exp_f32 v187, v187
    v_exp_f32 v188, v188
    v_exp_f32 v189, v189
    v_exp_f32 v190, v190
    v_exp_f32 v191, v191
    v_mfma_f32_32x32x16_bf16 v[96:111], v[8:11], v[44:47], v[64:79]
    v_exp_f32 v80, v80
    v_exp_f32 v81, v81
    v_exp_f32 v82, v82
    v_smfmac_f32_32x32x32_bf16 v[128:143], v[24:27], v[176:183], v7
    v_exp_f32 v83, v83
    v_exp_f32 v84, v84
    v_exp_f32 v85, v85
    v_smfmac_f32_32x32x32_bf16 v[128:143], v[28:31], v[184:191], v7
    s_waitcnt lgkmcnt(0)
    ds_read_b128 v[8:11], v3 offset:49536
    ds_read_b128 v[24:27], v4 offset:47472
    ds_read_b128 v[28:31], v5 offset:47472
    v_exp_f32 v86, v86
    v_exp_f32 v87, v87
    v_exp_f32 v88, v88
    v_exp_f32 v89, v89
    v_exp_f32 v90, v90
    v_exp_f32 v91, v91
    v_exp_f32 v92, v92
    v_exp_f32 v93, v93
    v_exp_f32 v94, v94
    v_exp_f32 v95, v95
    v_mfma_f32_32x32x16_bf16 v[176:191], v[12:15], v[40:43], v[48:63]
    v_exp_f32 v96, v96
    v_exp_f32 v97, v97
    v_exp_f32 v98, v98
    v_smfmac_f32_32x32x32_bf16 v[112:127], v[16:19], v[80:87], v7
    v_exp_f32 v99, v99
    v_exp_f32 v100, v100
    v_exp_f32 v101, v101
    v_smfmac_f32_32x32x32_bf16 v[112:127], v[20:23], v[88:95], v7
    v_exp_f32 v102, v102
    v_exp_f32 v103, v103
    v_exp_f32 v104, v104
    v_exp_f32 v105, v105
    v_exp_f32 v106, v106
    v_exp_f32 v107, v107
    v_exp_f32 v108, v108
    v_exp_f32 v109, v109
    v_exp_f32 v110, v110
    v_exp_f32 v111, v111
    v_mfma_f32_32x32x16_bf16 v[80:95], v[12:15], v[44:47], v[64:79]
    v_exp_f32 v176, v176
    v_exp_f32 v177, v177
    v_exp_f32 v178, v178
    v_smfmac_f32_32x32x32_bf16 v[128:143], v[16:19], v[96:103], v7
    v_exp_f32 v179, v179
    v_exp_f32 v180, v180
    v_exp_f32 v181, v181
    v_smfmac_f32_32x32x32_bf16 v[128:143], v[20:23], v[104:111], v7
    s_waitcnt lgkmcnt(0)
    ds_read_b128 v[12:15], v3 offset:51600
    ds_read_b128 v[16:19], v4 offset:49536
    ds_read_b128 v[20:23], v5 offset:49536
    v_exp_f32 v182, v182
    v_exp_f32 v183, v183
    v_exp_f32 v184, v184
    v_exp_f32 v185, v185
    v_exp_f32 v186, v186
    v_exp_f32 v187, v187
    v_exp_f32 v188, v188
    v_exp_f32 v189, v189
    v_exp_f32 v190, v190
    v_exp_f32 v191, v191
    v_mfma_f32_32x32x16_bf16 v[96:111], v[8:11], v[40:43], v[48:63]
    v_exp_f32 v80, v80
    v_exp_f32 v81, v81
    v_exp_f32 v82, v82
    v_smfmac_f32_32x32x32_bf16 v[112:127], v[24:27], v[176:183], v7
    v_exp_f32 v83, v83
    v_exp_f32 v84, v84
    v_exp_f32 v85, v85
    v_smfmac_f32_32x32x32_bf16 v[112:127], v[28:31], v[184:191], v7
    v_exp_f32 v86, v86
    v_exp_f32 v87, v87
    v_exp_f32 v88, v88
    v_exp_f32 v89, v89
    v_exp_f32 v90, v90
    v_exp_f32 v91, v91
    v_exp_f32 v92, v92
    v_exp_f32 v93, v93
    v_exp_f32 v94, v94
    v_exp_f32 v95, v95
    v_mfma_f32_32x32x16_bf16 v[176:191], v[8:11], v[44:47], v[64:79]
    v_exp_f32 v96, v96
    v_exp_f32 v97, v97
    v_exp_f32 v98, v98
    v_smfmac_f32_32x32x32_bf16 v[128:143], v[24:27], v[80:87], v7
    v_exp_f32 v99, v99
    v_exp_f32 v100, v100
    v_exp_f32 v101, v101
    v_smfmac_f32_32x32x32_bf16 v[128:143], v[28:31], v[88:95], v7
    s_waitcnt lgkmcnt(0)
    ds_read_b128 v[8:11], v3 offset:53664
    ds_read_b128 v[24:27], v4 offset:51600
    ds_read_b128 v[28:31], v5 offset:51600
    v_exp_f32 v102, v102
    v_exp_f32 v103, v103
    v_exp_f32 v104, v104
    v_exp_f32 v105, v105
    v_exp_f32 v106, v106
    v_exp_f32 v107, v107
    v_exp_f32 v108, v108
    v_exp_f32 v109, v109
    v_exp_f32 v110, v110
    v_exp_f32 v111, v111
    v_mfma_f32_32x32x16_bf16 v[80:95], v[12:15], v[40:43], v[48:63]
    v_exp_f32 v176, v176
    v_exp_f32 v177, v177
    v_exp_f32 v178, v178
    v_smfmac_f32_32x32x32_bf16 v[112:127], v[16:19], v[96:103], v7
    v_exp_f32 v179, v179
    v_exp_f32 v180, v180
    v_exp_f32 v181, v181
    v_smfmac_f32_32x32x32_bf16 v[112:127], v[20:23], v[104:111], v7
    s_mov_b64 exec, 1
    ds_add_u32 v144, v144 offset:52
    s_mov_b64 exec, -1
    v_exp_f32 v182, v182
    v_exp_f32 v183, v183
    v_exp_f32 v184, v184
    v_exp_f32 v185, v185
    v_exp_f32 v186, v186
    v_exp_f32 v187, v187
    v_exp_f32 v188, v188
    v_exp_f32 v189, v189
    v_exp_f32 v190, v190
    v_exp_f32 v191, v191
    v_mfma_f32_32x32x16_bf16 v[96:111], v[12:15], v[44:47], v[64:79]
    v_exp_f32 v80, v80
    v_exp_f32 v81, v81
    v_exp_f32 v82, v82
    v_smfmac_f32_32x32x32_bf16 v[128:143], v[16:19], v[176:183], v7
    v_exp_f32 v83, v83
    v_exp_f32 v84, v84
    v_exp_f32 v85, v85
    v_smfmac_f32_32x32x32_bf16 v[128:143], v[20:23], v[184:191], v7
    s_waitcnt lgkmcnt(0)
    ds_read_b128 v[12:15], v3 offset:55728
    ds_read_b128 v[16:19], v4 offset:53664
    ds_read_b128 v[20:23], v5 offset:53664
    v_exp_f32 v86, v86
    v_exp_f32 v87, v87
    v_exp_f32 v88, v88
    v_exp_f32 v89, v89
    v_exp_f32 v90, v90
    v_exp_f32 v91, v91
    v_exp_f32 v92, v92
    v_exp_f32 v93, v93
    v_exp_f32 v94, v94
    v_exp_f32 v95, v95
    v_mfma_f32_32x32x16_bf16 v[176:191], v[8:11], v[40:43], v[48:63]
    v_exp_f32 v96, v96
    v_exp_f32 v97, v97
    v_exp_f32 v98, v98
    v_smfmac_f32_32x32x32_bf16 v[112:127], v[24:27], v[80:87], v7
    v_exp_f32 v99, v99
    v_exp_f32 v100, v100
    v_exp_f32 v101, v101
    v_smfmac_f32_32x32x32_bf16 v[112:127], v[28:31], v[88:95], v7
    v_exp_f32 v102, v102
    v_exp_f32 v103, v103
    v_exp_f32 v104, v104
    v_exp_f32 v105, v105
    v_exp_f32 v106, v106
    v_exp_f32 v107, v107
    v_exp_f32 v108, v108
    v_exp_f32 v109, v109
    v_exp_f32 v110, v110
    v_exp_f32 v111, v111
    v_mfma_f32_32x32x16_bf16 v[80:95], v[8:11], v[44:47], v[64:79]
    v_exp_f32 v176, v176
    v_exp_f32 v177, v177
    v_exp_f32 v178, v178
    v_smfmac_f32_32x32x32_bf16 v[128:143], v[24:27], v[96:103], v7
    v_exp_f32 v179, v179
    v_exp_f32 v180, v180
    v_exp_f32 v181, v181
    v_smfmac_f32_32x32x32_bf16 v[128:143], v[28:31], v[104:111], v7
    s_waitcnt lgkmcnt(0)
    ds_read_b128 v[8:11], v3 offset:57792
    ds_read_b128 v[24:27], v4 offset:55728
    ds_read_b128 v[28:31], v5 offset:55728
    v_exp_f32 v182, v182
    v_exp_f32 v183, v183
    v_exp_f32 v184, v184
    v_exp_f32 v185, v185
    v_exp_f32 v186, v186
    v_exp_f32 v187, v187
    v_exp_f32 v188, v188
    v_exp_f32 v189, v189
    v_exp_f32 v190, v190
    v_exp_f32 v191, v191
    v_mfma_f32_32x32x16_bf16 v[96:111], v[12:15], v[40:43], v[48:63]
    v_exp_f32 v80, v80
    v_exp_f32 v81, v81
    v_exp_f32 v82, v82
    v_smfmac_f32_32x32x32_bf16 v[112:127], v[16:19], v[176:183], v7
    v_exp_f32 v83, v83
    v_exp_f32 v84, v84
    v_exp_f32 v85, v85
    v_smfmac_f32_32x32x32_bf16 v[112:127], v[20:23], v[184:191], v7
    v_exp_f32 v86, v86
    v_exp_f32 v87, v87
    v_exp_f32 v88, v88
    v_exp_f32 v89, v89
    v_exp_f32 v90, v90
    v_exp_f32 v91, v91
    v_exp_f32 v92, v92
    v_exp_f32 v93, v93
    v_exp_f32 v94, v94
    v_exp_f32 v95, v95
    v_mfma_f32_32x32x16_bf16 v[176:191], v[12:15], v[44:47], v[64:79]
    v_exp_f32 v96, v96
    v_exp_f32 v97, v97
    v_exp_f32 v98, v98
    v_smfmac_f32_32x32x32_bf16 v[128:143], v[16:19], v[80:87], v7
    v_exp_f32 v99, v99
    v_exp_f32 v100, v100
    v_exp_f32 v101, v101
    v_smfmac_f32_32x32x32_bf16 v[128:143], v[20:23], v[88:95], v7
    s_waitcnt lgkmcnt(0)
    ds_read_b128 v[12:15], v3 offset:59856
    ds_read_b128 v[16:19], v4 offset:57792
    ds_read_b128 v[20:23], v5 offset:57792
    v_exp_f32 v102, v102
    v_exp_f32 v103, v103
    v_exp_f32 v104, v104
    v_exp_f32 v105, v105
    v_exp_f32 v106, v106
    v_exp_f32 v107, v107
    v_exp_f32 v108, v108
    v_exp_f32 v109, v109
    v_exp_f32 v110, v110
    v_exp_f32 v111, v111
    v_mfma_f32_32x32x16_bf16 v[80:95], v[8:11], v[40:43], v[48:63]
    v_exp_f32 v176, v176
    v_exp_f32 v177, v177
    v_exp_f32 v178, v178
    v_smfmac_f32_32x32x32_bf16 v[112:127], v[24:27], v[96:103], v7
    v_exp_f32 v179, v179
    v_exp_f32 v180, v180
    v_exp_f32 v181, v181
    v_smfmac_f32_32x32x32_bf16 v[112:127], v[28:31], v[104:111], v7
    v_exp_f32 v182, v182
    v_exp_f32 v183, v183
    v_exp_f32 v184, v184
    v_exp_f32 v185, v185
    v_exp_f32 v186, v186
    v_exp_f32 v187, v187
    v_exp_f32 v188, v188
    v_exp_f32 v189, v189
    v_exp_f32 v190, v190
    v_exp_f32 v191, v191
    v_mfma_f32_32x32x16_bf16 v[96:111], v[8:11], v[44:47], v[64:79]
    v_exp_f32 v80, v80
    v_exp_f32 v81, v81
    v_exp_f32 v82, v82
    v_smfmac_f32_32x32x32_bf16 v[128:143], v[24:27], v[176:183], v7
    v_exp_f32 v83, v83
    v_exp_f32 v84, v84
    v_exp_f32 v85, v85
    v_smfmac_f32_32x32x32_bf16 v[128:143], v[28:31], v[184:191], v7
    s_waitcnt lgkmcnt(0)
    ds_read_b128 v[8:11], v3 offset:61920
    s_setprio 3
    ds_read_b128 v[24:27], v4 offset:59856
    ds_read_b128 v[28:31], v5 offset:59856
    v_exp_f32 v86, v86
    v_exp_f32 v87, v87
    v_exp_f32 v88, v88
    v_exp_f32 v89, v89
    v_exp_f32 v90, v90
    v_exp_f32 v91, v91
    v_exp_f32 v92, v92
    v_exp_f32 v93, v93
    v_exp_f32 v94, v94
    v_exp_f32 v95, v95
    v_mfma_f32_32x32x16_bf16 v[176:191], v[12:15], v[40:43], v[48:63]
    v_exp_f32 v96, v96
    v_exp_f32 v97, v97
    v_exp_f32 v98, v98
    v_smfmac_f32_32x32x32_bf16 v[112:127], v[16:19], v[80:87], v7
    v_exp_f32 v99, v99
    v_exp_f32 v100, v100
    v_exp_f32 v101, v101
    v_smfmac_f32_32x32x32_bf16 v[112:127], v[20:23], v[88:95], v7
    s_mov_b64 exec, 1
    ds_add_u32 v144, v144 offset:44
    s_mov_b64 exec, -1
    v_exp_f32 v102, v102
    v_exp_f32 v103, v103
    v_exp_f32 v104, v104
    v_exp_f32 v105, v105
    v_exp_f32 v106, v106
    v_exp_f32 v107, v107
    v_exp_f32 v108, v108
    v_exp_f32 v109, v109
    v_exp_f32 v110, v110
    v_exp_f32 v111, v111
    v_mfma_f32_32x32x16_bf16 v[80:95], v[12:15], v[44:47], v[64:79]
    v_exp_f32 v176, v176
    v_exp_f32 v177, v177
    v_exp_f32 v178, v178
    v_smfmac_f32_32x32x32_bf16 v[128:143], v[16:19], v[96:103], v7
    v_exp_f32 v179, v179
    v_exp_f32 v180, v180
    v_exp_f32 v181, v181
    v_smfmac_f32_32x32x32_bf16 v[128:143], v[20:23], v[104:111], v7
    s_waitcnt lgkmcnt(0)
    ds_read_b128 v[12:15], v3 offset:63984
    ds_read_b128 v[16:19], v4 offset:61920
    ds_read_b128 v[20:23], v5 offset:61920
    v_exp_f32 v182, v182
    v_exp_f32 v183, v183
    v_exp_f32 v184, v184
    v_exp_f32 v185, v185
    v_exp_f32 v186, v186
    v_exp_f32 v187, v187
    v_exp_f32 v188, v188
    v_exp_f32 v189, v189
    v_exp_f32 v190, v190
    v_exp_f32 v191, v191
    v_mfma_f32_32x32x16_bf16 v[96:111], v[8:11], v[40:43], v[48:63]
    v_exp_f32 v80, v80
    v_exp_f32 v81, v81
    v_exp_f32 v82, v82
    v_smfmac_f32_32x32x32_bf16 v[112:127], v[24:27], v[176:183], v7
    v_exp_f32 v83, v83
    v_exp_f32 v84, v84
    v_exp_f32 v85, v85
    v_smfmac_f32_32x32x32_bf16 v[112:127], v[28:31], v[184:191], v7
    v_exp_f32 v86, v86
    v_exp_f32 v87, v87
    v_exp_f32 v88, v88
    v_exp_f32 v89, v89
L_tp10568:
    s_cbranch_execz L_ret_d
    v_exp_f32 v90, v90
    v_exp_f32 v91, v91
    v_exp_f32 v92, v92
    v_exp_f32 v93, v93
    v_exp_f32 v94, v94
    v_exp_f32 v95, v95
    v_mfma_f32_32x32x16_bf16 v[176:191], v[8:11], v[44:47], v[64:79]
    v_exp_f32 v96, v96
    v_exp_f32 v97, v97
    v_exp_f32 v98, v98
    v_smfmac_f32_32x32x32_bf16 v[128:143], v[24:27], v[80:87], v7
    v_exp_f32 v99, v99
    v_exp_f32 v100, v100
    v_exp_f32 v101, v101
    v_smfmac_f32_32x32x32_bf16 v[128:143], v[28:31], v[88:95], v7
    s_waitcnt lgkmcnt(0)
    ds_read_b128 v[24:27], v4 offset:63984
    ds_read_b128 v[28:31], v5 offset:63984
    v_exp_f32 v102, v102
    v_exp_f32 v103, v103
    v_exp_f32 v104, v104
    v_exp_f32 v105, v105
    v_exp_f32 v106, v106
    v_exp_f32 v107, v107
    v_exp_f32 v108, v108
    v_exp_f32 v109, v109
    v_exp_f32 v110, v110
    v_exp_f32 v111, v111
    v_mfma_f32_32x32x16_bf16 v[80:95], v[12:15], v[40:43], v[48:63]
    v_exp_f32 v176, v176
    v_exp_f32 v177, v177
    v_exp_f32 v178, v178
    v_smfmac_f32_32x32x32_bf16 v[112:127], v[16:19], v[96:103], v7
    v_exp_f32 v179, v179
    v_exp_f32 v180, v180
    v_exp_f32 v181, v181
    v_smfmac_f32_32x32x32_bf16 v[112:127], v[20:23], v[104:111], v7
    v_exp_f32 v182, v182
    v_exp_f32 v183, v183
    v_exp_f32 v184, v184
    v_exp_f32 v185, v185
    v_exp_f32 v186, v186
    v_exp_f32 v187, v187
    v_exp_f32 v188, v188
    v_exp_f32 v189, v189
    v_exp_f32 v190, v190
    v_exp_f32 v191, v191
    v_exp_f32 v80, v80
    v_exp_f32 v81, v81
    v_smfmac_f32_32x32x32_bf16 v[128:143], v[16:19], v[176:183], v7
    v_smfmac_f32_32x32x32_bf16 v[128:143], v[20:23], v[184:191], v7
    v_exp_f32 v82, v82
    v_exp_f32 v83, v83
    v_exp_f32 v84, v84
    v_mfma_f32_32x32x16_bf16 v[96:111], v[12:15], v[44:47], v[64:79]
    s_waitcnt lgkmcnt(0)
    v_exp_f32 v85, v85
    v_exp_f32 v86, v86
    v_exp_f32 v87, v87
    v_exp_f32 v88, v88
    v_exp_f32 v89, v89
    v_smfmac_f32_32x32x32_bf16 v[112:127], v[24:27], v[80:87], v7
    v_exp_f32 v90, v90
    v_exp_f32 v91, v91
    v_exp_f32 v92, v92
    v_exp_f32 v93, v93
    v_exp_f32 v94, v94
    v_exp_f32 v95, v95
    v_exp_f32 v96, v96
    v_exp_f32 v97, v97
    v_smfmac_f32_32x32x32_bf16 v[112:127], v[28:31], v[88:95], v7
    v_exp_f32 v98, v98
    v_exp_f32 v99, v99
    v_exp_f32 v100, v100
    v_exp_f32 v101, v101
    v_exp_f32 v102, v102
    v_exp_f32 v103, v103
    v_exp_f32 v104, v104
    v_exp_f32 v105, v105
    v_smfmac_f32_32x32x32_bf16 v[128:143], v[24:27], v[96:103], v7
    v_exp_f32 v106, v106
    v_exp_f32 v107, v107
    v_exp_f32 v108, v108
    v_exp_f32 v109, v109
    v_exp_f32 v110, v110
    v_exp_f32 v111, v111
    s_nop 1
    v_smfmac_f32_32x32x32_bf16 v[128:143], v[28:31], v[104:111], v7
    v_rcp_f32 v152, v120
    v_fma_f32 v150, v112, v113, v120
    v_fma_f32 v150, v114, v115, v150
    v_fma_f32 v150, v116, v117, v150
    v_fma_f32 v150, v118, v119, v150
    v_cmp_class_f32 vcc, v150, v6
    v_mul_f32 v112, v112, v152
    v_mul_f32 v113, v113, v152
    v_mul_f32 v114, v114, v152
    v_mul_f32 v115, v115, v152
    v_mul_f32 v116, v116, v152
    v_mul_f32 v117, v117, v152
    v_mul_f32 v118, v118, v152
    v_mul_f32 v119, v119, v152
    s_cbranch_vccnz L_c_fb_175
L_c_done_176:
    v_cvt_pk_bf16_f32 v112, v112, v113
    v_cvt_pk_bf16_f32 v113, v114, v115
    v_cvt_pk_bf16_f32 v114, v116, v117
    v_cvt_pk_bf16_f32 v115, v118, v119
    buffer_store_dwordx4 v[112:115], v2, s[32:35], s66 offen sc1
    v_rcp_f32 v152, v136
    v_fma_f32 v150, v128, v129, v136
    v_fma_f32 v150, v130, v131, v150
    v_fma_f32 v150, v132, v133, v150
    v_fma_f32 v150, v134, v135, v150
    v_cmp_class_f32 vcc, v150, v6
    v_mul_f32 v128, v128, v152
    v_mul_f32 v129, v129, v152
    v_mul_f32 v130, v130, v152
    v_mul_f32 v131, v131, v152
    v_mul_f32 v132, v132, v152
    v_mul_f32 v133, v133, v152
    v_mul_f32 v134, v134, v152
    v_mul_f32 v135, v135, v152
    s_cbranch_vccnz L_c_fb_179
L_c_done_180:
    s_add_u32 s66, s66, 131072
    v_cvt_pk_bf16_f32 v128, v128, v129
    v_cvt_pk_bf16_f32 v129, v130, v131
    v_cvt_pk_bf16_f32 v130, v132, v133
    v_cvt_pk_bf16_f32 v131, v134, v135
    buffer_store_dwordx4 v[128:131], v2, s[32:35], s66 offen sc1
L_fin:
L_end:
    s_endpgm
L_eAD_sl_152:
    s_sleep 1
    ds_read_b32 v145, v144 offset:12
    s_waitcnt lgkmcnt(0)
    v_cmp_ne_u32 vcc, 1253888, v145
    s_nop 0
    s_cbranch_vccnz L_eAD_sl_152
    s_branch L_eAD_ok_151
L_eKV1_sl_164:
    s_sleep 1
    ds_read_b32 v145, v144 offset:20
    s_waitcnt lgkmcnt(0)
    v_cmp_ne_u32 vcc, 626944, v145
    s_nop 0
    s_cbranch_vccnz L_eKV1_sl_164
    s_branch L_eKV1_ok_163
L_eKV2_sl_167:
    s_sleep 1
    ds_read_b32 v145, v144 offset:24
    s_waitcnt lgkmcnt(0)
    v_cmp_ne_u32 vcc, 626944, v145
    s_nop 0
    s_cbranch_vccnz L_eKV2_sl_167
    s_branch L_eKV2_ok_166
L_eKV3_sl_170:
    s_sleep 1
    ds_read_b32 v145, v144 offset:28
    s_waitcnt lgkmcnt(0)
    v_cmp_ne_u32 vcc, 626944, v145
    s_nop 0
    s_cbranch_vccnz L_eKV3_sl_170
    s_branch L_eKV3_ok_169
L_eKV4_sl_173:
    s_sleep 1
    ds_read_b32 v145, v144 offset:32
    s_waitcnt lgkmcnt(0)
    v_cmp_ne_u32 vcc, 626944, v145
    s_nop 0
    s_cbranch_vccnz L_eKV4_sl_173
    s_branch L_eKV4_ok_172
L_c_fb_175:
    s_nop 15
    s_lshl_b32 s47, s60, 16
    s_add_u32 s48, s47, 2097152
    s_mov_b32 s62, 64
    v_mov_b32 v150, 0xff800000
L_c_fb1_177:
    buffer_load_dwordx4 v[8:11], v2, s[32:35], s48 offen sc1
    s_add_u32 s48, s48, 1024
    s_waitcnt vmcnt(0)
    v_mfma_f32_32x32x16_bf16 v[80:95], v[8:11], v[40:43], 0
    s_nop 11
    v_max3_f32 v150, v150, v80, v81
    v_max3_f32 v150, v150, v82, v83
    v_max3_f32 v150, v150, v84, v85
    v_max3_f32 v150, v150, v86, v87
    v_max3_f32 v150, v150, v88, v89
    v_max3_f32 v150, v150, v90, v91
    v_max3_f32 v150, v150, v92, v93
    v_max3_f32 v150, v150, v94, v95
    s_sub_u32 s62, s62, 1
    s_nop 4
    s_cmp_lg_u32 s62, 0
    s_cbranch_scc1 L_c_fb1_177
    v_mov_b32 v151, v150
    s_nop 1
    v_permlane32_swap_b32 v150, v151
    v_lshrrev_b32 v152, 5, v1
    v_lshlrev_b32 v152, 8, v152
    v_max_f32 v150, v150, v151
    v_and_b32 v151, 15, v1
    v_lshl_add_u32 v152, v151, 4, v152
    v_sub_f32 v48, 0, v150
    v_sub_f32 v49, 0, v150
    v_sub_f32 v50, 0, v150
    v_sub_f32 v51, 0, v150
    v_sub_f32 v52, 0, v150
    v_sub_f32 v53, 0, v150
    v_sub_f32 v54, 0, v150
    v_sub_f32 v55, 0, v150
    v_sub_f32 v56, 0, v150
    v_sub_f32 v57, 0, v150
    v_sub_f32 v58, 0, v150
    v_sub_f32 v59, 0, v150
    v_sub_f32 v60, 0, v150
    v_sub_f32 v61, 0, v150
    v_sub_f32 v62, 0, v150
    v_sub_f32 v63, 0, v150
    v_mov_b32 v112, 0
    v_mov_b32 v113, 0
    v_mov_b32 v114, 0
    v_mov_b32 v115, 0
    v_mov_b32 v116, 0
    v_mov_b32 v117, 0
    v_mov_b32 v118, 0
    v_mov_b32 v119, 0
    v_mov_b32 v120, 0
    v_mov_b32 v121, 0
    v_mov_b32 v122, 0
    v_mov_b32 v123, 0
    v_mov_b32 v124, 0
    v_mov_b32 v125, 0
    v_mov_b32 v126, 0
    v_mov_b32 v127, 0
    v_mov_b32 v16, 0x4d804d80
    v_mov_b32 v17, 0x4d804d80
    v_mov_b32 v18, 0x4d804d80
    v_mov_b32 v19, 0x4d804d80
    v_mov_b32 v20, 0x4d804d80
    v_mov_b32 v21, 0x4d804d80
    v_mov_b32 v22, 0x4d804d80
    v_mov_b32 v23, 0x4d804d80
    s_add_u32 s48, s47, 2097152
    s_add_u32 s47, s47, 4194304
    s_mov_b32 s62, 64
L_c_fb2_178:
    buffer_load_dwordx4 v[8:11], v2, s[32:35], s48 offen sc1
    s_mov_b32 exec_lo, 0xffff
    s_mov_b32 exec_hi, 0xffff
    buffer_load_dwordx4 v[16:19], v152, s[32:35], s47 offen sc1
    buffer_load_dwordx4 v[20:23], v152, s[32:35], s47 offen offset:512 sc1
    s_mov_b64 exec, -1
    s_add_u32 s48, s48, 1024
    s_add_u32 s47, s47, 1024
    s_waitcnt vmcnt(0)
    v_mfma_f32_32x32x16_bf16 v[80:95], v[8:11], v[40:43], v[48:63]
    s_nop 11
    v_exp_f32 v80, v80
    v_exp_f32 v81, v81
    v_exp_f32 v82, v82
    v_exp_f32 v83, v83
    v_exp_f32 v84, v84
    v_exp_f32 v85, v85
    v_exp_f32 v86, v86
    v_exp_f32 v87, v87
    v_exp_f32 v88, v88
    v_exp_f32 v89, v89
    v_exp_f32 v90, v90
    v_exp_f32 v91, v91
    v_exp_f32 v92, v92
    v_exp_f32 v93, v93
    v_exp_f32 v94, v94
    v_exp_f32 v95, v95
    v_cvt_pk_bf16_f32 v32, v80, v81
    v_cvt_pk_bf16_f32 v33, v82, v83
    v_cvt_pk_bf16_f32 v34, v84, v85
    v_cvt_pk_bf16_f32 v35, v86, v87
    v_cvt_pk_bf16_f32 v36, v88, v89
    v_cvt_pk_bf16_f32 v37, v90, v91
    v_cvt_pk_bf16_f32 v38, v92, v93
    v_cvt_pk_bf16_f32 v39, v94, v95
    v_mfma_f32_32x32x16_bf16 v[112:127], v[16:19], v[32:35], v[112:127]
    s_nop 0
    v_mfma_f32_32x32x16_bf16 v[112:127], v[20:23], v[36:39], v[112:127]
    s_sub_u32 s62, s62, 1
    s_nop 15
    s_cmp_lg_u32 s62, 0
    s_cbranch_scc1 L_c_fb2_178
    v_rcp_f32 v152, v120
    s_nop 1
    v_mul_f32 v112, v112, v152
    v_mul_f32 v113, v113, v152
    v_mul_f32 v114, v114, v152
    v_mul_f32 v115, v115, v152
    v_mul_f32 v116, v116, v152
    v_mul_f32 v117, v117, v152
    v_mul_f32 v118, v118, v152
    v_mul_f32 v119, v119, v152
    s_branch L_c_done_176
L_c_fb_179:
    s_nop 15
    s_lshl_b32 s47, s60, 16
    s_add_u32 s48, s47, 2097152
    s_mov_b32 s62, 64
    v_mov_b32 v150, 0xff800000
L_c_fb1_181:
    buffer_load_dwordx4 v[8:11], v2, s[32:35], s48 offen sc1
    s_add_u32 s48, s48, 1024
    s_waitcnt vmcnt(0)
    v_mfma_f32_32x32x16_bf16 v[80:95], v[8:11], v[44:47], 0
    s_nop 11
    v_max3_f32 v150, v150, v80, v81
    v_max3_f32 v150, v150, v82, v83
    v_max3_f32 v150, v150, v84, v85
    v_max3_f32 v150, v150, v86, v87
    v_max3_f32 v150, v150, v88, v89
    v_max3_f32 v150, v150, v90, v91
    v_max3_f32 v150, v150, v92, v93
    v_max3_f32 v150, v150, v94, v95
    s_sub_u32 s62, s62, 1
    s_nop 4
    s_cmp_lg_u32 s62, 0
    s_cbranch_scc1 L_c_fb1_181
    v_mov_b32 v151, v150
    s_nop 1
    v_permlane32_swap_b32 v150, v151
    v_lshrrev_b32 v152, 5, v1
    v_lshlrev_b32 v152, 8, v152
    v_max_f32 v150, v150, v151
    v_and_b32 v151, 15, v1
    v_lshl_add_u32 v152, v151, 4, v152
    v_sub_f32 v48, 0, v150
    v_sub_f32 v49, 0, v150
    v_sub_f32 v50, 0, v150
    v_sub_f32 v51, 0, v150
    v_sub_f32 v52, 0, v150
    v_sub_f32 v53, 0, v150
    v_sub_f32 v54, 0, v150
    v_sub_f32 v55, 0, v150
    v_sub_f32 v56, 0, v150
    v_sub_f32 v57, 0, v150
    v_sub_f32 v58, 0, v150
    v_sub_f32 v59, 0, v150
    v_sub_f32 v60, 0, v150
    v_sub_f32 v61, 0, v150
    v_sub_f32 v62, 0, v150
    v_sub_f32 v63, 0, v150
    v_mov_b32 v128, 0
    v_mov_b32 v129, 0
    v_mov_b32 v130, 0
    v_mov_b32 v131, 0
    v_mov_b32 v132, 0
    v_mov_b32 v133, 0
    v_mov_b32 v134, 0
    v_mov_b32 v135, 0
    v_mov_b32 v136, 0
    v_mov_b32 v137, 0
    v_mov_b32 v138, 0
    v_mov_b32 v139, 0
    v_mov_b32 v140, 0
    v_mov_b32 v141, 0
    v_mov_b32 v142, 0
    v_mov_b32 v143, 0
    v_mov_b32 v16, 0x4d804d80
    v_mov_b32 v17, 0x4d804d80
    v_mov_b32 v18, 0x4d804d80
    v_mov_b32 v19, 0x4d804d80
    v_mov_b32 v20, 0x4d804d80
    v_mov_b32 v21, 0x4d804d80
    v_mov_b32 v22, 0x4d804d80
    v_mov_b32 v23, 0x4d804d80
    s_add_u32 s48, s47, 2097152
    s_add_u32 s47, s47, 4194304
    s_mov_b32 s62, 64
L_c_fb2_182:
    buffer_load_dwordx4 v[8:11], v2, s[32:35], s48 offen sc1
    s_mov_b32 exec_lo, 0xffff
    s_mov_b32 exec_hi, 0xffff
    buffer_load_dwordx4 v[16:19], v152, s[32:35], s47 offen sc1
    buffer_load_dwordx4 v[20:23], v152, s[32:35], s47 offen offset:512 sc1
    s_mov_b64 exec, -1
    s_add_u32 s48, s48, 1024
    s_add_u32 s47, s47, 1024
    s_waitcnt vmcnt(0)
    v_mfma_f32_32x32x16_bf16 v[80:95], v[8:11], v[44:47], v[48:63]
    s_nop 11
    v_exp_f32 v80, v80
    v_exp_f32 v81, v81
    v_exp_f32 v82, v82
    v_exp_f32 v83, v83
    v_exp_f32 v84, v84
    v_exp_f32 v85, v85
    v_exp_f32 v86, v86
    v_exp_f32 v87, v87
    v_exp_f32 v88, v88
    v_exp_f32 v89, v89
    v_exp_f32 v90, v90
    v_exp_f32 v91, v91
    v_exp_f32 v92, v92
    v_exp_f32 v93, v93
    v_exp_f32 v94, v94
    v_exp_f32 v95, v95
    v_cvt_pk_bf16_f32 v32, v80, v81
    v_cvt_pk_bf16_f32 v33, v82, v83
    v_cvt_pk_bf16_f32 v34, v84, v85
    v_cvt_pk_bf16_f32 v35, v86, v87
    v_cvt_pk_bf16_f32 v36, v88, v89
    v_cvt_pk_bf16_f32 v37, v90, v91
    v_cvt_pk_bf16_f32 v38, v92, v93
    v_cvt_pk_bf16_f32 v39, v94, v95
    v_mfma_f32_32x32x16_bf16 v[128:143], v[16:19], v[32:35], v[128:143]
    s_nop 0
    v_mfma_f32_32x32x16_bf16 v[128:143], v[20:23], v[36:39], v[128:143]
    s_sub_u32 s62, s62, 1
    s_nop 15
    s_cmp_lg_u32 s62, 0
    s_cbranch_scc1 L_c_fb2_182
    v_rcp_f32 v152, v136
    s_nop 1
    v_mul_f32 v128, v128, v152
    v_mul_f32 v129, v129, v152
    v_mul_f32 v130, v130, v152
    v_mul_f32 v131, v131, v152
    v_mul_f32 v132, v132, v152
    v_mul_f32 v133, v133, v152
    v_mul_f32 v134, v134, v152
    v_mul_f32 v135, v135, v152
    s_branch L_c_done_180
L_code_end:
.section .rodata,"a"
.p2align 6
.amdhsa_kernel parallel_sum__mha_block__geglu_ffn__prompt_kernel
  .amdhsa_next_free_vgpr 256
  .amdhsa_next_free_sgpr 102
  .amdhsa_accum_offset 256
  .amdhsa_group_segment_fixed_size 0
  .amdhsa_kernarg_size 80
  .amdhsa_user_sgpr_count 2
  .amdhsa_user_sgpr_kernarg_segment_ptr 1
  .amdhsa_system_sgpr_workgroup_id_x 1
.end_amdhsa_kernel
```
